```python
import torch

def _softmax(x, axis=-1):
    return torch.softmax(x, dim=axis)
def _gelu(x):
    return torch.nn.functional.gelu(x, approximate="tanh")
def _silu(x):
    return torch.nn.functional.silu(x)
def _sigmoid(x):
    return torch.sigmoid(x)
def _layernorm(x, axis=-1, eps=1e-5):
    m = x.mean(dim=axis, keepdim=True)
    v = x.var(dim=axis, keepdim=True, unbiased=False)
    return (x - m) / torch.sqrt(v + eps)
def _scatter_add(tgt, idx, src, axis=0):
    return tgt.clone().index_add_(axis, idx, src)
def _segment_sum(src, seg, n):
    out = torch.zeros((n,) + src.shape[1:], dtype=src.dtype)
    return out.index_add_(0, seg, src)
def _pad(x, pw):
    flat = tuple(v for pair in reversed(pw) for v in pair)
    return torch.nn.functional.pad(x, flat)

kernel_name = 'concat_heads__ssm_conv_s4d__mha_block__prompt'

def setup_inputs():

    _w = (lambda a: (lambda t: t.to(torch.bfloat16) if t.is_floating_point() else t)(torch.as_tensor(a)))
    def _A_setup():
        Bsz, L, D, N = 1, 2048, 576, 128
        return {
            "u": _w((lambda *s: torch.randn(*s, dtype=torch.bfloat16) * 0.05)(Bsz, L, D)),
            "log_A_real": _w((lambda *s: torch.randn(*s, dtype=torch.bfloat16) * 3.2)(D, N) * 0.5),
            "A_imag": _w((lambda *s: torch.randn(*s, dtype=torch.bfloat16) * 0.1)(D, N) * 3.14),
            "C_real": _w((lambda *s: torch.randn(*s, dtype=torch.bfloat16) * 0.8)(D, N) / N ** 0.5),
            "C_imag": _w((lambda *s: torch.randn(*s, dtype=torch.bfloat16) * 1.6)(D, N) / N ** 0.5),
            "log_dt": _w((lambda *s: torch.randn(*s, dtype=torch.bfloat16) * 0.1)(D) * 0.5 - 4.0),
            "D_skip": _w((lambda *s: torch.randn(*s, dtype=torch.bfloat16) * 0.1)(D)),
        }
    _A_in = _A_setup()

    def _B_setup():
        B, S, D, H = 1, 2048, 576, 32
        return {
            "x": _w((lambda *s: torch.randn(*s, dtype=torch.bfloat16) * 0.2)(B, S, D)),
            "wqkv": _w((lambda *s: torch.randn(*s, dtype=torch.bfloat16) * 0.2)(D, 3 * D)),
            "wo": _w((lambda *s: torch.randn(*s, dtype=torch.bfloat16) * 0.05)(D, D)),
        }
    _B_in = _B_setup()

    return {
        "A_u": _A_in["u"],
        "A_log_A_real": _A_in["log_A_real"],
        "A_A_imag": _A_in["A_imag"],
        "A_C_real": _A_in["C_real"],
        "A_C_imag": _A_in["C_imag"],
        "A_log_dt": _A_in["log_dt"],
        "A_D_skip": _A_in["D_skip"],
        "B_x": _B_in["x"],
        "B_wqkv": _B_in["wqkv"],
        "B_wo": _B_in["wo"],
    }

def reference(A_u, A_log_A_real, A_A_imag, A_C_real, A_C_imag, A_log_dt, A_D_skip, B_x, B_wqkv, B_wo):
    def _A_ref(u, log_A_real, A_imag, C_real, C_imag, log_dt, D_skip):
        L = u.shape[1]
        dt = torch.exp(log_dt)
        A = -torch.exp(log_A_real) + 1j * A_imag
        C = (C_real + 1j * C_imag) * dt[:, None]
        pos = (lambda x, dt: x.to(dt))(torch.arange(L), log_dt.dtype)
        P = torch.exp((A * dt[:, None])[:, :, None] * pos[None, None, :])
        K = 2.0 * torch.einsum("dn,dnl->dl", C, P).real
        L2 = 2 * L
        u_t = (lambda x, *d: x.permute(*d))(u, 0, 2, 1)
        Kf = (lambda x, *a, **k: torch.fft.rfft(x.float(), *a, **k))(K, L2)
        Uf = (lambda x, *a, **k: torch.fft.rfft(x.float(), *a, **k))(u_t, L2)
        y = (lambda x, *a, **k: torch.fft.irfft(x, *a, **k).to(torch.bfloat16))(Uf * Kf[None, :, :], L2)[:, :, :L]
        y = (lambda x, *d: x.permute(*d))(y, 0, 2, 1)
        return y + u * D_skip[None, None, :]

    def _B_ref(x, wqkv, wo):
        B, S, D = x.shape
        H = 32
        Dh = D // H
        qkv = (lambda x, *d: x.permute(*d))((x @ wqkv).reshape(B, S, 3, H, Dh), 2, 0, 3, 1, 4)
        q, k, v = qkv[0], qkv[1], qkv[2]
        scores = torch.einsum("bhqd,bhkd->bhqk", q, k) * (Dh ** -0.5)
        p = _softmax(scores, axis=-1)
        o = torch.einsum("bhqk,bhkd->bhqd", p, v)
        return (lambda x, *d: x.permute(*d))(o, 0, 2, 1, 3).reshape(B, S, D) @ wo

    a = _A_ref(A_u, A_log_A_real, A_A_imag, A_C_real, A_C_imag, A_log_dt, A_D_skip)
    b = _B_ref(B_x, B_wqkv, B_wo)
    return torch.concatenate([a, b], axis=-1)
```

```asm
; @launch kernel=k1_kernel grid=(256,1,1) block=(704,1,1) lds=158976
; @launch kernel=k2_kernel grid=(256,1,1) block=(512,1,1) lds=163840
; @launch kernel=k3_kernel grid=(216,1,1) block=(512,1,1) lds=98304
.amdgcn_target "amdgcn-amd-amdhsa--gfx950"

.text
.globl k1_kernel
.p2align 8
.type k1_kernel,@function
k1_kernel:
    s_cmp_ge_u32 s2, 256
    s_cbranch_scc1 L_k1_kernel_exit
    v_lshrrev_b32 v1, 6, v0
    v_and_b32 v2, 63, v0
    s_nop 0
    v_readfirstlane_b32 s49, v1
    s_nop 3
    s_cmp_ge_u32 s2, 8
    s_cbranch_scc1 L_k1_kernel_ipfskip_5
    s_cmp_lt_u32 s49, 8
    s_cbranch_scc1 L_k1_kernel_ipfskip_5
    s_getpc_b64 s[4:5]
L_k1_kernel_pc_4:
    s_add_u32 s4, s4, k1_kernel - L_k1_kernel_pc_4
    s_addc_u32 s5, s5, -1
    s_sub_u32 s6, s49, 8
    s_lshl_b32 s6, s6, 13
    s_mov_b32 s7, L_text_end - k1_kernel - 4
    v_lshlrev_b32 v6, 7, v2
    v_add_u32 v4, s6, v6
    v_min_u32 v4, s7, v4
    v_mov_b32 v5, s5
    v_add_co_u32 v4, vcc, s4, v4
    s_add_u32 s6, s6, 24576
    s_nop 0
    v_addc_co_u32 v5, vcc, 0, v5, vcc
    global_load_dword v40, v[4:5], off
    v_add_u32 v4, s6, v6
    v_min_u32 v4, s7, v4
    v_mov_b32 v5, s5
    v_add_co_u32 v4, vcc, s4, v4
    s_add_u32 s6, s6, 24576
    s_nop 0
    v_addc_co_u32 v5, vcc, 0, v5, vcc
    global_load_dword v41, v[4:5], off
    v_add_u32 v4, s6, v6
    v_min_u32 v4, s7, v4
    v_mov_b32 v5, s5
    v_add_co_u32 v4, vcc, s4, v4
    s_add_u32 s6, s6, 24576
    s_nop 0
    v_addc_co_u32 v5, vcc, 0, v5, vcc
    global_load_dword v42, v[4:5], off
L_k1_kernel_ipfskip_5:
    s_cmp_ge_u32 s2, 192
    s_cbranch_scc1 L_k1_kernel_kg_2
    s_cmp_ge_u32 s49, 8
    s_cbranch_scc1 L_k1_kernel_pf_6
    s_load_dwordx4 s[4:7], s[0:1], 56
    s_load_dwordx2 s[28:29], s[0:1], 96
    v_lshrrev_b32 v1, 6, v0
    v_and_b32 v2, 63, v0
    s_and_b32 s30, s2, 7
    v_readfirstlane_b32 s49, v1
    s_lshr_b32 s31, s2, 3
    s_lshr_b32 s21, s30, 1
    s_lshl_b32 s21, s21, 2
    s_and_b32 s32, s31, 3
    s_add_u32 s21, s21, s32
    s_and_b32 s32, s30, 1
    s_mul_i32 s32, s32, 6
    s_lshr_b32 s33, s31, 2
    s_add_u32 s32, s32, s33
    s_lshr_b32 s22, s32, 2
    s_and_b32 s23, s32, 3
    s_and_b32 s20, s49, 3
    s_lshr_b32 s43, s49, 2
    s_lshl_b32 s24, s21, 7
    s_lshl_b32 s33, s20, 5
    s_add_u32 s24, s24, s33
    s_lshl_b32 s33, s43, 4
    s_add_u32 s24, s24, s33
    s_mul_i32 s24, s24, 1152
    s_mul_i32 s25, s22, 1152
    s_mul_i32 s33, s23, 288
    s_add_u32 s25, s25, s33
    s_mul_i32 s33, s49, 27648
    s_add_u32 s25, s25, s33
    s_lshl_b32 s26, s20, 12
    s_lshl_b32 s33, s43, 11
    s_add_u32 s48, s26, s33
    s_mul_i32 s27, s49, 3072
    s_add_u32 s27, s27, 49152
    v_lshrrev_b32 v100, 3, v2
    v_mul_u32_u24 v100, 1152, v100
    v_and_b32 v101, 7, v2
    v_lshrrev_b32 v102, 4, v2
    v_xor_b32 v103, v101, v102
    v_lshl_add_u32 v4, v103, 4, v100
    v_xor_b32 v103, 4, v103
    v_lshl_add_u32 v5, v103, 4, v100
    v_add_u32 v100, 0, v2
    v_mul_u32_u24 v101, 2731, v100
    v_lshrrev_b32 v101, 16, v101
    v_mul_u32_u24 v102, 24, v101
    v_sub_u32 v102, v100, v102
    v_bfe_u32 v103, v101, 1, 1
    v_lshlrev_b32 v104, 2, v103
    v_xor_b32 v104, v102, v104
    v_lshrrev_b32 v105, 1, v104
    v_mul_u32_u24 v105, 36, v105
    v_and_b32 v104, 1, v104
    v_lshl_add_u32 v105, v104, 4, v105
    v_subrev_u32 v106, 16, v102
    v_mul_u32_u24 v106, 36, v106
    v_add_u32 v106, 32, v106
    v_lshlrev_b32 v103, 3, v103
    v_sub_u32 v106, v106, v103
    v_cmp_gt_u32 vcc, 16, v102
    v_mul_u32_u24 v101, 3456, v101
    s_nop 0
    v_cndmask_b32_e64 v105, v106, v105, vcc
    v_add_u32 v6, v101, v105
    v_add_u32 v100, 64, v2
    v_mul_u32_u24 v101, 2731, v100
    v_lshrrev_b32 v101, 16, v101
    v_mul_u32_u24 v102, 24, v101
    v_sub_u32 v102, v100, v102
    v_bfe_u32 v103, v101, 1, 1
    v_lshlrev_b32 v104, 2, v103
    v_xor_b32 v104, v102, v104
    v_lshrrev_b32 v105, 1, v104
    v_mul_u32_u24 v105, 36, v105
    v_and_b32 v104, 1, v104
    v_lshl_add_u32 v105, v104, 4, v105
    v_subrev_u32 v106, 16, v102
    v_mul_u32_u24 v106, 36, v106
    v_add_u32 v106, 32, v106
    v_lshlrev_b32 v103, 3, v103
    v_sub_u32 v106, v106, v103
    v_cmp_gt_u32 vcc, 16, v102
    v_mul_u32_u24 v101, 3456, v101
    s_nop 0
    v_cndmask_b32_e64 v105, v106, v105, vcc
    v_add_u32 v7, v101, v105
    v_add_u32 v100, 128, v2
    v_mul_u32_u24 v101, 2731, v100
    v_lshrrev_b32 v101, 16, v101
    v_mul_u32_u24 v102, 24, v101
    v_sub_u32 v102, v100, v102
    v_bfe_u32 v103, v101, 1, 1
    v_lshlrev_b32 v104, 2, v103
    v_xor_b32 v104, v102, v104
    v_lshrrev_b32 v105, 1, v104
    v_mul_u32_u24 v105, 36, v105
    v_and_b32 v104, 1, v104
    v_lshl_add_u32 v105, v104, 4, v105
    v_subrev_u32 v106, 16, v102
    v_mul_u32_u24 v106, 36, v106
    v_add_u32 v106, 32, v106
    v_lshlrev_b32 v103, 3, v103
    v_sub_u32 v106, v106, v103
    v_cmp_gt_u32 vcc, 16, v102
    v_mul_u32_u24 v101, 3456, v101
    s_nop 0
    v_cndmask_b32_e64 v105, v106, v105, vcc
    v_add_u32 v8, v101, v105
    s_waitcnt lgkmcnt(0)
    s_mov_b32 s8, s4
    s_and_b32 s9, s5, 0xffff
    s_mov_b32 s10, 2359296
    s_mov_b32 s11, 0x00020000
    s_mov_b32 s12, s6
    s_and_b32 s13, s7, 0xffff
    s_mov_b32 s14, 1990656
    s_mov_b32 s15, 0x00020000
    s_mov_b32 s16, s28
    s_and_b32 s17, s29, 0xffff
    s_mov_b32 s18, 26214400
    s_mov_b32 s19, 0x00020000
    s_add_u32 m0, s48, 0
    s_add_u32 s28, s24, 0
    buffer_load_dwordx4 v4, s[8:11], s28 offen lds
    s_add_u32 m0, s48, 1024
    s_add_u32 s28, s24, 9216
    buffer_load_dwordx4 v5, s[8:11], s28 offen lds
    s_add_u32 m0, s27, 0
    s_add_u32 s28, s25, 0
    buffer_load_dwordx4 v6, s[12:15], s28 offen lds
    s_add_u32 m0, s27, 1024
    s_add_u32 s28, s25, 0
    buffer_load_dwordx4 v7, s[12:15], s28 offen lds
    s_add_u32 m0, s27, 2048
    s_add_u32 s28, s25, 0
    buffer_load_dwordx4 v8, s[12:15], s28 offen lds
    s_barrier
    s_add_u32 m0, s48, 16384
    s_add_u32 s28, s24, 128
    buffer_load_dwordx4 v4, s[8:11], s28 offen lds
    s_add_u32 m0, s48, 17408
    s_add_u32 s28, s24, 9344
    buffer_load_dwordx4 v5, s[8:11], s28 offen lds
    s_add_u32 m0, s27, 24576
    s_add_u32 s28, s25, 221184
    buffer_load_dwordx4 v6, s[12:15], s28 offen lds
    s_add_u32 m0, s27, 25600
    s_add_u32 s28, s25, 221184
    buffer_load_dwordx4 v7, s[12:15], s28 offen lds
    s_add_u32 m0, s27, 26624
    s_add_u32 s28, s25, 221184
    buffer_load_dwordx4 v8, s[12:15], s28 offen lds
    v_and_b32 v100, 31, v2
    v_lshrrev_b32 v101, 5, v2
    v_bfe_u32 v102, v100, 1, 3
    v_lshlrev_b32 v100, 7, v100
    v_add_u32 v100, s26, v100
    v_add_u32 v103, 0, v101
    v_xor_b32 v103, v103, v102
    v_lshl_add_u32 v9, v103, 4, v100
    v_add_u32 v103, 2, v101
    v_xor_b32 v103, v103, v102
    v_lshl_add_u32 v10, v103, 4, v100
    v_add_u32 v103, 4, v101
    v_xor_b32 v103, v103, v102
    v_lshl_add_u32 v11, v103, 4, v100
    v_add_u32 v103, 6, v101
    v_xor_b32 v103, v103, v102
    v_lshl_add_u32 v12, v103, 4, v100
    v_bfe_u32 v100, v2, 2, 2
    v_lshrrev_b32 v101, 5, v2
    v_lshl_add_u32 v100, v101, 3, v100
    v_mul_u32_u24 v100, 384, v100
    v_add_u32 v100, 49152, v100
    v_bfe_u32 v101, v2, 4, 1
    v_and_b32 v102, 3, v2
    v_bfe_u32 v103, v2, 3, 1
    v_and_b32 v104, 1, v102
    v_lshl_add_u32 v104, v101, 1, v104
    v_lshlrev_b32 v104, 4, v104
    v_lshrrev_b32 v105, 1, v102
    v_lshl_add_u32 v104, v105, 3, v104
    v_add_u32 v104, v100, v104
    v_lshl_add_u32 v106, v103, 6, v104
    v_xor_b32 v105, 1, v103
    v_lshl_add_u32 v107, v105, 6, v104
    v_lshl_add_u32 v104, v101, 2, v102
    v_add_u32 v104, 16, v104
    v_lshl_add_u32 v104, v104, 4, v100
    v_lshl_add_u32 v110, v103, 3, v104
    s_cmp_eq_u32 s43, 1
    s_cbranch_scc1 L_k1_kernel_half1_8
    v_add_u32 v13, 0, v106
    v_add_u32 v96, 49152, v106
    v_add_u32 v14, 0, v107
    v_add_u32 v97, 49152, v107
    v_add_u32 v15, 128, v106
    v_add_u32 v98, 49280, v106
    s_cmp_eq_u32 s22, 2
    s_cbranch_scc1 L_k1_kernel_v_9
    s_waitcnt vmcnt(5)
    s_waitcnt lgkmcnt(0)
    s_barrier
    ds_read_b128 v[64:67], v9 offset:0
    ds_read_b64_tr_b16 v[72:73], v13 offset:0
    ds_read_b64_tr_b16 v[74:75], v13 offset:1536
    ds_read_b64_tr_b16 v[76:77], v14 offset:0
    ds_read_b64_tr_b16 v[78:79], v14 offset:1536
    ds_read_b64_tr_b16 v[80:81], v15 offset:0
    ds_read_b64_tr_b16 v[82:83], v15 offset:1536
    s_waitcnt lgkmcnt(4)
    v_mfma_f32_32x32x16_bf16 v[16:31], v[72:75], v[64:67], 0
    ds_read_b128 v[68:71], v10 offset:0
    ds_read_b64_tr_b16 v[84:85], v13 offset:6144
    ds_read_b64_tr_b16 v[86:87], v13 offset:7680
    s_add_u32 m0, s48, 32768
    s_add_u32 s28, s24, 256
    buffer_load_dwordx4 v4, s[8:11], s28 offen lds
    s_waitcnt lgkmcnt(5)
    v_mfma_f32_32x32x16_bf16 v[32:47], v[76:79], v[64:67], 0
    ds_read_b64_tr_b16 v[88:89], v14 offset:6144
    ds_read_b64_tr_b16 v[90:91], v14 offset:7680
    ds_read_b64_tr_b16 v[92:93], v15 offset:6144
    s_waitcnt lgkmcnt(6)
    v_mfma_f32_32x32x16_bf16 v[48:63], v[80:83], v[64:67], 0
    ds_read_b64_tr_b16 v[94:95], v15 offset:7680
    s_waitcnt lgkmcnt(4)
    v_mfma_f32_32x32x16_bf16 v[16:31], v[84:87], v[68:71], v[16:31]
    ds_read_b128 v[64:67], v11 offset:0
    ds_read_b64_tr_b16 v[72:73], v13 offset:12288
    ds_read_b64_tr_b16 v[74:75], v13 offset:13824
    s_add_u32 m0, s48, 33792
    s_add_u32 s28, s24, 9472
    buffer_load_dwordx4 v5, s[8:11], s28 offen lds
    s_waitcnt lgkmcnt(5)
    v_mfma_f32_32x32x16_bf16 v[32:47], v[88:91], v[68:71], v[32:47]
    ds_read_b64_tr_b16 v[76:77], v14 offset:12288
    ds_read_b64_tr_b16 v[78:79], v14 offset:13824
    ds_read_b64_tr_b16 v[80:81], v15 offset:12288
    s_waitcnt lgkmcnt(6)
    v_mfma_f32_32x32x16_bf16 v[48:63], v[92:95], v[68:71], v[48:63]
    ds_read_b64_tr_b16 v[82:83], v15 offset:13824
    s_waitcnt lgkmcnt(4)
    v_mfma_f32_32x32x16_bf16 v[16:31], v[72:75], v[64:67], v[16:31]
    ds_read_b128 v[68:71], v12 offset:0
    ds_read_b64_tr_b16 v[84:85], v13 offset:18432
    ds_read_b64_tr_b16 v[86:87], v13 offset:19968
    s_add_u32 m0, s27, 49152
    s_add_u32 s28, s25, 442368
    buffer_load_dwordx4 v6, s[12:15], s28 offen lds
    s_waitcnt lgkmcnt(5)
    v_mfma_f32_32x32x16_bf16 v[32:47], v[76:79], v[64:67], v[32:47]
    ds_read_b64_tr_b16 v[88:89], v14 offset:18432
    ds_read_b64_tr_b16 v[90:91], v14 offset:19968
    ds_read_b64_tr_b16 v[92:93], v15 offset:18432
    s_waitcnt lgkmcnt(6)
    v_mfma_f32_32x32x16_bf16 v[48:63], v[80:83], v[64:67], v[48:63]
    ds_read_b64_tr_b16 v[94:95], v15 offset:19968
    s_add_u32 m0, s27, 50176
    s_add_u32 s28, s25, 442368
    buffer_load_dwordx4 v7, s[12:15], s28 offen lds
    s_add_u32 m0, s27, 51200
    s_add_u32 s28, s25, 442368
    buffer_load_dwordx4 v8, s[12:15], s28 offen lds
    s_waitcnt vmcnt(5)
    s_waitcnt lgkmcnt(0)
    s_barrier
    ds_read_b128 v[64:67], v9 offset:16384
    ds_read_b64_tr_b16 v[72:73], v13 offset:24576
    ds_read_b64_tr_b16 v[74:75], v13 offset:26112
    ds_read_b64_tr_b16 v[76:77], v14 offset:24576
    ds_read_b64_tr_b16 v[78:79], v14 offset:26112
    ds_read_b64_tr_b16 v[80:81], v15 offset:24576
    ds_read_b64_tr_b16 v[82:83], v15 offset:26112
    v_mfma_f32_32x32x16_bf16 v[16:31], v[84:87], v[68:71], v[16:31]
    s_add_u32 m0, s48, 0
    s_add_u32 s28, s24, 384
    buffer_load_dwordx4 v4, s[8:11], s28 offen lds
    v_mfma_f32_32x32x16_bf16 v[32:47], v[88:91], v[68:71], v[32:47]
    s_add_u32 m0, s48, 1024
    s_add_u32 s28, s24, 9600
    buffer_load_dwordx4 v5, s[8:11], s28 offen lds
    v_mfma_f32_32x32x16_bf16 v[48:63], v[92:95], v[68:71], v[48:63]
    s_add_u32 m0, s27, 0
    s_add_u32 s28, s25, 663552
    buffer_load_dwordx4 v6, s[12:15], s28 offen lds
    s_waitcnt lgkmcnt(4)
    v_mfma_f32_32x32x16_bf16 v[16:31], v[72:75], v[64:67], v[16:31]
    ds_read_b128 v[68:71], v10 offset:16384
    ds_read_b64_tr_b16 v[84:85], v13 offset:30720
    ds_read_b64_tr_b16 v[86:87], v13 offset:32256
    s_add_u32 m0, s27, 1024
    s_add_u32 s28, s25, 663552
    buffer_load_dwordx4 v7, s[12:15], s28 offen lds
    s_waitcnt lgkmcnt(5)
    v_mfma_f32_32x32x16_bf16 v[32:47], v[76:79], v[64:67], v[32:47]
    ds_read_b64_tr_b16 v[88:89], v14 offset:30720
    ds_read_b64_tr_b16 v[90:91], v14 offset:32256
    ds_read_b64_tr_b16 v[92:93], v15 offset:30720
    s_waitcnt lgkmcnt(6)
    v_mfma_f32_32x32x16_bf16 v[48:63], v[80:83], v[64:67], v[48:63]
    ds_read_b64_tr_b16 v[94:95], v15 offset:32256
    s_waitcnt lgkmcnt(4)
    v_mfma_f32_32x32x16_bf16 v[16:31], v[84:87], v[68:71], v[16:31]
    ds_read_b128 v[64:67], v11 offset:16384
    ds_read_b64_tr_b16 v[72:73], v13 offset:36864
    ds_read_b64_tr_b16 v[74:75], v13 offset:38400
    s_add_u32 m0, s27, 2048
    s_add_u32 s28, s25, 663552
    buffer_load_dwordx4 v8, s[12:15], s28 offen lds
    s_waitcnt lgkmcnt(5)
    v_mfma_f32_32x32x16_bf16 v[32:47], v[88:91], v[68:71], v[32:47]
    ds_read_b64_tr_b16 v[76:77], v14 offset:36864
    ds_read_b64_tr_b16 v[78:79], v14 offset:38400
    ds_read_b64_tr_b16 v[80:81], v15 offset:36864
    s_waitcnt lgkmcnt(6)
    v_mfma_f32_32x32x16_bf16 v[48:63], v[92:95], v[68:71], v[48:63]
    ds_read_b64_tr_b16 v[82:83], v15 offset:38400
    s_waitcnt lgkmcnt(4)
    v_mfma_f32_32x32x16_bf16 v[16:31], v[72:75], v[64:67], v[16:31]
    ds_read_b128 v[68:71], v12 offset:16384
    ds_read_b64_tr_b16 v[84:85], v13 offset:43008
    ds_read_b64_tr_b16 v[86:87], v13 offset:44544
    s_waitcnt lgkmcnt(5)
    v_mfma_f32_32x32x16_bf16 v[32:47], v[76:79], v[64:67], v[32:47]
    ds_read_b64_tr_b16 v[88:89], v14 offset:43008
    ds_read_b64_tr_b16 v[90:91], v14 offset:44544
    ds_read_b64_tr_b16 v[92:93], v15 offset:43008
    s_waitcnt lgkmcnt(6)
    v_mfma_f32_32x32x16_bf16 v[48:63], v[80:83], v[64:67], v[48:63]
    ds_read_b64_tr_b16 v[94:95], v15 offset:44544
    s_waitcnt vmcnt(5)
    s_waitcnt lgkmcnt(0)
    s_barrier
    ds_read_b128 v[64:67], v9 offset:32768
    ds_read_b64_tr_b16 v[72:73], v96 offset:0
    ds_read_b64_tr_b16 v[74:75], v96 offset:1536
    ds_read_b64_tr_b16 v[76:77], v97 offset:0
    ds_read_b64_tr_b16 v[78:79], v97 offset:1536
    ds_read_b64_tr_b16 v[80:81], v98 offset:0
    ds_read_b64_tr_b16 v[82:83], v98 offset:1536
    v_mfma_f32_32x32x16_bf16 v[16:31], v[84:87], v[68:71], v[16:31]
    s_add_u32 m0, s48, 16384
    s_add_u32 s28, s24, 512
    buffer_load_dwordx4 v4, s[8:11], s28 offen lds
    v_mfma_f32_32x32x16_bf16 v[32:47], v[88:91], v[68:71], v[32:47]
    s_add_u32 m0, s48, 17408
    s_add_u32 s28, s24, 9728
    buffer_load_dwordx4 v5, s[8:11], s28 offen lds
    v_mfma_f32_32x32x16_bf16 v[48:63], v[92:95], v[68:71], v[48:63]
    s_add_u32 m0, s27, 24576
    s_add_u32 s28, s25, 884736
    buffer_load_dwordx4 v6, s[12:15], s28 offen lds
    s_waitcnt lgkmcnt(4)
    v_mfma_f32_32x32x16_bf16 v[16:31], v[72:75], v[64:67], v[16:31]
    ds_read_b128 v[68:71], v10 offset:32768
    ds_read_b64_tr_b16 v[84:85], v96 offset:6144
    ds_read_b64_tr_b16 v[86:87], v96 offset:7680
    s_add_u32 m0, s27, 25600
    s_add_u32 s28, s25, 884736
    buffer_load_dwordx4 v7, s[12:15], s28 offen lds
    s_waitcnt lgkmcnt(5)
    v_mfma_f32_32x32x16_bf16 v[32:47], v[76:79], v[64:67], v[32:47]
    ds_read_b64_tr_b16 v[88:89], v97 offset:6144
    ds_read_b64_tr_b16 v[90:91], v97 offset:7680
    ds_read_b64_tr_b16 v[92:93], v98 offset:6144
    s_waitcnt lgkmcnt(6)
    v_mfma_f32_32x32x16_bf16 v[48:63], v[80:83], v[64:67], v[48:63]
    ds_read_b64_tr_b16 v[94:95], v98 offset:7680
    s_waitcnt lgkmcnt(4)
    v_mfma_f32_32x32x16_bf16 v[16:31], v[84:87], v[68:71], v[16:31]
    ds_read_b128 v[64:67], v11 offset:32768
    ds_read_b64_tr_b16 v[72:73], v96 offset:12288
    ds_read_b64_tr_b16 v[74:75], v96 offset:13824
    s_add_u32 m0, s27, 26624
    s_add_u32 s28, s25, 884736
    buffer_load_dwordx4 v8, s[12:15], s28 offen lds
    s_waitcnt lgkmcnt(5)
    v_mfma_f32_32x32x16_bf16 v[32:47], v[88:91], v[68:71], v[32:47]
    ds_read_b64_tr_b16 v[76:77], v97 offset:12288
    ds_read_b64_tr_b16 v[78:79], v97 offset:13824
    ds_read_b64_tr_b16 v[80:81], v98 offset:12288
    s_waitcnt lgkmcnt(6)
    v_mfma_f32_32x32x16_bf16 v[48:63], v[92:95], v[68:71], v[48:63]
    ds_read_b64_tr_b16 v[82:83], v98 offset:13824
    s_waitcnt lgkmcnt(4)
    v_mfma_f32_32x32x16_bf16 v[16:31], v[72:75], v[64:67], v[16:31]
    ds_read_b128 v[68:71], v12 offset:32768
    ds_read_b64_tr_b16 v[84:85], v96 offset:18432
    ds_read_b64_tr_b16 v[86:87], v96 offset:19968
    s_waitcnt lgkmcnt(5)
    v_mfma_f32_32x32x16_bf16 v[32:47], v[76:79], v[64:67], v[32:47]
    ds_read_b64_tr_b16 v[88:89], v97 offset:18432
    ds_read_b64_tr_b16 v[90:91], v97 offset:19968
    ds_read_b64_tr_b16 v[92:93], v98 offset:18432
    s_waitcnt lgkmcnt(6)
    v_mfma_f32_32x32x16_bf16 v[48:63], v[80:83], v[64:67], v[48:63]
    ds_read_b64_tr_b16 v[94:95], v98 offset:19968
    s_waitcnt vmcnt(5)
    s_waitcnt lgkmcnt(0)
    s_barrier
    ds_read_b128 v[64:67], v9 offset:0
    ds_read_b64_tr_b16 v[72:73], v13 offset:0
    ds_read_b64_tr_b16 v[74:75], v13 offset:1536
    ds_read_b64_tr_b16 v[76:77], v14 offset:0
    ds_read_b64_tr_b16 v[78:79], v14 offset:1536
    ds_read_b64_tr_b16 v[80:81], v15 offset:0
    ds_read_b64_tr_b16 v[82:83], v15 offset:1536
    v_mfma_f32_32x32x16_bf16 v[16:31], v[84:87], v[68:71], v[16:31]
    s_add_u32 m0, s48, 32768
    s_add_u32 s28, s24, 640
    buffer_load_dwordx4 v4, s[8:11], s28 offen lds
    v_mfma_f32_32x32x16_bf16 v[32:47], v[88:91], v[68:71], v[32:47]
    s_add_u32 m0, s48, 33792
    s_add_u32 s28, s24, 9856
    buffer_load_dwordx4 v5, s[8:11], s28 offen lds
    v_mfma_f32_32x32x16_bf16 v[48:63], v[92:95], v[68:71], v[48:63]
    s_add_u32 m0, s27, 49152
    s_add_u32 s28, s25, 1105920
    buffer_load_dwordx4 v6, s[12:15], s28 offen lds
    s_waitcnt lgkmcnt(4)
    v_mfma_f32_32x32x16_bf16 v[16:31], v[72:75], v[64:67], v[16:31]
    ds_read_b128 v[68:71], v10 offset:0
    ds_read_b64_tr_b16 v[84:85], v13 offset:6144
    ds_read_b64_tr_b16 v[86:87], v13 offset:7680
    s_add_u32 m0, s27, 50176
    s_add_u32 s28, s25, 1105920
    buffer_load_dwordx4 v7, s[12:15], s28 offen lds
    s_waitcnt lgkmcnt(5)
    v_mfma_f32_32x32x16_bf16 v[32:47], v[76:79], v[64:67], v[32:47]
    ds_read_b64_tr_b16 v[88:89], v14 offset:6144
    ds_read_b64_tr_b16 v[90:91], v14 offset:7680
    ds_read_b64_tr_b16 v[92:93], v15 offset:6144
    s_waitcnt lgkmcnt(6)
    v_mfma_f32_32x32x16_bf16 v[48:63], v[80:83], v[64:67], v[48:63]
    ds_read_b64_tr_b16 v[94:95], v15 offset:7680
    s_waitcnt lgkmcnt(4)
    v_mfma_f32_32x32x16_bf16 v[16:31], v[84:87], v[68:71], v[16:31]
    ds_read_b128 v[64:67], v11 offset:0
    ds_read_b64_tr_b16 v[72:73], v13 offset:12288
    ds_read_b64_tr_b16 v[74:75], v13 offset:13824
    s_add_u32 m0, s27, 51200
    s_add_u32 s28, s25, 1105920
    buffer_load_dwordx4 v8, s[12:15], s28 offen lds
    s_waitcnt lgkmcnt(5)
    v_mfma_f32_32x32x16_bf16 v[32:47], v[88:91], v[68:71], v[32:47]
    ds_read_b64_tr_b16 v[76:77], v14 offset:12288
    ds_read_b64_tr_b16 v[78:79], v14 offset:13824
    ds_read_b64_tr_b16 v[80:81], v15 offset:12288
    s_waitcnt lgkmcnt(6)
    v_mfma_f32_32x32x16_bf16 v[48:63], v[92:95], v[68:71], v[48:63]
    ds_read_b64_tr_b16 v[82:83], v15 offset:13824
    s_waitcnt lgkmcnt(4)
    v_mfma_f32_32x32x16_bf16 v[16:31], v[72:75], v[64:67], v[16:31]
    ds_read_b128 v[68:71], v12 offset:0
    ds_read_b64_tr_b16 v[84:85], v13 offset:18432
    ds_read_b64_tr_b16 v[86:87], v13 offset:19968
    s_waitcnt lgkmcnt(5)
    v_mfma_f32_32x32x16_bf16 v[32:47], v[76:79], v[64:67], v[32:47]
    ds_read_b64_tr_b16 v[88:89], v14 offset:18432
    ds_read_b64_tr_b16 v[90:91], v14 offset:19968
    ds_read_b64_tr_b16 v[92:93], v15 offset:18432
    s_waitcnt lgkmcnt(6)
    v_mfma_f32_32x32x16_bf16 v[48:63], v[80:83], v[64:67], v[48:63]
    ds_read_b64_tr_b16 v[94:95], v15 offset:19968
    s_waitcnt vmcnt(5)
    s_waitcnt lgkmcnt(0)
    s_barrier
    ds_read_b128 v[64:67], v9 offset:16384
    ds_read_b64_tr_b16 v[72:73], v13 offset:24576
    ds_read_b64_tr_b16 v[74:75], v13 offset:26112
    ds_read_b64_tr_b16 v[76:77], v14 offset:24576
    ds_read_b64_tr_b16 v[78:79], v14 offset:26112
    ds_read_b64_tr_b16 v[80:81], v15 offset:24576
    ds_read_b64_tr_b16 v[82:83], v15 offset:26112
    v_mfma_f32_32x32x16_bf16 v[16:31], v[84:87], v[68:71], v[16:31]
    s_add_u32 m0, s48, 0
    s_add_u32 s28, s24, 768
    buffer_load_dwordx4 v4, s[8:11], s28 offen lds
    v_mfma_f32_32x32x16_bf16 v[32:47], v[88:91], v[68:71], v[32:47]
    s_add_u32 m0, s48, 1024
    s_add_u32 s28, s24, 9984
    buffer_load_dwordx4 v5, s[8:11], s28 offen lds
    v_mfma_f32_32x32x16_bf16 v[48:63], v[92:95], v[68:71], v[48:63]
    s_add_u32 m0, s27, 0
    s_add_u32 s28, s25, 1327104
    buffer_load_dwordx4 v6, s[12:15], s28 offen lds
    s_waitcnt lgkmcnt(4)
    v_mfma_f32_32x32x16_bf16 v[16:31], v[72:75], v[64:67], v[16:31]
    ds_read_b128 v[68:71], v10 offset:16384
    ds_read_b64_tr_b16 v[84:85], v13 offset:30720
    ds_read_b64_tr_b16 v[86:87], v13 offset:32256
    s_add_u32 m0, s27, 1024
    s_add_u32 s28, s25, 1327104
    buffer_load_dwordx4 v7, s[12:15], s28 offen lds
    s_waitcnt lgkmcnt(5)
    v_mfma_f32_32x32x16_bf16 v[32:47], v[76:79], v[64:67], v[32:47]
    ds_read_b64_tr_b16 v[88:89], v14 offset:30720
    ds_read_b64_tr_b16 v[90:91], v14 offset:32256
    ds_read_b64_tr_b16 v[92:93], v15 offset:30720
    s_waitcnt lgkmcnt(6)
    v_mfma_f32_32x32x16_bf16 v[48:63], v[80:83], v[64:67], v[48:63]
    ds_read_b64_tr_b16 v[94:95], v15 offset:32256
    s_waitcnt lgkmcnt(4)
    v_mfma_f32_32x32x16_bf16 v[16:31], v[84:87], v[68:71], v[16:31]
    ds_read_b128 v[64:67], v11 offset:16384
    ds_read_b64_tr_b16 v[72:73], v13 offset:36864
    ds_read_b64_tr_b16 v[74:75], v13 offset:38400
    s_add_u32 m0, s27, 2048
    s_add_u32 s28, s25, 1327104
    buffer_load_dwordx4 v8, s[12:15], s28 offen lds
    s_waitcnt lgkmcnt(5)
    v_mfma_f32_32x32x16_bf16 v[32:47], v[88:91], v[68:71], v[32:47]
    ds_read_b64_tr_b16 v[76:77], v14 offset:36864
    ds_read_b64_tr_b16 v[78:79], v14 offset:38400
    ds_read_b64_tr_b16 v[80:81], v15 offset:36864
    s_waitcnt lgkmcnt(6)
    v_mfma_f32_32x32x16_bf16 v[48:63], v[92:95], v[68:71], v[48:63]
    ds_read_b64_tr_b16 v[82:83], v15 offset:38400
    s_waitcnt lgkmcnt(4)
    v_mfma_f32_32x32x16_bf16 v[16:31], v[72:75], v[64:67], v[16:31]
    ds_read_b128 v[68:71], v12 offset:16384
    ds_read_b64_tr_b16 v[84:85], v13 offset:43008
    ds_read_b64_tr_b16 v[86:87], v13 offset:44544
    s_waitcnt lgkmcnt(5)
    v_mfma_f32_32x32x16_bf16 v[32:47], v[76:79], v[64:67], v[32:47]
    ds_read_b64_tr_b16 v[88:89], v14 offset:43008
    ds_read_b64_tr_b16 v[90:91], v14 offset:44544
    ds_read_b64_tr_b16 v[92:93], v15 offset:43008
    s_waitcnt lgkmcnt(6)
    v_mfma_f32_32x32x16_bf16 v[48:63], v[80:83], v[64:67], v[48:63]
    ds_read_b64_tr_b16 v[94:95], v15 offset:44544
    s_waitcnt vmcnt(5)
    s_waitcnt lgkmcnt(0)
    s_barrier
    ds_read_b128 v[64:67], v9 offset:32768
    ds_read_b64_tr_b16 v[72:73], v96 offset:0
    ds_read_b64_tr_b16 v[74:75], v96 offset:1536
    ds_read_b64_tr_b16 v[76:77], v97 offset:0
    ds_read_b64_tr_b16 v[78:79], v97 offset:1536
    ds_read_b64_tr_b16 v[80:81], v98 offset:0
    ds_read_b64_tr_b16 v[82:83], v98 offset:1536
    v_mfma_f32_32x32x16_bf16 v[16:31], v[84:87], v[68:71], v[16:31]
    s_add_u32 m0, s48, 16384
    s_add_u32 s28, s24, 896
    buffer_load_dwordx4 v4, s[8:11], s28 offen lds
    v_mfma_f32_32x32x16_bf16 v[32:47], v[88:91], v[68:71], v[32:47]
    s_add_u32 m0, s48, 17408
    s_add_u32 s28, s24, 10112
    buffer_load_dwordx4 v5, s[8:11], s28 offen lds
    v_mfma_f32_32x32x16_bf16 v[48:63], v[92:95], v[68:71], v[48:63]
    s_add_u32 m0, s27, 24576
    s_add_u32 s28, s25, 1548288
    buffer_load_dwordx4 v6, s[12:15], s28 offen lds
    s_waitcnt lgkmcnt(4)
    v_mfma_f32_32x32x16_bf16 v[16:31], v[72:75], v[64:67], v[16:31]
    ds_read_b128 v[68:71], v10 offset:32768
    ds_read_b64_tr_b16 v[84:85], v96 offset:6144
    ds_read_b64_tr_b16 v[86:87], v96 offset:7680
    s_add_u32 m0, s27, 25600
    s_add_u32 s28, s25, 1548288
    buffer_load_dwordx4 v7, s[12:15], s28 offen lds
    s_waitcnt lgkmcnt(5)
    v_mfma_f32_32x32x16_bf16 v[32:47], v[76:79], v[64:67], v[32:47]
    ds_read_b64_tr_b16 v[88:89], v97 offset:6144
    ds_read_b64_tr_b16 v[90:91], v97 offset:7680
    ds_read_b64_tr_b16 v[92:93], v98 offset:6144
    s_waitcnt lgkmcnt(6)
    v_mfma_f32_32x32x16_bf16 v[48:63], v[80:83], v[64:67], v[48:63]
    ds_read_b64_tr_b16 v[94:95], v98 offset:7680
    s_waitcnt lgkmcnt(4)
    v_mfma_f32_32x32x16_bf16 v[16:31], v[84:87], v[68:71], v[16:31]
    ds_read_b128 v[64:67], v11 offset:32768
    ds_read_b64_tr_b16 v[72:73], v96 offset:12288
    ds_read_b64_tr_b16 v[74:75], v96 offset:13824
    s_add_u32 m0, s27, 26624
    s_add_u32 s28, s25, 1548288
    buffer_load_dwordx4 v8, s[12:15], s28 offen lds
    s_waitcnt lgkmcnt(5)
    v_mfma_f32_32x32x16_bf16 v[32:47], v[88:91], v[68:71], v[32:47]
    ds_read_b64_tr_b16 v[76:77], v97 offset:12288
    ds_read_b64_tr_b16 v[78:79], v97 offset:13824
    ds_read_b64_tr_b16 v[80:81], v98 offset:12288
    s_waitcnt lgkmcnt(6)
    v_mfma_f32_32x32x16_bf16 v[48:63], v[92:95], v[68:71], v[48:63]
    ds_read_b64_tr_b16 v[82:83], v98 offset:13824
    s_waitcnt lgkmcnt(4)
    v_mfma_f32_32x32x16_bf16 v[16:31], v[72:75], v[64:67], v[16:31]
    ds_read_b128 v[68:71], v12 offset:32768
    ds_read_b64_tr_b16 v[84:85], v96 offset:18432
    ds_read_b64_tr_b16 v[86:87], v96 offset:19968
    s_waitcnt lgkmcnt(5)
    v_mfma_f32_32x32x16_bf16 v[32:47], v[76:79], v[64:67], v[32:47]
    ds_read_b64_tr_b16 v[88:89], v97 offset:18432
    ds_read_b64_tr_b16 v[90:91], v97 offset:19968
    ds_read_b64_tr_b16 v[92:93], v98 offset:18432
    s_waitcnt lgkmcnt(6)
    v_mfma_f32_32x32x16_bf16 v[48:63], v[80:83], v[64:67], v[48:63]
    ds_read_b64_tr_b16 v[94:95], v98 offset:19968
    s_waitcnt vmcnt(5)
    s_waitcnt lgkmcnt(0)
    s_barrier
    ds_read_b128 v[64:67], v9 offset:0
    ds_read_b64_tr_b16 v[72:73], v13 offset:0
    ds_read_b64_tr_b16 v[74:75], v13 offset:1536
    ds_read_b64_tr_b16 v[76:77], v14 offset:0
    ds_read_b64_tr_b16 v[78:79], v14 offset:1536
    ds_read_b64_tr_b16 v[80:81], v15 offset:0
    ds_read_b64_tr_b16 v[82:83], v15 offset:1536
    v_mfma_f32_32x32x16_bf16 v[16:31], v[84:87], v[68:71], v[16:31]
    s_add_u32 m0, s48, 32768
    s_add_u32 s28, s24, 1024
    buffer_load_dwordx4 v4, s[8:11], s28 offen lds
    v_mfma_f32_32x32x16_bf16 v[32:47], v[88:91], v[68:71], v[32:47]
    s_add_u32 m0, s48, 33792
    s_add_u32 s28, s24, 10240
    buffer_load_dwordx4 v5, s[8:11], s28 offen lds
    v_mfma_f32_32x32x16_bf16 v[48:63], v[92:95], v[68:71], v[48:63]
    s_add_u32 m0, s27, 49152
    s_add_u32 s28, s25, 1769472
    buffer_load_dwordx4 v6, s[12:15], s28 offen lds
    s_waitcnt lgkmcnt(4)
    v_mfma_f32_32x32x16_bf16 v[16:31], v[72:75], v[64:67], v[16:31]
    ds_read_b128 v[68:71], v10 offset:0
    ds_read_b64_tr_b16 v[84:85], v13 offset:6144
    ds_read_b64_tr_b16 v[86:87], v13 offset:7680
    s_add_u32 m0, s27, 50176
    s_add_u32 s28, s25, 1769472
    buffer_load_dwordx4 v7, s[12:15], s28 offen lds
    s_waitcnt lgkmcnt(5)
    v_mfma_f32_32x32x16_bf16 v[32:47], v[76:79], v[64:67], v[32:47]
    ds_read_b64_tr_b16 v[88:89], v14 offset:6144
    ds_read_b64_tr_b16 v[90:91], v14 offset:7680
    ds_read_b64_tr_b16 v[92:93], v15 offset:6144
    s_waitcnt lgkmcnt(6)
    v_mfma_f32_32x32x16_bf16 v[48:63], v[80:83], v[64:67], v[48:63]
    ds_read_b64_tr_b16 v[94:95], v15 offset:7680
    s_waitcnt lgkmcnt(4)
    v_mfma_f32_32x32x16_bf16 v[16:31], v[84:87], v[68:71], v[16:31]
    ds_read_b128 v[64:67], v11 offset:0
    ds_read_b64_tr_b16 v[72:73], v13 offset:12288
    ds_read_b64_tr_b16 v[74:75], v13 offset:13824
    s_add_u32 m0, s27, 51200
    s_add_u32 s28, s25, 1769472
    buffer_load_dwordx4 v8, s[12:15], s28 offen lds
    s_waitcnt lgkmcnt(5)
    v_mfma_f32_32x32x16_bf16 v[32:47], v[88:91], v[68:71], v[32:47]
    ds_read_b64_tr_b16 v[76:77], v14 offset:12288
    ds_read_b64_tr_b16 v[78:79], v14 offset:13824
    ds_read_b64_tr_b16 v[80:81], v15 offset:12288
    s_waitcnt lgkmcnt(6)
    v_mfma_f32_32x32x16_bf16 v[48:63], v[92:95], v[68:71], v[48:63]
    ds_read_b64_tr_b16 v[82:83], v15 offset:13824
    s_waitcnt lgkmcnt(4)
    v_mfma_f32_32x32x16_bf16 v[16:31], v[72:75], v[64:67], v[16:31]
    ds_read_b128 v[68:71], v12 offset:0
    ds_read_b64_tr_b16 v[84:85], v13 offset:18432
    ds_read_b64_tr_b16 v[86:87], v13 offset:19968
    s_waitcnt lgkmcnt(5)
    v_mfma_f32_32x32x16_bf16 v[32:47], v[76:79], v[64:67], v[32:47]
    ds_read_b64_tr_b16 v[88:89], v14 offset:18432
    ds_read_b64_tr_b16 v[90:91], v14 offset:19968
    ds_read_b64_tr_b16 v[92:93], v15 offset:18432
    s_waitcnt lgkmcnt(6)
    v_mfma_f32_32x32x16_bf16 v[48:63], v[80:83], v[64:67], v[48:63]
    ds_read_b64_tr_b16 v[94:95], v15 offset:19968
    s_waitcnt vmcnt(5)
    s_waitcnt lgkmcnt(0)
    s_barrier
    ds_read_b128 v[64:67], v9 offset:16384
    ds_read_b64_tr_b16 v[72:73], v13 offset:24576
    ds_read_b64_tr_b16 v[74:75], v13 offset:26112
    ds_read_b64_tr_b16 v[76:77], v14 offset:24576
    ds_read_b64_tr_b16 v[78:79], v14 offset:26112
    ds_read_b64_tr_b16 v[80:81], v15 offset:24576
    ds_read_b64_tr_b16 v[82:83], v15 offset:26112
    v_mfma_f32_32x32x16_bf16 v[16:31], v[84:87], v[68:71], v[16:31]
    v_mfma_f32_32x32x16_bf16 v[32:47], v[88:91], v[68:71], v[32:47]
    v_mfma_f32_32x32x16_bf16 v[48:63], v[92:95], v[68:71], v[48:63]
    s_waitcnt lgkmcnt(4)
    v_mfma_f32_32x32x16_bf16 v[16:31], v[72:75], v[64:67], v[16:31]
    ds_read_b128 v[68:71], v10 offset:16384
    ds_read_b64_tr_b16 v[84:85], v13 offset:30720
    ds_read_b64_tr_b16 v[86:87], v13 offset:32256
    s_waitcnt lgkmcnt(5)
    v_mfma_f32_32x32x16_bf16 v[32:47], v[76:79], v[64:67], v[32:47]
    ds_read_b64_tr_b16 v[88:89], v14 offset:30720
    ds_read_b64_tr_b16 v[90:91], v14 offset:32256
    ds_read_b64_tr_b16 v[92:93], v15 offset:30720
    s_waitcnt lgkmcnt(6)
    v_mfma_f32_32x32x16_bf16 v[48:63], v[80:83], v[64:67], v[48:63]
    ds_read_b64_tr_b16 v[94:95], v15 offset:32256
    s_waitcnt lgkmcnt(4)
    v_mfma_f32_32x32x16_bf16 v[16:31], v[84:87], v[68:71], v[16:31]
    ds_read_b128 v[64:67], v11 offset:16384
    ds_read_b64_tr_b16 v[72:73], v13 offset:36864
    ds_read_b64_tr_b16 v[74:75], v13 offset:38400
    s_waitcnt lgkmcnt(5)
    v_mfma_f32_32x32x16_bf16 v[32:47], v[88:91], v[68:71], v[32:47]
    ds_read_b64_tr_b16 v[76:77], v14 offset:36864
    ds_read_b64_tr_b16 v[78:79], v14 offset:38400
    ds_read_b64_tr_b16 v[80:81], v15 offset:36864
    s_waitcnt lgkmcnt(6)
    v_mfma_f32_32x32x16_bf16 v[48:63], v[92:95], v[68:71], v[48:63]
    ds_read_b64_tr_b16 v[82:83], v15 offset:38400
    s_waitcnt lgkmcnt(4)
    v_mfma_f32_32x32x16_bf16 v[16:31], v[72:75], v[64:67], v[16:31]
    ds_read_b128 v[68:71], v12 offset:16384
    ds_read_b64_tr_b16 v[84:85], v13 offset:43008
    ds_read_b64_tr_b16 v[86:87], v13 offset:44544
    s_waitcnt lgkmcnt(5)
    v_mfma_f32_32x32x16_bf16 v[32:47], v[76:79], v[64:67], v[32:47]
    ds_read_b64_tr_b16 v[88:89], v14 offset:43008
    ds_read_b64_tr_b16 v[90:91], v14 offset:44544
    ds_read_b64_tr_b16 v[92:93], v15 offset:43008
    s_waitcnt lgkmcnt(6)
    v_mfma_f32_32x32x16_bf16 v[48:63], v[80:83], v[64:67], v[48:63]
    ds_read_b64_tr_b16 v[94:95], v15 offset:44544
    s_waitcnt vmcnt(0)
    s_waitcnt lgkmcnt(0)
    s_barrier
    ds_read_b128 v[64:67], v9 offset:32768
    ds_read_b64_tr_b16 v[72:73], v96 offset:0
    ds_read_b64_tr_b16 v[74:75], v96 offset:1536
    ds_read_b64_tr_b16 v[76:77], v97 offset:0
    ds_read_b64_tr_b16 v[78:79], v97 offset:1536
    ds_read_b64_tr_b16 v[80:81], v98 offset:0
    ds_read_b64_tr_b16 v[82:83], v98 offset:1536
    v_mfma_f32_32x32x16_bf16 v[16:31], v[84:87], v[68:71], v[16:31]
    v_mfma_f32_32x32x16_bf16 v[32:47], v[88:91], v[68:71], v[32:47]
    v_mfma_f32_32x32x16_bf16 v[48:63], v[92:95], v[68:71], v[48:63]
    s_waitcnt lgkmcnt(4)
    v_mfma_f32_32x32x16_bf16 v[16:31], v[72:75], v[64:67], v[16:31]
    ds_read_b128 v[68:71], v10 offset:32768
    ds_read_b64_tr_b16 v[84:85], v96 offset:6144
    ds_read_b64_tr_b16 v[86:87], v96 offset:7680
    s_waitcnt lgkmcnt(5)
    v_mfma_f32_32x32x16_bf16 v[32:47], v[76:79], v[64:67], v[32:47]
    ds_read_b64_tr_b16 v[88:89], v97 offset:6144
    ds_read_b64_tr_b16 v[90:91], v97 offset:7680
    ds_read_b64_tr_b16 v[92:93], v98 offset:6144
    s_waitcnt lgkmcnt(6)
    v_mfma_f32_32x32x16_bf16 v[48:63], v[80:83], v[64:67], v[48:63]
    ds_read_b64_tr_b16 v[94:95], v98 offset:7680
    s_waitcnt lgkmcnt(4)
    v_mfma_f32_32x32x16_bf16 v[16:31], v[84:87], v[68:71], v[16:31]
    ds_read_b128 v[64:67], v11 offset:32768
    ds_read_b64_tr_b16 v[72:73], v96 offset:12288
    ds_read_b64_tr_b16 v[74:75], v96 offset:13824
    s_waitcnt lgkmcnt(5)
    v_mfma_f32_32x32x16_bf16 v[32:47], v[88:91], v[68:71], v[32:47]
    ds_read_b64_tr_b16 v[76:77], v97 offset:12288
    ds_read_b64_tr_b16 v[78:79], v97 offset:13824
    ds_read_b64_tr_b16 v[80:81], v98 offset:12288
    s_waitcnt lgkmcnt(6)
    v_mfma_f32_32x32x16_bf16 v[48:63], v[92:95], v[68:71], v[48:63]
    ds_read_b64_tr_b16 v[82:83], v98 offset:13824
    s_waitcnt lgkmcnt(4)
    v_mfma_f32_32x32x16_bf16 v[16:31], v[72:75], v[64:67], v[16:31]
    ds_read_b128 v[68:71], v12 offset:32768
    ds_read_b64_tr_b16 v[84:85], v96 offset:18432
    ds_read_b64_tr_b16 v[86:87], v96 offset:19968
    s_waitcnt lgkmcnt(5)
    v_mfma_f32_32x32x16_bf16 v[32:47], v[76:79], v[64:67], v[32:47]
    ds_read_b64_tr_b16 v[88:89], v97 offset:18432
    ds_read_b64_tr_b16 v[90:91], v97 offset:19968
    ds_read_b64_tr_b16 v[92:93], v98 offset:18432
    s_waitcnt lgkmcnt(6)
    v_mfma_f32_32x32x16_bf16 v[48:63], v[80:83], v[64:67], v[48:63]
    ds_read_b64_tr_b16 v[94:95], v98 offset:19968
    s_waitcnt lgkmcnt(4)
    v_mfma_f32_32x32x16_bf16 v[16:31], v[84:87], v[68:71], v[16:31]
    s_waitcnt lgkmcnt(2)
    v_mfma_f32_32x32x16_bf16 v[32:47], v[88:91], v[68:71], v[32:47]
    s_waitcnt lgkmcnt(0)
    v_mfma_f32_32x32x16_bf16 v[48:63], v[92:95], v[68:71], v[48:63]
    s_lshl_b32 s30, s21, 2
    s_add_u32 s30, s30, s20
    s_lshr_b32 s31, s30, 3
    s_and_b32 s32, s30, 7
    s_cmp_eq_u32 s22, 0
    s_cselect_b32 s33, 1051597459, 1.0
    s_mov_b32 s34, 155648
    s_cselect_b32 s35, 8192, s34
    s_cselect_b32 s34, 65536, s34
    s_mul_i32 s36, s31, 19456
    s_lshl_b32 s37, s32, 10
    s_add_u32 s37, s37, s36
    s_lshr_b32 s38, s32, 2
    s_lshl_b32 s38, s38, 9
    s_and_b32 s39, s32, 3
    s_lshl_b32 s39, s39, 2
    s_add_u32 s38, s38, s39
    s_add_u32 s38, s38, s36
    s_add_u32 s38, s38, 8192
    s_lshl_b32 s39, s30, 10
    s_add_u32 s39, s39, 5242880
    s_lshl_b32 s40, s30, 7
    s_add_u32 s40, s40, 7340032
    s_cmp_eq_u32 s22, 0
    s_cselect_b32 s37, s39, s37
    s_cselect_b32 s38, s40, s38
    s_lshl_b32 s41, s23, 3
    s_mul_i32 s42, s41, s35
    s_add_u32 s38, s38, s42
    s_add_u32 s41, s41, 0
    s_mul_i32 s42, s41, s34
    s_add_u32 s37, s37, s42
    v_lshlrev_b32 v100, 4, v2
    v_and_b32 v101, 31, v2
    s_cmp_eq_u32 s22, 0
    s_cselect_b32 s39, 2, 4
    v_lshlrev_b32 v101, s39, v101
    v_lshrrev_b32 v102, 5, v2
    v_mul_lo_u32 v102, v102, s35
    v_add_u32 v101, v101, v102
    v_mul_f32 v16, s33, v16
    v_mul_f32 v17, s33, v17
    v_mul_f32 v18, s33, v18
    v_mul_f32 v19, s33, v19
    v_mul_f32 v20, s33, v20
    v_mul_f32 v21, s33, v21
    v_mul_f32 v22, s33, v22
    v_mul_f32 v23, s33, v23
    v_cvt_pk_bf16_f32 v64, v16, v17
    v_cvt_pk_bf16_f32 v65, v18, v19
    v_cvt_pk_bf16_f32 v66, v20, v21
    v_cvt_pk_bf16_f32 v67, v22, v23
    buffer_store_dwordx4 v[64:67], v100, s[16:19], s37 offen
    s_add_u32 s37, s37, s34
    v_mul_f32 v24, s33, v24
    v_mul_f32 v25, s33, v25
    v_mul_f32 v26, s33, v26
    v_mul_f32 v27, s33, v27
    v_mul_f32 v28, s33, v28
    v_mul_f32 v29, s33, v29
    v_mul_f32 v30, s33, v30
    v_mul_f32 v31, s33, v31
    v_cvt_pk_bf16_f32 v72, v24, v25
    v_cvt_pk_bf16_f32 v73, v26, v27
    v_cvt_pk_bf16_f32 v74, v28, v29
    v_cvt_pk_bf16_f32 v75, v30, v31
    buffer_store_dwordx4 v[72:75], v100, s[16:19], s37 offen
    s_add_u32 s37, s37, s34
    v_mul_f32 v32, s33, v32
    v_mul_f32 v33, s33, v33
    v_mul_f32 v34, s33, v34
    v_mul_f32 v35, s33, v35
    v_mul_f32 v36, s33, v36
    v_mul_f32 v37, s33, v37
    v_mul_f32 v38, s33, v38
    v_mul_f32 v39, s33, v39
    v_cvt_pk_bf16_f32 v64, v32, v33
    v_cvt_pk_bf16_f32 v65, v34, v35
    v_cvt_pk_bf16_f32 v66, v36, v37
    v_cvt_pk_bf16_f32 v67, v38, v39
    buffer_store_dwordx4 v[64:67], v100, s[16:19], s37 offen
    s_add_u32 s37, s37, s34
    v_mul_f32 v40, s33, v40
    v_mul_f32 v41, s33, v41
    v_mul_f32 v42, s33, v42
    v_mul_f32 v43, s33, v43
    v_mul_f32 v44, s33, v44
    v_mul_f32 v45, s33, v45
    v_mul_f32 v46, s33, v46
    v_mul_f32 v47, s33, v47
    v_cvt_pk_bf16_f32 v72, v40, v41
    v_cvt_pk_bf16_f32 v73, v42, v43
    v_cvt_pk_bf16_f32 v74, v44, v45
    v_cvt_pk_bf16_f32 v75, v46, v47
    buffer_store_dwordx4 v[72:75], v100, s[16:19], s37 offen
    s_add_u32 s37, s37, s34
    v_mul_f32 v48, s33, v48
    v_mul_f32 v49, s33, v49
    v_mul_f32 v50, s33, v50
    v_mul_f32 v51, s33, v51
    v_mul_f32 v52, s33, v52
    v_mul_f32 v53, s33, v53
    v_mul_f32 v54, s33, v54
    v_mul_f32 v55, s33, v55
    v_cvt_pk_bf16_f32 v64, v48, v49
    v_cvt_pk_bf16_f32 v65, v50, v51
    v_cvt_pk_bf16_f32 v66, v52, v53
    v_cvt_pk_bf16_f32 v67, v54, v55
    buffer_store_dwordx4 v[64:67], v100, s[16:19], s37 offen
    s_add_u32 s37, s37, s34
    v_mul_f32 v56, s33, v56
    v_mul_f32 v57, s33, v57
    v_mul_f32 v58, s33, v58
    v_mul_f32 v59, s33, v59
    v_mul_f32 v60, s33, v60
    v_mul_f32 v61, s33, v61
    v_mul_f32 v62, s33, v62
    v_mul_f32 v63, s33, v63
    v_cvt_pk_bf16_f32 v72, v56, v57
    v_cvt_pk_bf16_f32 v73, v58, v59
    v_cvt_pk_bf16_f32 v74, v60, v61
    v_cvt_pk_bf16_f32 v75, v62, v63
    buffer_store_dwordx4 v[72:75], v100, s[16:19], s37 offen
    s_add_u32 s37, s37, s34
    s_branch L_k1_kernel_end_7
L_k1_kernel_v_9:
    s_waitcnt vmcnt(5)
    s_waitcnt lgkmcnt(0)
    s_barrier
    ds_read_b128 v[64:67], v9 offset:0
    ds_read_b64_tr_b16 v[72:73], v13 offset:0
    ds_read_b64_tr_b16 v[74:75], v13 offset:1536
    ds_read_b64_tr_b16 v[76:77], v14 offset:0
    ds_read_b64_tr_b16 v[78:79], v14 offset:1536
    ds_read_b64_tr_b16 v[80:81], v15 offset:0
    ds_read_b64_tr_b16 v[82:83], v15 offset:1536
    s_waitcnt lgkmcnt(4)
    v_mfma_f32_32x32x16_bf16 v[16:31], v[64:67], v[72:75], 0
    ds_read_b128 v[68:71], v10 offset:0
    ds_read_b64_tr_b16 v[84:85], v13 offset:6144
    ds_read_b64_tr_b16 v[86:87], v13 offset:7680
    s_add_u32 m0, s48, 32768
    s_add_u32 s28, s24, 256
    buffer_load_dwordx4 v4, s[8:11], s28 offen lds
    s_waitcnt lgkmcnt(5)
    v_mfma_f32_32x32x16_bf16 v[32:47], v[64:67], v[76:79], 0
    ds_read_b64_tr_b16 v[88:89], v14 offset:6144
    ds_read_b64_tr_b16 v[90:91], v14 offset:7680
    ds_read_b64_tr_b16 v[92:93], v15 offset:6144
    s_waitcnt lgkmcnt(6)
    v_mfma_f32_32x32x16_bf16 v[48:63], v[64:67], v[80:83], 0
    ds_read_b64_tr_b16 v[94:95], v15 offset:7680
    s_waitcnt lgkmcnt(4)
    v_mfma_f32_32x32x16_bf16 v[16:31], v[68:71], v[84:87], v[16:31]
    ds_read_b128 v[64:67], v11 offset:0
    ds_read_b64_tr_b16 v[72:73], v13 offset:12288
    ds_read_b64_tr_b16 v[74:75], v13 offset:13824
    s_add_u32 m0, s48, 33792
    s_add_u32 s28, s24, 9472
    buffer_load_dwordx4 v5, s[8:11], s28 offen lds
    s_waitcnt lgkmcnt(5)
    v_mfma_f32_32x32x16_bf16 v[32:47], v[68:71], v[88:91], v[32:47]
    ds_read_b64_tr_b16 v[76:77], v14 offset:12288
    ds_read_b64_tr_b16 v[78:79], v14 offset:13824
    ds_read_b64_tr_b16 v[80:81], v15 offset:12288
    s_waitcnt lgkmcnt(6)
    v_mfma_f32_32x32x16_bf16 v[48:63], v[68:71], v[92:95], v[48:63]
    ds_read_b64_tr_b16 v[82:83], v15 offset:13824
    s_waitcnt lgkmcnt(4)
    v_mfma_f32_32x32x16_bf16 v[16:31], v[64:67], v[72:75], v[16:31]
    ds_read_b128 v[68:71], v12 offset:0
    ds_read_b64_tr_b16 v[84:85], v13 offset:18432
    ds_read_b64_tr_b16 v[86:87], v13 offset:19968
    s_add_u32 m0, s27, 49152
    s_add_u32 s28, s25, 442368
    buffer_load_dwordx4 v6, s[12:15], s28 offen lds
    s_waitcnt lgkmcnt(5)
    v_mfma_f32_32x32x16_bf16 v[32:47], v[64:67], v[76:79], v[32:47]
    ds_read_b64_tr_b16 v[88:89], v14 offset:18432
    ds_read_b64_tr_b16 v[90:91], v14 offset:19968
    ds_read_b64_tr_b16 v[92:93], v15 offset:18432
    s_waitcnt lgkmcnt(6)
    v_mfma_f32_32x32x16_bf16 v[48:63], v[64:67], v[80:83], v[48:63]
    ds_read_b64_tr_b16 v[94:95], v15 offset:19968
    s_add_u32 m0, s27, 50176
    s_add_u32 s28, s25, 442368
    buffer_load_dwordx4 v7, s[12:15], s28 offen lds
    s_add_u32 m0, s27, 51200
    s_add_u32 s28, s25, 442368
    buffer_load_dwordx4 v8, s[12:15], s28 offen lds
    s_waitcnt vmcnt(5)
    s_waitcnt lgkmcnt(0)
    s_barrier
    ds_read_b128 v[64:67], v9 offset:16384
    ds_read_b64_tr_b16 v[72:73], v13 offset:24576
    ds_read_b64_tr_b16 v[74:75], v13 offset:26112
    ds_read_b64_tr_b16 v[76:77], v14 offset:24576
    ds_read_b64_tr_b16 v[78:79], v14 offset:26112
    ds_read_b64_tr_b16 v[80:81], v15 offset:24576
    ds_read_b64_tr_b16 v[82:83], v15 offset:26112
    v_mfma_f32_32x32x16_bf16 v[16:31], v[68:71], v[84:87], v[16:31]
    s_add_u32 m0, s48, 0
    s_add_u32 s28, s24, 384
    buffer_load_dwordx4 v4, s[8:11], s28 offen lds
    v_mfma_f32_32x32x16_bf16 v[32:47], v[68:71], v[88:91], v[32:47]
    s_add_u32 m0, s48, 1024
    s_add_u32 s28, s24, 9600
    buffer_load_dwordx4 v5, s[8:11], s28 offen lds
    v_mfma_f32_32x32x16_bf16 v[48:63], v[68:71], v[92:95], v[48:63]
    s_add_u32 m0, s27, 0
    s_add_u32 s28, s25, 663552
    buffer_load_dwordx4 v6, s[12:15], s28 offen lds
    s_waitcnt lgkmcnt(4)
    v_mfma_f32_32x32x16_bf16 v[16:31], v[64:67], v[72:75], v[16:31]
    ds_read_b128 v[68:71], v10 offset:16384
    ds_read_b64_tr_b16 v[84:85], v13 offset:30720
    ds_read_b64_tr_b16 v[86:87], v13 offset:32256
    s_add_u32 m0, s27, 1024
    s_add_u32 s28, s25, 663552
    buffer_load_dwordx4 v7, s[12:15], s28 offen lds
    s_waitcnt lgkmcnt(5)
    v_mfma_f32_32x32x16_bf16 v[32:47], v[64:67], v[76:79], v[32:47]
    ds_read_b64_tr_b16 v[88:89], v14 offset:30720
    ds_read_b64_tr_b16 v[90:91], v14 offset:32256
    ds_read_b64_tr_b16 v[92:93], v15 offset:30720
    s_waitcnt lgkmcnt(6)
    v_mfma_f32_32x32x16_bf16 v[48:63], v[64:67], v[80:83], v[48:63]
    ds_read_b64_tr_b16 v[94:95], v15 offset:32256
    s_waitcnt lgkmcnt(4)
    v_mfma_f32_32x32x16_bf16 v[16:31], v[68:71], v[84:87], v[16:31]
    ds_read_b128 v[64:67], v11 offset:16384
    ds_read_b64_tr_b16 v[72:73], v13 offset:36864
    ds_read_b64_tr_b16 v[74:75], v13 offset:38400
    s_add_u32 m0, s27, 2048
    s_add_u32 s28, s25, 663552
    buffer_load_dwordx4 v8, s[12:15], s28 offen lds
    s_waitcnt lgkmcnt(5)
    v_mfma_f32_32x32x16_bf16 v[32:47], v[68:71], v[88:91], v[32:47]
    ds_read_b64_tr_b16 v[76:77], v14 offset:36864
    ds_read_b64_tr_b16 v[78:79], v14 offset:38400
    ds_read_b64_tr_b16 v[80:81], v15 offset:36864
    s_waitcnt lgkmcnt(6)
    v_mfma_f32_32x32x16_bf16 v[48:63], v[68:71], v[92:95], v[48:63]
    ds_read_b64_tr_b16 v[82:83], v15 offset:38400
    s_waitcnt lgkmcnt(4)
    v_mfma_f32_32x32x16_bf16 v[16:31], v[64:67], v[72:75], v[16:31]
    ds_read_b128 v[68:71], v12 offset:16384
    ds_read_b64_tr_b16 v[84:85], v13 offset:43008
    ds_read_b64_tr_b16 v[86:87], v13 offset:44544
    s_waitcnt lgkmcnt(5)
    v_mfma_f32_32x32x16_bf16 v[32:47], v[64:67], v[76:79], v[32:47]
    ds_read_b64_tr_b16 v[88:89], v14 offset:43008
    ds_read_b64_tr_b16 v[90:91], v14 offset:44544
    ds_read_b64_tr_b16 v[92:93], v15 offset:43008
    s_waitcnt lgkmcnt(6)
    v_mfma_f32_32x32x16_bf16 v[48:63], v[64:67], v[80:83], v[48:63]
    ds_read_b64_tr_b16 v[94:95], v15 offset:44544
    s_waitcnt vmcnt(5)
    s_waitcnt lgkmcnt(0)
    s_barrier
    ds_read_b128 v[64:67], v9 offset:32768
    ds_read_b64_tr_b16 v[72:73], v96 offset:0
    ds_read_b64_tr_b16 v[74:75], v96 offset:1536
    ds_read_b64_tr_b16 v[76:77], v97 offset:0
    ds_read_b64_tr_b16 v[78:79], v97 offset:1536
    ds_read_b64_tr_b16 v[80:81], v98 offset:0
    ds_read_b64_tr_b16 v[82:83], v98 offset:1536
    v_mfma_f32_32x32x16_bf16 v[16:31], v[68:71], v[84:87], v[16:31]
    s_add_u32 m0, s48, 16384
    s_add_u32 s28, s24, 512
    buffer_load_dwordx4 v4, s[8:11], s28 offen lds
    v_mfma_f32_32x32x16_bf16 v[32:47], v[68:71], v[88:91], v[32:47]
    s_add_u32 m0, s48, 17408
    s_add_u32 s28, s24, 9728
    buffer_load_dwordx4 v5, s[8:11], s28 offen lds
    v_mfma_f32_32x32x16_bf16 v[48:63], v[68:71], v[92:95], v[48:63]
    s_add_u32 m0, s27, 24576
    s_add_u32 s28, s25, 884736
    buffer_load_dwordx4 v6, s[12:15], s28 offen lds
    s_waitcnt lgkmcnt(4)
    v_mfma_f32_32x32x16_bf16 v[16:31], v[64:67], v[72:75], v[16:31]
    ds_read_b128 v[68:71], v10 offset:32768
    ds_read_b64_tr_b16 v[84:85], v96 offset:6144
    ds_read_b64_tr_b16 v[86:87], v96 offset:7680
    s_add_u32 m0, s27, 25600
    s_add_u32 s28, s25, 884736
    buffer_load_dwordx4 v7, s[12:15], s28 offen lds
    s_waitcnt lgkmcnt(5)
    v_mfma_f32_32x32x16_bf16 v[32:47], v[64:67], v[76:79], v[32:47]
    ds_read_b64_tr_b16 v[88:89], v97 offset:6144
    ds_read_b64_tr_b16 v[90:91], v97 offset:7680
    ds_read_b64_tr_b16 v[92:93], v98 offset:6144
    s_waitcnt lgkmcnt(6)
    v_mfma_f32_32x32x16_bf16 v[48:63], v[64:67], v[80:83], v[48:63]
    ds_read_b64_tr_b16 v[94:95], v98 offset:7680
    s_waitcnt lgkmcnt(4)
    v_mfma_f32_32x32x16_bf16 v[16:31], v[68:71], v[84:87], v[16:31]
    ds_read_b128 v[64:67], v11 offset:32768
    ds_read_b64_tr_b16 v[72:73], v96 offset:12288
    ds_read_b64_tr_b16 v[74:75], v96 offset:13824
    s_add_u32 m0, s27, 26624
    s_add_u32 s28, s25, 884736
    buffer_load_dwordx4 v8, s[12:15], s28 offen lds
    s_waitcnt lgkmcnt(5)
    v_mfma_f32_32x32x16_bf16 v[32:47], v[68:71], v[88:91], v[32:47]
    ds_read_b64_tr_b16 v[76:77], v97 offset:12288
    ds_read_b64_tr_b16 v[78:79], v97 offset:13824
    ds_read_b64_tr_b16 v[80:81], v98 offset:12288
    s_waitcnt lgkmcnt(6)
    v_mfma_f32_32x32x16_bf16 v[48:63], v[68:71], v[92:95], v[48:63]
    ds_read_b64_tr_b16 v[82:83], v98 offset:13824
    s_waitcnt lgkmcnt(4)
    v_mfma_f32_32x32x16_bf16 v[16:31], v[64:67], v[72:75], v[16:31]
    ds_read_b128 v[68:71], v12 offset:32768
    ds_read_b64_tr_b16 v[84:85], v96 offset:18432
    ds_read_b64_tr_b16 v[86:87], v96 offset:19968
    s_waitcnt lgkmcnt(5)
    v_mfma_f32_32x32x16_bf16 v[32:47], v[64:67], v[76:79], v[32:47]
    ds_read_b64_tr_b16 v[88:89], v97 offset:18432
    ds_read_b64_tr_b16 v[90:91], v97 offset:19968
    ds_read_b64_tr_b16 v[92:93], v98 offset:18432
    s_waitcnt lgkmcnt(6)
    v_mfma_f32_32x32x16_bf16 v[48:63], v[64:67], v[80:83], v[48:63]
    ds_read_b64_tr_b16 v[94:95], v98 offset:19968
    s_waitcnt vmcnt(5)
    s_waitcnt lgkmcnt(0)
    s_barrier
    ds_read_b128 v[64:67], v9 offset:0
    ds_read_b64_tr_b16 v[72:73], v13 offset:0
    ds_read_b64_tr_b16 v[74:75], v13 offset:1536
    ds_read_b64_tr_b16 v[76:77], v14 offset:0
    ds_read_b64_tr_b16 v[78:79], v14 offset:1536
    ds_read_b64_tr_b16 v[80:81], v15 offset:0
    ds_read_b64_tr_b16 v[82:83], v15 offset:1536
    v_mfma_f32_32x32x16_bf16 v[16:31], v[68:71], v[84:87], v[16:31]
    s_add_u32 m0, s48, 32768
    s_add_u32 s28, s24, 640
    buffer_load_dwordx4 v4, s[8:11], s28 offen lds
    v_mfma_f32_32x32x16_bf16 v[32:47], v[68:71], v[88:91], v[32:47]
    s_add_u32 m0, s48, 33792
    s_add_u32 s28, s24, 9856
    buffer_load_dwordx4 v5, s[8:11], s28 offen lds
    v_mfma_f32_32x32x16_bf16 v[48:63], v[68:71], v[92:95], v[48:63]
    s_add_u32 m0, s27, 49152
    s_add_u32 s28, s25, 1105920
    buffer_load_dwordx4 v6, s[12:15], s28 offen lds
    s_waitcnt lgkmcnt(4)
    v_mfma_f32_32x32x16_bf16 v[16:31], v[64:67], v[72:75], v[16:31]
    ds_read_b128 v[68:71], v10 offset:0
    ds_read_b64_tr_b16 v[84:85], v13 offset:6144
    ds_read_b64_tr_b16 v[86:87], v13 offset:7680
    s_add_u32 m0, s27, 50176
    s_add_u32 s28, s25, 1105920
    buffer_load_dwordx4 v7, s[12:15], s28 offen lds
    s_waitcnt lgkmcnt(5)
    v_mfma_f32_32x32x16_bf16 v[32:47], v[64:67], v[76:79], v[32:47]
    ds_read_b64_tr_b16 v[88:89], v14 offset:6144
    ds_read_b64_tr_b16 v[90:91], v14 offset:7680
    ds_read_b64_tr_b16 v[92:93], v15 offset:6144
    s_waitcnt lgkmcnt(6)
    v_mfma_f32_32x32x16_bf16 v[48:63], v[64:67], v[80:83], v[48:63]
    ds_read_b64_tr_b16 v[94:95], v15 offset:7680
    s_waitcnt lgkmcnt(4)
    v_mfma_f32_32x32x16_bf16 v[16:31], v[68:71], v[84:87], v[16:31]
    ds_read_b128 v[64:67], v11 offset:0
    ds_read_b64_tr_b16 v[72:73], v13 offset:12288
    ds_read_b64_tr_b16 v[74:75], v13 offset:13824
    s_add_u32 m0, s27, 51200
    s_add_u32 s28, s25, 1105920
    buffer_load_dwordx4 v8, s[12:15], s28 offen lds
    s_waitcnt lgkmcnt(5)
    v_mfma_f32_32x32x16_bf16 v[32:47], v[68:71], v[88:91], v[32:47]
    ds_read_b64_tr_b16 v[76:77], v14 offset:12288
    ds_read_b64_tr_b16 v[78:79], v14 offset:13824
    ds_read_b64_tr_b16 v[80:81], v15 offset:12288
    s_waitcnt lgkmcnt(6)
    v_mfma_f32_32x32x16_bf16 v[48:63], v[68:71], v[92:95], v[48:63]
    ds_read_b64_tr_b16 v[82:83], v15 offset:13824
    s_waitcnt lgkmcnt(4)
    v_mfma_f32_32x32x16_bf16 v[16:31], v[64:67], v[72:75], v[16:31]
    ds_read_b128 v[68:71], v12 offset:0
    ds_read_b64_tr_b16 v[84:85], v13 offset:18432
    ds_read_b64_tr_b16 v[86:87], v13 offset:19968
    s_waitcnt lgkmcnt(5)
    v_mfma_f32_32x32x16_bf16 v[32:47], v[64:67], v[76:79], v[32:47]
    ds_read_b64_tr_b16 v[88:89], v14 offset:18432
    ds_read_b64_tr_b16 v[90:91], v14 offset:19968
    ds_read_b64_tr_b16 v[92:93], v15 offset:18432
    s_waitcnt lgkmcnt(6)
    v_mfma_f32_32x32x16_bf16 v[48:63], v[64:67], v[80:83], v[48:63]
    ds_read_b64_tr_b16 v[94:95], v15 offset:19968
    s_waitcnt vmcnt(5)
    s_waitcnt lgkmcnt(0)
    s_barrier
    ds_read_b128 v[64:67], v9 offset:16384
    ds_read_b64_tr_b16 v[72:73], v13 offset:24576
    ds_read_b64_tr_b16 v[74:75], v13 offset:26112
    ds_read_b64_tr_b16 v[76:77], v14 offset:24576
    ds_read_b64_tr_b16 v[78:79], v14 offset:26112
    ds_read_b64_tr_b16 v[80:81], v15 offset:24576
    ds_read_b64_tr_b16 v[82:83], v15 offset:26112
    v_mfma_f32_32x32x16_bf16 v[16:31], v[68:71], v[84:87], v[16:31]
    s_add_u32 m0, s48, 0
    s_add_u32 s28, s24, 768
    buffer_load_dwordx4 v4, s[8:11], s28 offen lds
    v_mfma_f32_32x32x16_bf16 v[32:47], v[68:71], v[88:91], v[32:47]
    s_add_u32 m0, s48, 1024
    s_add_u32 s28, s24, 9984
    buffer_load_dwordx4 v5, s[8:11], s28 offen lds
    v_mfma_f32_32x32x16_bf16 v[48:63], v[68:71], v[92:95], v[48:63]
    s_add_u32 m0, s27, 0
    s_add_u32 s28, s25, 1327104
    buffer_load_dwordx4 v6, s[12:15], s28 offen lds
    s_waitcnt lgkmcnt(4)
    v_mfma_f32_32x32x16_bf16 v[16:31], v[64:67], v[72:75], v[16:31]
    ds_read_b128 v[68:71], v10 offset:16384
    ds_read_b64_tr_b16 v[84:85], v13 offset:30720
    ds_read_b64_tr_b16 v[86:87], v13 offset:32256
    s_add_u32 m0, s27, 1024
    s_add_u32 s28, s25, 1327104
    buffer_load_dwordx4 v7, s[12:15], s28 offen lds
    s_waitcnt lgkmcnt(5)
    v_mfma_f32_32x32x16_bf16 v[32:47], v[64:67], v[76:79], v[32:47]
    ds_read_b64_tr_b16 v[88:89], v14 offset:30720
    ds_read_b64_tr_b16 v[90:91], v14 offset:32256
    ds_read_b64_tr_b16 v[92:93], v15 offset:30720
    s_waitcnt lgkmcnt(6)
    v_mfma_f32_32x32x16_bf16 v[48:63], v[64:67], v[80:83], v[48:63]
    ds_read_b64_tr_b16 v[94:95], v15 offset:32256
    s_waitcnt lgkmcnt(4)
    v_mfma_f32_32x32x16_bf16 v[16:31], v[68:71], v[84:87], v[16:31]
    ds_read_b128 v[64:67], v11 offset:16384
    ds_read_b64_tr_b16 v[72:73], v13 offset:36864
    ds_read_b64_tr_b16 v[74:75], v13 offset:38400
    s_add_u32 m0, s27, 2048
    s_add_u32 s28, s25, 1327104
    buffer_load_dwordx4 v8, s[12:15], s28 offen lds
    s_waitcnt lgkmcnt(5)
    v_mfma_f32_32x32x16_bf16 v[32:47], v[68:71], v[88:91], v[32:47]
    ds_read_b64_tr_b16 v[76:77], v14 offset:36864
    ds_read_b64_tr_b16 v[78:79], v14 offset:38400
    ds_read_b64_tr_b16 v[80:81], v15 offset:36864
    s_waitcnt lgkmcnt(6)
    v_mfma_f32_32x32x16_bf16 v[48:63], v[68:71], v[92:95], v[48:63]
    ds_read_b64_tr_b16 v[82:83], v15 offset:38400
    s_waitcnt lgkmcnt(4)
    v_mfma_f32_32x32x16_bf16 v[16:31], v[64:67], v[72:75], v[16:31]
    ds_read_b128 v[68:71], v12 offset:16384
    ds_read_b64_tr_b16 v[84:85], v13 offset:43008
    ds_read_b64_tr_b16 v[86:87], v13 offset:44544
    s_waitcnt lgkmcnt(5)
    v_mfma_f32_32x32x16_bf16 v[32:47], v[64:67], v[76:79], v[32:47]
    ds_read_b64_tr_b16 v[88:89], v14 offset:43008
    ds_read_b64_tr_b16 v[90:91], v14 offset:44544
    ds_read_b64_tr_b16 v[92:93], v15 offset:43008
    s_waitcnt lgkmcnt(6)
    v_mfma_f32_32x32x16_bf16 v[48:63], v[64:67], v[80:83], v[48:63]
    ds_read_b64_tr_b16 v[94:95], v15 offset:44544
    s_waitcnt vmcnt(5)
    s_waitcnt lgkmcnt(0)
    s_barrier
    ds_read_b128 v[64:67], v9 offset:32768
    ds_read_b64_tr_b16 v[72:73], v96 offset:0
    ds_read_b64_tr_b16 v[74:75], v96 offset:1536
    ds_read_b64_tr_b16 v[76:77], v97 offset:0
    ds_read_b64_tr_b16 v[78:79], v97 offset:1536
    ds_read_b64_tr_b16 v[80:81], v98 offset:0
    ds_read_b64_tr_b16 v[82:83], v98 offset:1536
    v_mfma_f32_32x32x16_bf16 v[16:31], v[68:71], v[84:87], v[16:31]
    s_add_u32 m0, s48, 16384
    s_add_u32 s28, s24, 896
    buffer_load_dwordx4 v4, s[8:11], s28 offen lds
    v_mfma_f32_32x32x16_bf16 v[32:47], v[68:71], v[88:91], v[32:47]
    s_add_u32 m0, s48, 17408
    s_add_u32 s28, s24, 10112
    buffer_load_dwordx4 v5, s[8:11], s28 offen lds
    v_mfma_f32_32x32x16_bf16 v[48:63], v[68:71], v[92:95], v[48:63]
    s_add_u32 m0, s27, 24576
    s_add_u32 s28, s25, 1548288
    buffer_load_dwordx4 v6, s[12:15], s28 offen lds
    s_waitcnt lgkmcnt(4)
    v_mfma_f32_32x32x16_bf16 v[16:31], v[64:67], v[72:75], v[16:31]
    ds_read_b128 v[68:71], v10 offset:32768
    ds_read_b64_tr_b16 v[84:85], v96 offset:6144
    ds_read_b64_tr_b16 v[86:87], v96 offset:7680
    s_add_u32 m0, s27, 25600
    s_add_u32 s28, s25, 1548288
    buffer_load_dwordx4 v7, s[12:15], s28 offen lds
    s_waitcnt lgkmcnt(5)
    v_mfma_f32_32x32x16_bf16 v[32:47], v[64:67], v[76:79], v[32:47]
    ds_read_b64_tr_b16 v[88:89], v97 offset:6144
    ds_read_b64_tr_b16 v[90:91], v97 offset:7680
    ds_read_b64_tr_b16 v[92:93], v98 offset:6144
    s_waitcnt lgkmcnt(6)
    v_mfma_f32_32x32x16_bf16 v[48:63], v[64:67], v[80:83], v[48:63]
    ds_read_b64_tr_b16 v[94:95], v98 offset:7680
    s_waitcnt lgkmcnt(4)
    v_mfma_f32_32x32x16_bf16 v[16:31], v[68:71], v[84:87], v[16:31]
    ds_read_b128 v[64:67], v11 offset:32768
    ds_read_b64_tr_b16 v[72:73], v96 offset:12288
    ds_read_b64_tr_b16 v[74:75], v96 offset:13824
    s_add_u32 m0, s27, 26624
    s_add_u32 s28, s25, 1548288
    buffer_load_dwordx4 v8, s[12:15], s28 offen lds
    s_waitcnt lgkmcnt(5)
    v_mfma_f32_32x32x16_bf16 v[32:47], v[68:71], v[88:91], v[32:47]
    ds_read_b64_tr_b16 v[76:77], v97 offset:12288
    ds_read_b64_tr_b16 v[78:79], v97 offset:13824
    ds_read_b64_tr_b16 v[80:81], v98 offset:12288
    s_waitcnt lgkmcnt(6)
    v_mfma_f32_32x32x16_bf16 v[48:63], v[68:71], v[92:95], v[48:63]
    ds_read_b64_tr_b16 v[82:83], v98 offset:13824
    s_waitcnt lgkmcnt(4)
    v_mfma_f32_32x32x16_bf16 v[16:31], v[64:67], v[72:75], v[16:31]
    ds_read_b128 v[68:71], v12 offset:32768
    ds_read_b64_tr_b16 v[84:85], v96 offset:18432
    ds_read_b64_tr_b16 v[86:87], v96 offset:19968
    s_waitcnt lgkmcnt(5)
    v_mfma_f32_32x32x16_bf16 v[32:47], v[64:67], v[76:79], v[32:47]
    ds_read_b64_tr_b16 v[88:89], v97 offset:18432
    ds_read_b64_tr_b16 v[90:91], v97 offset:19968
    ds_read_b64_tr_b16 v[92:93], v98 offset:18432
    s_waitcnt lgkmcnt(6)
    v_mfma_f32_32x32x16_bf16 v[48:63], v[64:67], v[80:83], v[48:63]
    ds_read_b64_tr_b16 v[94:95], v98 offset:19968
    s_waitcnt vmcnt(5)
    s_waitcnt lgkmcnt(0)
    s_barrier
    ds_read_b128 v[64:67], v9 offset:0
    ds_read_b64_tr_b16 v[72:73], v13 offset:0
    ds_read_b64_tr_b16 v[74:75], v13 offset:1536
    ds_read_b64_tr_b16 v[76:77], v14 offset:0
    ds_read_b64_tr_b16 v[78:79], v14 offset:1536
    ds_read_b64_tr_b16 v[80:81], v15 offset:0
    ds_read_b64_tr_b16 v[82:83], v15 offset:1536
    v_mfma_f32_32x32x16_bf16 v[16:31], v[68:71], v[84:87], v[16:31]
    s_add_u32 m0, s48, 32768
    s_add_u32 s28, s24, 1024
    buffer_load_dwordx4 v4, s[8:11], s28 offen lds
    v_mfma_f32_32x32x16_bf16 v[32:47], v[68:71], v[88:91], v[32:47]
    s_add_u32 m0, s48, 33792
    s_add_u32 s28, s24, 10240
    buffer_load_dwordx4 v5, s[8:11], s28 offen lds
    v_mfma_f32_32x32x16_bf16 v[48:63], v[68:71], v[92:95], v[48:63]
    s_add_u32 m0, s27, 49152
    s_add_u32 s28, s25, 1769472
    buffer_load_dwordx4 v6, s[12:15], s28 offen lds
    s_waitcnt lgkmcnt(4)
    v_mfma_f32_32x32x16_bf16 v[16:31], v[64:67], v[72:75], v[16:31]
    ds_read_b128 v[68:71], v10 offset:0
    ds_read_b64_tr_b16 v[84:85], v13 offset:6144
    ds_read_b64_tr_b16 v[86:87], v13 offset:7680
    s_add_u32 m0, s27, 50176
    s_add_u32 s28, s25, 1769472
    buffer_load_dwordx4 v7, s[12:15], s28 offen lds
    s_waitcnt lgkmcnt(5)
    v_mfma_f32_32x32x16_bf16 v[32:47], v[64:67], v[76:79], v[32:47]
    ds_read_b64_tr_b16 v[88:89], v14 offset:6144
    ds_read_b64_tr_b16 v[90:91], v14 offset:7680
    ds_read_b64_tr_b16 v[92:93], v15 offset:6144
    s_waitcnt lgkmcnt(6)
    v_mfma_f32_32x32x16_bf16 v[48:63], v[64:67], v[80:83], v[48:63]
    ds_read_b64_tr_b16 v[94:95], v15 offset:7680
    s_waitcnt lgkmcnt(4)
    v_mfma_f32_32x32x16_bf16 v[16:31], v[68:71], v[84:87], v[16:31]
    ds_read_b128 v[64:67], v11 offset:0
    ds_read_b64_tr_b16 v[72:73], v13 offset:12288
    ds_read_b64_tr_b16 v[74:75], v13 offset:13824
    s_add_u32 m0, s27, 51200
    s_add_u32 s28, s25, 1769472
    buffer_load_dwordx4 v8, s[12:15], s28 offen lds
    s_waitcnt lgkmcnt(5)
    v_mfma_f32_32x32x16_bf16 v[32:47], v[68:71], v[88:91], v[32:47]
    ds_read_b64_tr_b16 v[76:77], v14 offset:12288
    ds_read_b64_tr_b16 v[78:79], v14 offset:13824
    ds_read_b64_tr_b16 v[80:81], v15 offset:12288
    s_waitcnt lgkmcnt(6)
    v_mfma_f32_32x32x16_bf16 v[48:63], v[68:71], v[92:95], v[48:63]
    ds_read_b64_tr_b16 v[82:83], v15 offset:13824
    s_waitcnt lgkmcnt(4)
    v_mfma_f32_32x32x16_bf16 v[16:31], v[64:67], v[72:75], v[16:31]
    ds_read_b128 v[68:71], v12 offset:0
    ds_read_b64_tr_b16 v[84:85], v13 offset:18432
    ds_read_b64_tr_b16 v[86:87], v13 offset:19968
    s_waitcnt lgkmcnt(5)
    v_mfma_f32_32x32x16_bf16 v[32:47], v[64:67], v[76:79], v[32:47]
    ds_read_b64_tr_b16 v[88:89], v14 offset:18432
    ds_read_b64_tr_b16 v[90:91], v14 offset:19968
    ds_read_b64_tr_b16 v[92:93], v15 offset:18432
    s_waitcnt lgkmcnt(6)
    v_mfma_f32_32x32x16_bf16 v[48:63], v[64:67], v[80:83], v[48:63]
    ds_read_b64_tr_b16 v[94:95], v15 offset:19968
    s_waitcnt vmcnt(5)
    s_waitcnt lgkmcnt(0)
    s_barrier
    ds_read_b128 v[64:67], v9 offset:16384
    ds_read_b64_tr_b16 v[72:73], v13 offset:24576
    ds_read_b64_tr_b16 v[74:75], v13 offset:26112
    ds_read_b64_tr_b16 v[76:77], v14 offset:24576
    ds_read_b64_tr_b16 v[78:79], v14 offset:26112
    ds_read_b64_tr_b16 v[80:81], v15 offset:24576
    ds_read_b64_tr_b16 v[82:83], v15 offset:26112
    v_mfma_f32_32x32x16_bf16 v[16:31], v[68:71], v[84:87], v[16:31]
    v_mfma_f32_32x32x16_bf16 v[32:47], v[68:71], v[88:91], v[32:47]
    v_mfma_f32_32x32x16_bf16 v[48:63], v[68:71], v[92:95], v[48:63]
    s_waitcnt lgkmcnt(4)
    v_mfma_f32_32x32x16_bf16 v[16:31], v[64:67], v[72:75], v[16:31]
    ds_read_b128 v[68:71], v10 offset:16384
    ds_read_b64_tr_b16 v[84:85], v13 offset:30720
    ds_read_b64_tr_b16 v[86:87], v13 offset:32256
    s_waitcnt lgkmcnt(5)
    v_mfma_f32_32x32x16_bf16 v[32:47], v[64:67], v[76:79], v[32:47]
    ds_read_b64_tr_b16 v[88:89], v14 offset:30720
    ds_read_b64_tr_b16 v[90:91], v14 offset:32256
    ds_read_b64_tr_b16 v[92:93], v15 offset:30720
    s_waitcnt lgkmcnt(6)
    v_mfma_f32_32x32x16_bf16 v[48:63], v[64:67], v[80:83], v[48:63]
    ds_read_b64_tr_b16 v[94:95], v15 offset:32256
    s_waitcnt lgkmcnt(4)
    v_mfma_f32_32x32x16_bf16 v[16:31], v[68:71], v[84:87], v[16:31]
    ds_read_b128 v[64:67], v11 offset:16384
    ds_read_b64_tr_b16 v[72:73], v13 offset:36864
    ds_read_b64_tr_b16 v[74:75], v13 offset:38400
    s_waitcnt lgkmcnt(5)
    v_mfma_f32_32x32x16_bf16 v[32:47], v[68:71], v[88:91], v[32:47]
    ds_read_b64_tr_b16 v[76:77], v14 offset:36864
    ds_read_b64_tr_b16 v[78:79], v14 offset:38400
    ds_read_b64_tr_b16 v[80:81], v15 offset:36864
    s_waitcnt lgkmcnt(6)
    v_mfma_f32_32x32x16_bf16 v[48:63], v[68:71], v[92:95], v[48:63]
    ds_read_b64_tr_b16 v[82:83], v15 offset:38400
    s_waitcnt lgkmcnt(4)
    v_mfma_f32_32x32x16_bf16 v[16:31], v[64:67], v[72:75], v[16:31]
    ds_read_b128 v[68:71], v12 offset:16384
    ds_read_b64_tr_b16 v[84:85], v13 offset:43008
    ds_read_b64_tr_b16 v[86:87], v13 offset:44544
    s_waitcnt lgkmcnt(5)
    v_mfma_f32_32x32x16_bf16 v[32:47], v[64:67], v[76:79], v[32:47]
    ds_read_b64_tr_b16 v[88:89], v14 offset:43008
    ds_read_b64_tr_b16 v[90:91], v14 offset:44544
    ds_read_b64_tr_b16 v[92:93], v15 offset:43008
    s_waitcnt lgkmcnt(6)
    v_mfma_f32_32x32x16_bf16 v[48:63], v[64:67], v[80:83], v[48:63]
    ds_read_b64_tr_b16 v[94:95], v15 offset:44544
    s_waitcnt vmcnt(0)
    s_waitcnt lgkmcnt(0)
    s_barrier
    ds_read_b128 v[64:67], v9 offset:32768
    ds_read_b64_tr_b16 v[72:73], v96 offset:0
    ds_read_b64_tr_b16 v[74:75], v96 offset:1536
    ds_read_b64_tr_b16 v[76:77], v97 offset:0
    ds_read_b64_tr_b16 v[78:79], v97 offset:1536
    ds_read_b64_tr_b16 v[80:81], v98 offset:0
    ds_read_b64_tr_b16 v[82:83], v98 offset:1536
    v_mfma_f32_32x32x16_bf16 v[16:31], v[68:71], v[84:87], v[16:31]
    v_mfma_f32_32x32x16_bf16 v[32:47], v[68:71], v[88:91], v[32:47]
    v_mfma_f32_32x32x16_bf16 v[48:63], v[68:71], v[92:95], v[48:63]
    s_waitcnt lgkmcnt(4)
    v_mfma_f32_32x32x16_bf16 v[16:31], v[64:67], v[72:75], v[16:31]
    ds_read_b128 v[68:71], v10 offset:32768
    ds_read_b64_tr_b16 v[84:85], v96 offset:6144
    ds_read_b64_tr_b16 v[86:87], v96 offset:7680
    s_waitcnt lgkmcnt(5)
    v_mfma_f32_32x32x16_bf16 v[32:47], v[64:67], v[76:79], v[32:47]
    ds_read_b64_tr_b16 v[88:89], v97 offset:6144
    ds_read_b64_tr_b16 v[90:91], v97 offset:7680
    ds_read_b64_tr_b16 v[92:93], v98 offset:6144
    s_waitcnt lgkmcnt(6)
    v_mfma_f32_32x32x16_bf16 v[48:63], v[64:67], v[80:83], v[48:63]
    ds_read_b64_tr_b16 v[94:95], v98 offset:7680
    s_waitcnt lgkmcnt(4)
    v_mfma_f32_32x32x16_bf16 v[16:31], v[68:71], v[84:87], v[16:31]
    ds_read_b128 v[64:67], v11 offset:32768
    ds_read_b64_tr_b16 v[72:73], v96 offset:12288
    ds_read_b64_tr_b16 v[74:75], v96 offset:13824
    s_waitcnt lgkmcnt(5)
    v_mfma_f32_32x32x16_bf16 v[32:47], v[68:71], v[88:91], v[32:47]
    ds_read_b64_tr_b16 v[76:77], v97 offset:12288
    ds_read_b64_tr_b16 v[78:79], v97 offset:13824
    ds_read_b64_tr_b16 v[80:81], v98 offset:12288
    s_waitcnt lgkmcnt(6)
    v_mfma_f32_32x32x16_bf16 v[48:63], v[68:71], v[92:95], v[48:63]
    ds_read_b64_tr_b16 v[82:83], v98 offset:13824
    s_waitcnt lgkmcnt(4)
    v_mfma_f32_32x32x16_bf16 v[16:31], v[64:67], v[72:75], v[16:31]
    ds_read_b128 v[68:71], v12 offset:32768
    ds_read_b64_tr_b16 v[84:85], v96 offset:18432
    ds_read_b64_tr_b16 v[86:87], v96 offset:19968
    s_waitcnt lgkmcnt(5)
    v_mfma_f32_32x32x16_bf16 v[32:47], v[64:67], v[76:79], v[32:47]
    ds_read_b64_tr_b16 v[88:89], v97 offset:18432
    ds_read_b64_tr_b16 v[90:91], v97 offset:19968
    ds_read_b64_tr_b16 v[92:93], v98 offset:18432
    s_waitcnt lgkmcnt(6)
    v_mfma_f32_32x32x16_bf16 v[48:63], v[64:67], v[80:83], v[48:63]
    ds_read_b64_tr_b16 v[94:95], v98 offset:19968
    s_waitcnt lgkmcnt(4)
    v_mfma_f32_32x32x16_bf16 v[16:31], v[68:71], v[84:87], v[16:31]
    s_waitcnt lgkmcnt(2)
    v_mfma_f32_32x32x16_bf16 v[32:47], v[68:71], v[88:91], v[32:47]
    s_waitcnt lgkmcnt(0)
    v_mfma_f32_32x32x16_bf16 v[48:63], v[68:71], v[92:95], v[48:63]
    s_lshl_b32 s30, s21, 2
    s_add_u32 s30, s30, s20
    s_lshr_b32 s31, s30, 3
    s_and_b32 s32, s30, 7
    s_mul_i32 s36, s31, 19456
    s_mul_i32 s37, s32, 1280
    s_add_u32 s37, s37, s36
    s_add_u32 s37, s37, 9216
    s_lshl_b32 s41, s23, 3
    s_mul_i32 s42, s41, 155648
    s_add_u32 s38, s37, s42
    s_add_u32 s37, s38, 0
    s_mov_b32 s34, 155648
    v_bfe_u32 v100, v2, 4, 1
    v_bfe_u32 v101, v2, 2, 1
    v_bfe_u32 v102, v2, 3, 1
    v_and_b32 v103, 3, v2
    v_lshrrev_b32 v104, 5, v2
    v_mul_u32_u24 v104, 320, v104
    v_lshl_add_u32 v105, v101, 3, v103
    v_lshl_add_u32 v105, v102, 2, v105
    v_lshl_add_u32 v105, v105, 4, v104
    v_mul_lo_u32 v106, v100, s34
    v_add_u32 v105, v105, v106
    v_bfe_u32 v107, v2, 2, 2
    v_lshl_add_u32 v107, v100, 2, v107
    v_mul_lo_u32 v107, v107, s34
    v_add_u32 v108, 16, v103
    v_lshl_add_u32 v108, v108, 4, v104
    v_add_u32 v107, v107, v108
    v_cvt_pk_bf16_f32 v64, v16, v17
    v_cvt_pk_bf16_f32 v65, v18, v19
    v_cvt_pk_bf16_f32 v66, v20, v21
    v_cvt_pk_bf16_f32 v67, v22, v23
    buffer_store_dwordx4 v[64:67], v105, s[16:19], s37 offen offset:0
    v_cvt_pk_bf16_f32 v72, v24, v25
    v_cvt_pk_bf16_f32 v73, v26, v27
    v_cvt_pk_bf16_f32 v74, v28, v29
    v_cvt_pk_bf16_f32 v75, v30, v31
    buffer_store_dwordx4 v[72:75], v105, s[16:19], s37 offen offset:640
    s_add_u32 s37, s37, s34
    s_add_u32 s37, s37, s34
    v_cvt_pk_bf16_f32 v64, v32, v33
    v_cvt_pk_bf16_f32 v65, v34, v35
    v_cvt_pk_bf16_f32 v66, v36, v37
    v_cvt_pk_bf16_f32 v67, v38, v39
    buffer_store_dwordx4 v[64:67], v105, s[16:19], s37 offen offset:0
    v_cvt_pk_bf16_f32 v72, v40, v41
    v_cvt_pk_bf16_f32 v73, v42, v43
    v_cvt_pk_bf16_f32 v74, v44, v45
    v_cvt_pk_bf16_f32 v75, v46, v47
    buffer_store_dwordx4 v[72:75], v105, s[16:19], s37 offen offset:640
    s_add_u32 s37, s37, s34
    s_add_u32 s37, s37, s34
    v_cvt_pk_bf16_f32 v64, v48, v49
    v_cvt_pk_bf16_f32 v65, v50, v51
    v_cvt_pk_bf16_f32 v66, v52, v53
    v_cvt_pk_bf16_f32 v67, v54, v55
    buffer_store_dwordx4 v[64:67], v105, s[16:19], s37 offen offset:0
    v_cvt_pk_bf16_f32 v72, v56, v57
    v_cvt_pk_bf16_f32 v73, v58, v59
    v_cvt_pk_bf16_f32 v74, v60, v61
    v_cvt_pk_bf16_f32 v75, v62, v63
    buffer_store_dwordx4 v[72:75], v105, s[16:19], s37 offen offset:640
    s_add_u32 s37, s37, s34
    s_add_u32 s37, s37, s34
    s_branch L_k1_kernel_end_7
L_k1_kernel_half1_8:
    v_add_u32 v13, 128, v107
    v_add_u32 v96, 49280, v107
    v_add_u32 v14, 0, v110
    v_add_u32 v97, 49152, v110
    s_cmp_eq_u32 s22, 2
    s_cbranch_scc1 L_k1_kernel_v_10
    s_waitcnt vmcnt(5)
    s_waitcnt lgkmcnt(0)
    s_barrier
    ds_read_b128 v[64:67], v9 offset:0
    ds_read_b64_tr_b16 v[72:73], v13 offset:0
    ds_read_b64_tr_b16 v[74:75], v13 offset:1536
    ds_read_b64_tr_b16 v[76:77], v14 offset:0
    ds_read_b64_tr_b16 v[78:79], v14 offset:1536
    s_waitcnt lgkmcnt(2)
    v_mfma_f32_32x32x16_bf16 v[16:31], v[72:75], v[64:67], 0
    ds_read_b128 v[68:71], v10 offset:0
    ds_read_b64_tr_b16 v[84:85], v13 offset:6144
    ds_read_b64_tr_b16 v[86:87], v13 offset:7680
    s_add_u32 m0, s48, 32768
    s_add_u32 s28, s24, 256
    buffer_load_dwordx4 v4, s[8:11], s28 offen lds
    s_waitcnt lgkmcnt(3)
    v_mfma_f32_32x32x16_bf16 v[32:47], v[76:79], v[64:67], 0
    ds_read_b64_tr_b16 v[88:89], v14 offset:6144
    ds_read_b64_tr_b16 v[90:91], v14 offset:7680
    s_waitcnt lgkmcnt(2)
    v_mfma_f32_32x32x16_bf16 v[16:31], v[84:87], v[68:71], v[16:31]
    ds_read_b128 v[64:67], v11 offset:0
    ds_read_b64_tr_b16 v[72:73], v13 offset:12288
    ds_read_b64_tr_b16 v[74:75], v13 offset:13824
    s_add_u32 m0, s48, 33792
    s_add_u32 s28, s24, 9472
    buffer_load_dwordx4 v5, s[8:11], s28 offen lds
    s_waitcnt lgkmcnt(3)
    v_mfma_f32_32x32x16_bf16 v[32:47], v[88:91], v[68:71], v[32:47]
    ds_read_b64_tr_b16 v[76:77], v14 offset:12288
    ds_read_b64_tr_b16 v[78:79], v14 offset:13824
    s_waitcnt lgkmcnt(2)
    v_mfma_f32_32x32x16_bf16 v[16:31], v[72:75], v[64:67], v[16:31]
    ds_read_b128 v[68:71], v12 offset:0
    ds_read_b64_tr_b16 v[84:85], v13 offset:18432
    ds_read_b64_tr_b16 v[86:87], v13 offset:19968
    s_add_u32 m0, s27, 49152
    s_add_u32 s28, s25, 442368
    buffer_load_dwordx4 v6, s[12:15], s28 offen lds
    s_waitcnt lgkmcnt(3)
    v_mfma_f32_32x32x16_bf16 v[32:47], v[76:79], v[64:67], v[32:47]
    ds_read_b64_tr_b16 v[88:89], v14 offset:18432
    ds_read_b64_tr_b16 v[90:91], v14 offset:19968
    s_add_u32 m0, s27, 50176
    s_add_u32 s28, s25, 442368
    buffer_load_dwordx4 v7, s[12:15], s28 offen lds
    s_add_u32 m0, s27, 51200
    s_add_u32 s28, s25, 442368
    buffer_load_dwordx4 v8, s[12:15], s28 offen lds
    s_waitcnt vmcnt(5)
    s_waitcnt lgkmcnt(0)
    s_barrier
    ds_read_b128 v[64:67], v9 offset:16384
    ds_read_b64_tr_b16 v[72:73], v13 offset:24576
    ds_read_b64_tr_b16 v[74:75], v13 offset:26112
    ds_read_b64_tr_b16 v[76:77], v14 offset:24576
    ds_read_b64_tr_b16 v[78:79], v14 offset:26112
    v_mfma_f32_32x32x16_bf16 v[16:31], v[84:87], v[68:71], v[16:31]
    s_add_u32 m0, s48, 0
    s_add_u32 s28, s24, 384
    buffer_load_dwordx4 v4, s[8:11], s28 offen lds
    v_mfma_f32_32x32x16_bf16 v[32:47], v[88:91], v[68:71], v[32:47]
    s_add_u32 m0, s48, 1024
    s_add_u32 s28, s24, 9600
    buffer_load_dwordx4 v5, s[8:11], s28 offen lds
    s_waitcnt lgkmcnt(2)
    v_mfma_f32_32x32x16_bf16 v[16:31], v[72:75], v[64:67], v[16:31]
    ds_read_b128 v[68:71], v10 offset:16384
    ds_read_b64_tr_b16 v[84:85], v13 offset:30720
    ds_read_b64_tr_b16 v[86:87], v13 offset:32256
    s_add_u32 m0, s27, 0
    s_add_u32 s28, s25, 663552
    buffer_load_dwordx4 v6, s[12:15], s28 offen lds
    s_waitcnt lgkmcnt(3)
    v_mfma_f32_32x32x16_bf16 v[32:47], v[76:79], v[64:67], v[32:47]
    ds_read_b64_tr_b16 v[88:89], v14 offset:30720
    ds_read_b64_tr_b16 v[90:91], v14 offset:32256
    s_waitcnt lgkmcnt(2)
    v_mfma_f32_32x32x16_bf16 v[16:31], v[84:87], v[68:71], v[16:31]
    ds_read_b128 v[64:67], v11 offset:16384
    ds_read_b64_tr_b16 v[72:73], v13 offset:36864
    ds_read_b64_tr_b16 v[74:75], v13 offset:38400
    s_add_u32 m0, s27, 1024
    s_add_u32 s28, s25, 663552
    buffer_load_dwordx4 v7, s[12:15], s28 offen lds
    s_waitcnt lgkmcnt(3)
    v_mfma_f32_32x32x16_bf16 v[32:47], v[88:91], v[68:71], v[32:47]
    ds_read_b64_tr_b16 v[76:77], v14 offset:36864
    ds_read_b64_tr_b16 v[78:79], v14 offset:38400
    s_waitcnt lgkmcnt(2)
    v_mfma_f32_32x32x16_bf16 v[16:31], v[72:75], v[64:67], v[16:31]
    ds_read_b128 v[68:71], v12 offset:16384
    ds_read_b64_tr_b16 v[84:85], v13 offset:43008
    ds_read_b64_tr_b16 v[86:87], v13 offset:44544
    s_add_u32 m0, s27, 2048
    s_add_u32 s28, s25, 663552
    buffer_load_dwordx4 v8, s[12:15], s28 offen lds
    s_waitcnt lgkmcnt(3)
    v_mfma_f32_32x32x16_bf16 v[32:47], v[76:79], v[64:67], v[32:47]
    ds_read_b64_tr_b16 v[88:89], v14 offset:43008
    ds_read_b64_tr_b16 v[90:91], v14 offset:44544
    s_waitcnt vmcnt(5)
    s_waitcnt lgkmcnt(0)
    s_barrier
    ds_read_b128 v[64:67], v9 offset:32768
    ds_read_b64_tr_b16 v[72:73], v96 offset:0
    ds_read_b64_tr_b16 v[74:75], v96 offset:1536
    ds_read_b64_tr_b16 v[76:77], v97 offset:0
    ds_read_b64_tr_b16 v[78:79], v97 offset:1536
    v_mfma_f32_32x32x16_bf16 v[16:31], v[84:87], v[68:71], v[16:31]
    s_add_u32 m0, s48, 16384
    s_add_u32 s28, s24, 512
    buffer_load_dwordx4 v4, s[8:11], s28 offen lds
    v_mfma_f32_32x32x16_bf16 v[32:47], v[88:91], v[68:71], v[32:47]
    s_add_u32 m0, s48, 17408
    s_add_u32 s28, s24, 9728
    buffer_load_dwordx4 v5, s[8:11], s28 offen lds
    s_waitcnt lgkmcnt(2)
    v_mfma_f32_32x32x16_bf16 v[16:31], v[72:75], v[64:67], v[16:31]
    ds_read_b128 v[68:71], v10 offset:32768
    ds_read_b64_tr_b16 v[84:85], v96 offset:6144
    ds_read_b64_tr_b16 v[86:87], v96 offset:7680
    s_add_u32 m0, s27, 24576
    s_add_u32 s28, s25, 884736
    buffer_load_dwordx4 v6, s[12:15], s28 offen lds
    s_waitcnt lgkmcnt(3)
    v_mfma_f32_32x32x16_bf16 v[32:47], v[76:79], v[64:67], v[32:47]
    ds_read_b64_tr_b16 v[88:89], v97 offset:6144
    ds_read_b64_tr_b16 v[90:91], v97 offset:7680
    s_waitcnt lgkmcnt(2)
    v_mfma_f32_32x32x16_bf16 v[16:31], v[84:87], v[68:71], v[16:31]
    ds_read_b128 v[64:67], v11 offset:32768
    ds_read_b64_tr_b16 v[72:73], v96 offset:12288
    ds_read_b64_tr_b16 v[74:75], v96 offset:13824
    s_add_u32 m0, s27, 25600
    s_add_u32 s28, s25, 884736
    buffer_load_dwordx4 v7, s[12:15], s28 offen lds
    s_waitcnt lgkmcnt(3)
    v_mfma_f32_32x32x16_bf16 v[32:47], v[88:91], v[68:71], v[32:47]
    ds_read_b64_tr_b16 v[76:77], v97 offset:12288
    ds_read_b64_tr_b16 v[78:79], v97 offset:13824
    s_waitcnt lgkmcnt(2)
    v_mfma_f32_32x32x16_bf16 v[16:31], v[72:75], v[64:67], v[16:31]
    ds_read_b128 v[68:71], v12 offset:32768
    ds_read_b64_tr_b16 v[84:85], v96 offset:18432
    ds_read_b64_tr_b16 v[86:87], v96 offset:19968
    s_add_u32 m0, s27, 26624
    s_add_u32 s28, s25, 884736
    buffer_load_dwordx4 v8, s[12:15], s28 offen lds
    s_waitcnt lgkmcnt(3)
    v_mfma_f32_32x32x16_bf16 v[32:47], v[76:79], v[64:67], v[32:47]
    ds_read_b64_tr_b16 v[88:89], v97 offset:18432
    ds_read_b64_tr_b16 v[90:91], v97 offset:19968
    s_waitcnt vmcnt(5)
    s_waitcnt lgkmcnt(0)
    s_barrier
    ds_read_b128 v[64:67], v9 offset:0
    ds_read_b64_tr_b16 v[72:73], v13 offset:0
    ds_read_b64_tr_b16 v[74:75], v13 offset:1536
    ds_read_b64_tr_b16 v[76:77], v14 offset:0
    ds_read_b64_tr_b16 v[78:79], v14 offset:1536
    v_mfma_f32_32x32x16_bf16 v[16:31], v[84:87], v[68:71], v[16:31]
    s_add_u32 m0, s48, 32768
    s_add_u32 s28, s24, 640
    buffer_load_dwordx4 v4, s[8:11], s28 offen lds
    v_mfma_f32_32x32x16_bf16 v[32:47], v[88:91], v[68:71], v[32:47]
    s_add_u32 m0, s48, 33792
    s_add_u32 s28, s24, 9856
    buffer_load_dwordx4 v5, s[8:11], s28 offen lds
    s_waitcnt lgkmcnt(2)
    v_mfma_f32_32x32x16_bf16 v[16:31], v[72:75], v[64:67], v[16:31]
    ds_read_b128 v[68:71], v10 offset:0
    ds_read_b64_tr_b16 v[84:85], v13 offset:6144
    ds_read_b64_tr_b16 v[86:87], v13 offset:7680
    s_add_u32 m0, s27, 49152
    s_add_u32 s28, s25, 1105920
    buffer_load_dwordx4 v6, s[12:15], s28 offen lds
    s_waitcnt lgkmcnt(3)
    v_mfma_f32_32x32x16_bf16 v[32:47], v[76:79], v[64:67], v[32:47]
    ds_read_b64_tr_b16 v[88:89], v14 offset:6144
    ds_read_b64_tr_b16 v[90:91], v14 offset:7680
    s_waitcnt lgkmcnt(2)
    v_mfma_f32_32x32x16_bf16 v[16:31], v[84:87], v[68:71], v[16:31]
    ds_read_b128 v[64:67], v11 offset:0
    ds_read_b64_tr_b16 v[72:73], v13 offset:12288
    ds_read_b64_tr_b16 v[74:75], v13 offset:13824
    s_add_u32 m0, s27, 50176
    s_add_u32 s28, s25, 1105920
    buffer_load_dwordx4 v7, s[12:15], s28 offen lds
    s_waitcnt lgkmcnt(3)
    v_mfma_f32_32x32x16_bf16 v[32:47], v[88:91], v[68:71], v[32:47]
    ds_read_b64_tr_b16 v[76:77], v14 offset:12288
    ds_read_b64_tr_b16 v[78:79], v14 offset:13824
    s_waitcnt lgkmcnt(2)
    v_mfma_f32_32x32x16_bf16 v[16:31], v[72:75], v[64:67], v[16:31]
    ds_read_b128 v[68:71], v12 offset:0
    ds_read_b64_tr_b16 v[84:85], v13 offset:18432
    ds_read_b64_tr_b16 v[86:87], v13 offset:19968
    s_add_u32 m0, s27, 51200
    s_add_u32 s28, s25, 1105920
    buffer_load_dwordx4 v8, s[12:15], s28 offen lds
    s_waitcnt lgkmcnt(3)
    v_mfma_f32_32x32x16_bf16 v[32:47], v[76:79], v[64:67], v[32:47]
    ds_read_b64_tr_b16 v[88:89], v14 offset:18432
    ds_read_b64_tr_b16 v[90:91], v14 offset:19968
    s_waitcnt vmcnt(5)
    s_waitcnt lgkmcnt(0)
    s_barrier
    ds_read_b128 v[64:67], v9 offset:16384
    ds_read_b64_tr_b16 v[72:73], v13 offset:24576
    ds_read_b64_tr_b16 v[74:75], v13 offset:26112
    ds_read_b64_tr_b16 v[76:77], v14 offset:24576
    ds_read_b64_tr_b16 v[78:79], v14 offset:26112
    v_mfma_f32_32x32x16_bf16 v[16:31], v[84:87], v[68:71], v[16:31]
    s_add_u32 m0, s48, 0
    s_add_u32 s28, s24, 768
    buffer_load_dwordx4 v4, s[8:11], s28 offen lds
    v_mfma_f32_32x32x16_bf16 v[32:47], v[88:91], v[68:71], v[32:47]
    s_add_u32 m0, s48, 1024
    s_add_u32 s28, s24, 9984
    buffer_load_dwordx4 v5, s[8:11], s28 offen lds
    s_waitcnt lgkmcnt(2)
    v_mfma_f32_32x32x16_bf16 v[16:31], v[72:75], v[64:67], v[16:31]
    ds_read_b128 v[68:71], v10 offset:16384
    ds_read_b64_tr_b16 v[84:85], v13 offset:30720
    ds_read_b64_tr_b16 v[86:87], v13 offset:32256
    s_add_u32 m0, s27, 0
    s_add_u32 s28, s25, 1327104
    buffer_load_dwordx4 v6, s[12:15], s28 offen lds
    s_waitcnt lgkmcnt(3)
    v_mfma_f32_32x32x16_bf16 v[32:47], v[76:79], v[64:67], v[32:47]
    ds_read_b64_tr_b16 v[88:89], v14 offset:30720
    ds_read_b64_tr_b16 v[90:91], v14 offset:32256
    s_waitcnt lgkmcnt(2)
    v_mfma_f32_32x32x16_bf16 v[16:31], v[84:87], v[68:71], v[16:31]
    ds_read_b128 v[64:67], v11 offset:16384
    ds_read_b64_tr_b16 v[72:73], v13 offset:36864
    ds_read_b64_tr_b16 v[74:75], v13 offset:38400
    s_add_u32 m0, s27, 1024
    s_add_u32 s28, s25, 1327104
    buffer_load_dwordx4 v7, s[12:15], s28 offen lds
    s_waitcnt lgkmcnt(3)
    v_mfma_f32_32x32x16_bf16 v[32:47], v[88:91], v[68:71], v[32:47]
    ds_read_b64_tr_b16 v[76:77], v14 offset:36864
    ds_read_b64_tr_b16 v[78:79], v14 offset:38400
    s_waitcnt lgkmcnt(2)
    v_mfma_f32_32x32x16_bf16 v[16:31], v[72:75], v[64:67], v[16:31]
    ds_read_b128 v[68:71], v12 offset:16384
    ds_read_b64_tr_b16 v[84:85], v13 offset:43008
    ds_read_b64_tr_b16 v[86:87], v13 offset:44544
    s_add_u32 m0, s27, 2048
    s_add_u32 s28, s25, 1327104
    buffer_load_dwordx4 v8, s[12:15], s28 offen lds
    s_waitcnt lgkmcnt(3)
    v_mfma_f32_32x32x16_bf16 v[32:47], v[76:79], v[64:67], v[32:47]
    ds_read_b64_tr_b16 v[88:89], v14 offset:43008
    ds_read_b64_tr_b16 v[90:91], v14 offset:44544
    s_waitcnt vmcnt(5)
    s_waitcnt lgkmcnt(0)
    s_barrier
    ds_read_b128 v[64:67], v9 offset:32768
    ds_read_b64_tr_b16 v[72:73], v96 offset:0
    ds_read_b64_tr_b16 v[74:75], v96 offset:1536
    ds_read_b64_tr_b16 v[76:77], v97 offset:0
    ds_read_b64_tr_b16 v[78:79], v97 offset:1536
    v_mfma_f32_32x32x16_bf16 v[16:31], v[84:87], v[68:71], v[16:31]
    s_add_u32 m0, s48, 16384
    s_add_u32 s28, s24, 896
    buffer_load_dwordx4 v4, s[8:11], s28 offen lds
    v_mfma_f32_32x32x16_bf16 v[32:47], v[88:91], v[68:71], v[32:47]
    s_add_u32 m0, s48, 17408
    s_add_u32 s28, s24, 10112
    buffer_load_dwordx4 v5, s[8:11], s28 offen lds
    s_waitcnt lgkmcnt(2)
    v_mfma_f32_32x32x16_bf16 v[16:31], v[72:75], v[64:67], v[16:31]
    ds_read_b128 v[68:71], v10 offset:32768
    ds_read_b64_tr_b16 v[84:85], v96 offset:6144
    ds_read_b64_tr_b16 v[86:87], v96 offset:7680
    s_add_u32 m0, s27, 24576
    s_add_u32 s28, s25, 1548288
    buffer_load_dwordx4 v6, s[12:15], s28 offen lds
    s_waitcnt lgkmcnt(3)
    v_mfma_f32_32x32x16_bf16 v[32:47], v[76:79], v[64:67], v[32:47]
    ds_read_b64_tr_b16 v[88:89], v97 offset:6144
    ds_read_b64_tr_b16 v[90:91], v97 offset:7680
    s_waitcnt lgkmcnt(2)
    v_mfma_f32_32x32x16_bf16 v[16:31], v[84:87], v[68:71], v[16:31]
    ds_read_b128 v[64:67], v11 offset:32768
    ds_read_b64_tr_b16 v[72:73], v96 offset:12288
    ds_read_b64_tr_b16 v[74:75], v96 offset:13824
    s_add_u32 m0, s27, 25600
    s_add_u32 s28, s25, 1548288
    buffer_load_dwordx4 v7, s[12:15], s28 offen lds
    s_waitcnt lgkmcnt(3)
    v_mfma_f32_32x32x16_bf16 v[32:47], v[88:91], v[68:71], v[32:47]
    ds_read_b64_tr_b16 v[76:77], v97 offset:12288
    ds_read_b64_tr_b16 v[78:79], v97 offset:13824
    s_waitcnt lgkmcnt(2)
    v_mfma_f32_32x32x16_bf16 v[16:31], v[72:75], v[64:67], v[16:31]
    ds_read_b128 v[68:71], v12 offset:32768
    ds_read_b64_tr_b16 v[84:85], v96 offset:18432
    ds_read_b64_tr_b16 v[86:87], v96 offset:19968
    s_add_u32 m0, s27, 26624
    s_add_u32 s28, s25, 1548288
    buffer_load_dwordx4 v8, s[12:15], s28 offen lds
    s_waitcnt lgkmcnt(3)
    v_mfma_f32_32x32x16_bf16 v[32:47], v[76:79], v[64:67], v[32:47]
    ds_read_b64_tr_b16 v[88:89], v97 offset:18432
    ds_read_b64_tr_b16 v[90:91], v97 offset:19968
    s_waitcnt vmcnt(5)
    s_waitcnt lgkmcnt(0)
    s_barrier
    ds_read_b128 v[64:67], v9 offset:0
    ds_read_b64_tr_b16 v[72:73], v13 offset:0
    ds_read_b64_tr_b16 v[74:75], v13 offset:1536
    ds_read_b64_tr_b16 v[76:77], v14 offset:0
    ds_read_b64_tr_b16 v[78:79], v14 offset:1536
    v_mfma_f32_32x32x16_bf16 v[16:31], v[84:87], v[68:71], v[16:31]
    s_add_u32 m0, s48, 32768
    s_add_u32 s28, s24, 1024
    buffer_load_dwordx4 v4, s[8:11], s28 offen lds
    v_mfma_f32_32x32x16_bf16 v[32:47], v[88:91], v[68:71], v[32:47]
    s_add_u32 m0, s48, 33792
    s_add_u32 s28, s24, 10240
    buffer_load_dwordx4 v5, s[8:11], s28 offen lds
    s_waitcnt lgkmcnt(2)
    v_mfma_f32_32x32x16_bf16 v[16:31], v[72:75], v[64:67], v[16:31]
    ds_read_b128 v[68:71], v10 offset:0
    ds_read_b64_tr_b16 v[84:85], v13 offset:6144
    ds_read_b64_tr_b16 v[86:87], v13 offset:7680
    s_add_u32 m0, s27, 49152
    s_add_u32 s28, s25, 1769472
    buffer_load_dwordx4 v6, s[12:15], s28 offen lds
    s_waitcnt lgkmcnt(3)
    v_mfma_f32_32x32x16_bf16 v[32:47], v[76:79], v[64:67], v[32:47]
    ds_read_b64_tr_b16 v[88:89], v14 offset:6144
    ds_read_b64_tr_b16 v[90:91], v14 offset:7680
    s_waitcnt lgkmcnt(2)
    v_mfma_f32_32x32x16_bf16 v[16:31], v[84:87], v[68:71], v[16:31]
    ds_read_b128 v[64:67], v11 offset:0
    ds_read_b64_tr_b16 v[72:73], v13 offset:12288
    ds_read_b64_tr_b16 v[74:75], v13 offset:13824
    s_add_u32 m0, s27, 50176
    s_add_u32 s28, s25, 1769472
    buffer_load_dwordx4 v7, s[12:15], s28 offen lds
    s_waitcnt lgkmcnt(3)
    v_mfma_f32_32x32x16_bf16 v[32:47], v[88:91], v[68:71], v[32:47]
    ds_read_b64_tr_b16 v[76:77], v14 offset:12288
    ds_read_b64_tr_b16 v[78:79], v14 offset:13824
    s_waitcnt lgkmcnt(2)
    v_mfma_f32_32x32x16_bf16 v[16:31], v[72:75], v[64:67], v[16:31]
    ds_read_b128 v[68:71], v12 offset:0
    ds_read_b64_tr_b16 v[84:85], v13 offset:18432
    ds_read_b64_tr_b16 v[86:87], v13 offset:19968
    s_add_u32 m0, s27, 51200
    s_add_u32 s28, s25, 1769472
    buffer_load_dwordx4 v8, s[12:15], s28 offen lds
    s_waitcnt lgkmcnt(3)
    v_mfma_f32_32x32x16_bf16 v[32:47], v[76:79], v[64:67], v[32:47]
    ds_read_b64_tr_b16 v[88:89], v14 offset:18432
    ds_read_b64_tr_b16 v[90:91], v14 offset:19968
    s_waitcnt vmcnt(5)
    s_waitcnt lgkmcnt(0)
    s_barrier
    ds_read_b128 v[64:67], v9 offset:16384
    ds_read_b64_tr_b16 v[72:73], v13 offset:24576
    ds_read_b64_tr_b16 v[74:75], v13 offset:26112
    ds_read_b64_tr_b16 v[76:77], v14 offset:24576
    ds_read_b64_tr_b16 v[78:79], v14 offset:26112
    v_mfma_f32_32x32x16_bf16 v[16:31], v[84:87], v[68:71], v[16:31]
    v_mfma_f32_32x32x16_bf16 v[32:47], v[88:91], v[68:71], v[32:47]
    s_waitcnt lgkmcnt(2)
    v_mfma_f32_32x32x16_bf16 v[16:31], v[72:75], v[64:67], v[16:31]
    ds_read_b128 v[68:71], v10 offset:16384
    ds_read_b64_tr_b16 v[84:85], v13 offset:30720
    ds_read_b64_tr_b16 v[86:87], v13 offset:32256
    s_waitcnt lgkmcnt(3)
    v_mfma_f32_32x32x16_bf16 v[32:47], v[76:79], v[64:67], v[32:47]
    ds_read_b64_tr_b16 v[88:89], v14 offset:30720
    ds_read_b64_tr_b16 v[90:91], v14 offset:32256
    s_waitcnt lgkmcnt(2)
    v_mfma_f32_32x32x16_bf16 v[16:31], v[84:87], v[68:71], v[16:31]
    ds_read_b128 v[64:67], v11 offset:16384
    ds_read_b64_tr_b16 v[72:73], v13 offset:36864
    ds_read_b64_tr_b16 v[74:75], v13 offset:38400
    s_waitcnt lgkmcnt(3)
    v_mfma_f32_32x32x16_bf16 v[32:47], v[88:91], v[68:71], v[32:47]
    ds_read_b64_tr_b16 v[76:77], v14 offset:36864
    ds_read_b64_tr_b16 v[78:79], v14 offset:38400
    s_waitcnt lgkmcnt(2)
    v_mfma_f32_32x32x16_bf16 v[16:31], v[72:75], v[64:67], v[16:31]
    ds_read_b128 v[68:71], v12 offset:16384
    ds_read_b64_tr_b16 v[84:85], v13 offset:43008
    ds_read_b64_tr_b16 v[86:87], v13 offset:44544
    s_waitcnt lgkmcnt(3)
    v_mfma_f32_32x32x16_bf16 v[32:47], v[76:79], v[64:67], v[32:47]
    ds_read_b64_tr_b16 v[88:89], v14 offset:43008
    ds_read_b64_tr_b16 v[90:91], v14 offset:44544
    s_waitcnt vmcnt(0)
    s_waitcnt lgkmcnt(0)
    s_barrier
    ds_read_b128 v[64:67], v9 offset:32768
    ds_read_b64_tr_b16 v[72:73], v96 offset:0
    ds_read_b64_tr_b16 v[74:75], v96 offset:1536
    ds_read_b64_tr_b16 v[76:77], v97 offset:0
    ds_read_b64_tr_b16 v[78:79], v97 offset:1536
    v_mfma_f32_32x32x16_bf16 v[16:31], v[84:87], v[68:71], v[16:31]
    v_mfma_f32_32x32x16_bf16 v[32:47], v[88:91], v[68:71], v[32:47]
    s_waitcnt lgkmcnt(2)
    v_mfma_f32_32x32x16_bf16 v[16:31], v[72:75], v[64:67], v[16:31]
    ds_read_b128 v[68:71], v10 offset:32768
    ds_read_b64_tr_b16 v[84:85], v96 offset:6144
    ds_read_b64_tr_b16 v[86:87], v96 offset:7680
    s_waitcnt lgkmcnt(3)
    v_mfma_f32_32x32x16_bf16 v[32:47], v[76:79], v[64:67], v[32:47]
    ds_read_b64_tr_b16 v[88:89], v97 offset:6144
    ds_read_b64_tr_b16 v[90:91], v97 offset:7680
    s_waitcnt lgkmcnt(2)
    v_mfma_f32_32x32x16_bf16 v[16:31], v[84:87], v[68:71], v[16:31]
    ds_read_b128 v[64:67], v11 offset:32768
    ds_read_b64_tr_b16 v[72:73], v96 offset:12288
    ds_read_b64_tr_b16 v[74:75], v96 offset:13824
    s_waitcnt lgkmcnt(3)
    v_mfma_f32_32x32x16_bf16 v[32:47], v[88:91], v[68:71], v[32:47]
    ds_read_b64_tr_b16 v[76:77], v97 offset:12288
    ds_read_b64_tr_b16 v[78:79], v97 offset:13824
    s_waitcnt lgkmcnt(2)
    v_mfma_f32_32x32x16_bf16 v[16:31], v[72:75], v[64:67], v[16:31]
    ds_read_b128 v[68:71], v12 offset:32768
    ds_read_b64_tr_b16 v[84:85], v96 offset:18432
    ds_read_b64_tr_b16 v[86:87], v96 offset:19968
    s_waitcnt lgkmcnt(3)
    v_mfma_f32_32x32x16_bf16 v[32:47], v[76:79], v[64:67], v[32:47]
    ds_read_b64_tr_b16 v[88:89], v97 offset:18432
    ds_read_b64_tr_b16 v[90:91], v97 offset:19968
    s_waitcnt lgkmcnt(2)
    v_mfma_f32_32x32x16_bf16 v[16:31], v[84:87], v[68:71], v[16:31]
    s_waitcnt lgkmcnt(0)
    v_mfma_f32_32x32x16_bf16 v[32:47], v[88:91], v[68:71], v[32:47]
    s_lshl_b32 s30, s21, 2
    s_add_u32 s30, s30, s20
    s_lshr_b32 s31, s30, 3
    s_and_b32 s32, s30, 7
    s_cmp_eq_u32 s22, 0
    s_cselect_b32 s33, 1051597459, 1.0
    s_mov_b32 s34, 155648
    s_cselect_b32 s35, 8192, s34
    s_cselect_b32 s34, 65536, s34
    s_mul_i32 s36, s31, 19456
    s_lshl_b32 s37, s32, 10
    s_add_u32 s37, s37, s36
    s_lshr_b32 s38, s32, 2
    s_lshl_b32 s38, s38, 9
    s_and_b32 s39, s32, 3
    s_lshl_b32 s39, s39, 2
    s_add_u32 s38, s38, s39
    s_add_u32 s38, s38, s36
    s_add_u32 s38, s38, 8192
    s_lshl_b32 s39, s30, 10
    s_add_u32 s39, s39, 5242880
    s_lshl_b32 s40, s30, 7
    s_add_u32 s40, s40, 7340032
    s_cmp_eq_u32 s22, 0
    s_cselect_b32 s37, s39, s37
    s_cselect_b32 s38, s40, s38
    s_lshl_b32 s41, s23, 3
    s_mul_i32 s42, s41, s35
    s_add_u32 s38, s38, s42
    s_add_u32 s41, s41, 6
    s_mul_i32 s42, s41, s34
    s_add_u32 s37, s37, s42
    v_lshlrev_b32 v100, 4, v2
    v_and_b32 v101, 31, v2
    s_cmp_eq_u32 s22, 0
    s_cselect_b32 s39, 2, 4
    v_lshlrev_b32 v101, s39, v101
    v_lshrrev_b32 v102, 5, v2
    v_mul_lo_u32 v102, v102, s35
    v_add_u32 v101, v101, v102
    v_mul_f32 v16, s33, v16
    v_mul_f32 v17, s33, v17
    v_mul_f32 v18, s33, v18
    v_mul_f32 v19, s33, v19
    v_mul_f32 v20, s33, v20
    v_mul_f32 v21, s33, v21
    v_mul_f32 v22, s33, v22
    v_mul_f32 v23, s33, v23
    v_cvt_pk_bf16_f32 v64, v16, v17
    v_cvt_pk_bf16_f32 v65, v18, v19
    v_cvt_pk_bf16_f32 v66, v20, v21
    v_cvt_pk_bf16_f32 v67, v22, v23
    buffer_store_dwordx4 v[64:67], v100, s[16:19], s37 offen
    s_add_u32 s37, s37, s34
    v_mul_f32 v24, s33, v24
    v_mul_f32 v25, s33, v25
    v_mul_f32 v26, s33, v26
    v_mul_f32 v27, s33, v27
    v_mul_f32 v28, s33, v28
    v_mul_f32 v29, s33, v29
    v_mul_f32 v30, s33, v30
    v_mul_f32 v31, s33, v31
    v_cvt_pk_bf16_f32 v72, v24, v25
    v_cvt_pk_bf16_f32 v73, v26, v27
    v_cvt_pk_bf16_f32 v74, v28, v29
    v_cvt_pk_bf16_f32 v75, v30, v31
    buffer_store_dwordx4 v[72:75], v100, s[16:19], s37 offen
    s_add_u32 s37, s37, s34
    v_mul_f32 v32, s33, v32
    v_mul_f32 v33, s33, v33
    v_cvt_pk_bf16_f32 v80, v32, v33
    buffer_store_dword v80, v101, s[16:19], s38 offen
    s_add_u32 s38, s38, s35
    s_add_u32 s38, s38, s35
    v_mul_f32 v36, s33, v36
    v_mul_f32 v37, s33, v37
    v_cvt_pk_bf16_f32 v81, v36, v37
    buffer_store_dword v81, v101, s[16:19], s38 offen
    s_add_u32 s38, s38, s35
    s_add_u32 s38, s38, s35
    v_mul_f32 v40, s33, v40
    v_mul_f32 v41, s33, v41
    v_cvt_pk_bf16_f32 v82, v40, v41
    buffer_store_dword v82, v101, s[16:19], s38 offen
    s_add_u32 s38, s38, s35
    s_add_u32 s38, s38, s35
    v_mul_f32 v44, s33, v44
    v_mul_f32 v45, s33, v45
    v_cvt_pk_bf16_f32 v83, v44, v45
    buffer_store_dword v83, v101, s[16:19], s38 offen
    s_add_u32 s38, s38, s35
    s_add_u32 s38, s38, s35
    s_branch L_k1_kernel_end_7
L_k1_kernel_v_10:
    s_waitcnt vmcnt(5)
    s_waitcnt lgkmcnt(0)
    s_barrier
    ds_read_b128 v[64:67], v9 offset:0
    ds_read_b64_tr_b16 v[72:73], v13 offset:0
    ds_read_b64_tr_b16 v[74:75], v13 offset:1536
    ds_read_b64_tr_b16 v[76:77], v14 offset:0
    ds_read_b64_tr_b16 v[78:79], v14 offset:1536
    s_waitcnt lgkmcnt(2)
    v_mfma_f32_32x32x16_bf16 v[16:31], v[64:67], v[72:75], 0
    ds_read_b128 v[68:71], v10 offset:0
    ds_read_b64_tr_b16 v[84:85], v13 offset:6144
    ds_read_b64_tr_b16 v[86:87], v13 offset:7680
    s_add_u32 m0, s48, 32768
    s_add_u32 s28, s24, 256
    buffer_load_dwordx4 v4, s[8:11], s28 offen lds
    s_waitcnt lgkmcnt(3)
    v_mfma_f32_32x32x16_bf16 v[32:47], v[64:67], v[76:79], 0
    ds_read_b64_tr_b16 v[88:89], v14 offset:6144
    ds_read_b64_tr_b16 v[90:91], v14 offset:7680
    s_waitcnt lgkmcnt(2)
    v_mfma_f32_32x32x16_bf16 v[16:31], v[68:71], v[84:87], v[16:31]
    ds_read_b128 v[64:67], v11 offset:0
    ds_read_b64_tr_b16 v[72:73], v13 offset:12288
    ds_read_b64_tr_b16 v[74:75], v13 offset:13824
    s_add_u32 m0, s48, 33792
    s_add_u32 s28, s24, 9472
    buffer_load_dwordx4 v5, s[8:11], s28 offen lds
    s_waitcnt lgkmcnt(3)
    v_mfma_f32_32x32x16_bf16 v[32:47], v[68:71], v[88:91], v[32:47]
    ds_read_b64_tr_b16 v[76:77], v14 offset:12288
    ds_read_b64_tr_b16 v[78:79], v14 offset:13824
    s_waitcnt lgkmcnt(2)
    v_mfma_f32_32x32x16_bf16 v[16:31], v[64:67], v[72:75], v[16:31]
    ds_read_b128 v[68:71], v12 offset:0
    ds_read_b64_tr_b16 v[84:85], v13 offset:18432
    ds_read_b64_tr_b16 v[86:87], v13 offset:19968
    s_add_u32 m0, s27, 49152
    s_add_u32 s28, s25, 442368
    buffer_load_dwordx4 v6, s[12:15], s28 offen lds
    s_waitcnt lgkmcnt(3)
    v_mfma_f32_32x32x16_bf16 v[32:47], v[64:67], v[76:79], v[32:47]
    ds_read_b64_tr_b16 v[88:89], v14 offset:18432
    ds_read_b64_tr_b16 v[90:91], v14 offset:19968
    s_add_u32 m0, s27, 50176
    s_add_u32 s28, s25, 442368
    buffer_load_dwordx4 v7, s[12:15], s28 offen lds
    s_add_u32 m0, s27, 51200
    s_add_u32 s28, s25, 442368
    buffer_load_dwordx4 v8, s[12:15], s28 offen lds
    s_waitcnt vmcnt(5)
    s_waitcnt lgkmcnt(0)
    s_barrier
    ds_read_b128 v[64:67], v9 offset:16384
    ds_read_b64_tr_b16 v[72:73], v13 offset:24576
    ds_read_b64_tr_b16 v[74:75], v13 offset:26112
    ds_read_b64_tr_b16 v[76:77], v14 offset:24576
    ds_read_b64_tr_b16 v[78:79], v14 offset:26112
    v_mfma_f32_32x32x16_bf16 v[16:31], v[68:71], v[84:87], v[16:31]
    s_add_u32 m0, s48, 0
    s_add_u32 s28, s24, 384
    buffer_load_dwordx4 v4, s[8:11], s28 offen lds
    v_mfma_f32_32x32x16_bf16 v[32:47], v[68:71], v[88:91], v[32:47]
    s_add_u32 m0, s48, 1024
    s_add_u32 s28, s24, 9600
    buffer_load_dwordx4 v5, s[8:11], s28 offen lds
    s_waitcnt lgkmcnt(2)
    v_mfma_f32_32x32x16_bf16 v[16:31], v[64:67], v[72:75], v[16:31]
    ds_read_b128 v[68:71], v10 offset:16384
    ds_read_b64_tr_b16 v[84:85], v13 offset:30720
    ds_read_b64_tr_b16 v[86:87], v13 offset:32256
    s_add_u32 m0, s27, 0
    s_add_u32 s28, s25, 663552
    buffer_load_dwordx4 v6, s[12:15], s28 offen lds
    s_waitcnt lgkmcnt(3)
    v_mfma_f32_32x32x16_bf16 v[32:47], v[64:67], v[76:79], v[32:47]
    ds_read_b64_tr_b16 v[88:89], v14 offset:30720
    ds_read_b64_tr_b16 v[90:91], v14 offset:32256
    s_waitcnt lgkmcnt(2)
    v_mfma_f32_32x32x16_bf16 v[16:31], v[68:71], v[84:87], v[16:31]
    ds_read_b128 v[64:67], v11 offset:16384
    ds_read_b64_tr_b16 v[72:73], v13 offset:36864
    ds_read_b64_tr_b16 v[74:75], v13 offset:38400
    s_add_u32 m0, s27, 1024
    s_add_u32 s28, s25, 663552
    buffer_load_dwordx4 v7, s[12:15], s28 offen lds
    s_waitcnt lgkmcnt(3)
    v_mfma_f32_32x32x16_bf16 v[32:47], v[68:71], v[88:91], v[32:47]
    ds_read_b64_tr_b16 v[76:77], v14 offset:36864
    ds_read_b64_tr_b16 v[78:79], v14 offset:38400
    s_waitcnt lgkmcnt(2)
    v_mfma_f32_32x32x16_bf16 v[16:31], v[64:67], v[72:75], v[16:31]
    ds_read_b128 v[68:71], v12 offset:16384
    ds_read_b64_tr_b16 v[84:85], v13 offset:43008
    ds_read_b64_tr_b16 v[86:87], v13 offset:44544
    s_add_u32 m0, s27, 2048
    s_add_u32 s28, s25, 663552
    buffer_load_dwordx4 v8, s[12:15], s28 offen lds
    s_waitcnt lgkmcnt(3)
    v_mfma_f32_32x32x16_bf16 v[32:47], v[64:67], v[76:79], v[32:47]
    ds_read_b64_tr_b16 v[88:89], v14 offset:43008
    ds_read_b64_tr_b16 v[90:91], v14 offset:44544
    s_waitcnt vmcnt(5)
    s_waitcnt lgkmcnt(0)
    s_barrier
    ds_read_b128 v[64:67], v9 offset:32768
    ds_read_b64_tr_b16 v[72:73], v96 offset:0
    ds_read_b64_tr_b16 v[74:75], v96 offset:1536
    ds_read_b64_tr_b16 v[76:77], v97 offset:0
    ds_read_b64_tr_b16 v[78:79], v97 offset:1536
    v_mfma_f32_32x32x16_bf16 v[16:31], v[68:71], v[84:87], v[16:31]
    s_add_u32 m0, s48, 16384
    s_add_u32 s28, s24, 512
    buffer_load_dwordx4 v4, s[8:11], s28 offen lds
    v_mfma_f32_32x32x16_bf16 v[32:47], v[68:71], v[88:91], v[32:47]
    s_add_u32 m0, s48, 17408
    s_add_u32 s28, s24, 9728
    buffer_load_dwordx4 v5, s[8:11], s28 offen lds
    s_waitcnt lgkmcnt(2)
    v_mfma_f32_32x32x16_bf16 v[16:31], v[64:67], v[72:75], v[16:31]
    ds_read_b128 v[68:71], v10 offset:32768
    ds_read_b64_tr_b16 v[84:85], v96 offset:6144
    ds_read_b64_tr_b16 v[86:87], v96 offset:7680
    s_add_u32 m0, s27, 24576
    s_add_u32 s28, s25, 884736
    buffer_load_dwordx4 v6, s[12:15], s28 offen lds
    s_waitcnt lgkmcnt(3)
    v_mfma_f32_32x32x16_bf16 v[32:47], v[64:67], v[76:79], v[32:47]
    ds_read_b64_tr_b16 v[88:89], v97 offset:6144
    ds_read_b64_tr_b16 v[90:91], v97 offset:7680
    s_waitcnt lgkmcnt(2)
    v_mfma_f32_32x32x16_bf16 v[16:31], v[68:71], v[84:87], v[16:31]
    ds_read_b128 v[64:67], v11 offset:32768
    ds_read_b64_tr_b16 v[72:73], v96 offset:12288
    ds_read_b64_tr_b16 v[74:75], v96 offset:13824
    s_add_u32 m0, s27, 25600
    s_add_u32 s28, s25, 884736
    buffer_load_dwordx4 v7, s[12:15], s28 offen lds
    s_waitcnt lgkmcnt(3)
    v_mfma_f32_32x32x16_bf16 v[32:47], v[68:71], v[88:91], v[32:47]
    ds_read_b64_tr_b16 v[76:77], v97 offset:12288
    ds_read_b64_tr_b16 v[78:79], v97 offset:13824
    s_waitcnt lgkmcnt(2)
    v_mfma_f32_32x32x16_bf16 v[16:31], v[64:67], v[72:75], v[16:31]
    ds_read_b128 v[68:71], v12 offset:32768
    ds_read_b64_tr_b16 v[84:85], v96 offset:18432
    ds_read_b64_tr_b16 v[86:87], v96 offset:19968
    s_add_u32 m0, s27, 26624
    s_add_u32 s28, s25, 884736
    buffer_load_dwordx4 v8, s[12:15], s28 offen lds
    s_waitcnt lgkmcnt(3)
    v_mfma_f32_32x32x16_bf16 v[32:47], v[64:67], v[76:79], v[32:47]
    ds_read_b64_tr_b16 v[88:89], v97 offset:18432
    ds_read_b64_tr_b16 v[90:91], v97 offset:19968
    s_waitcnt vmcnt(5)
    s_waitcnt lgkmcnt(0)
    s_barrier
    ds_read_b128 v[64:67], v9 offset:0
    ds_read_b64_tr_b16 v[72:73], v13 offset:0
    ds_read_b64_tr_b16 v[74:75], v13 offset:1536
    ds_read_b64_tr_b16 v[76:77], v14 offset:0
    ds_read_b64_tr_b16 v[78:79], v14 offset:1536
    v_mfma_f32_32x32x16_bf16 v[16:31], v[68:71], v[84:87], v[16:31]
    s_add_u32 m0, s48, 32768
    s_add_u32 s28, s24, 640
    buffer_load_dwordx4 v4, s[8:11], s28 offen lds
    v_mfma_f32_32x32x16_bf16 v[32:47], v[68:71], v[88:91], v[32:47]
    s_add_u32 m0, s48, 33792
    s_add_u32 s28, s24, 9856
    buffer_load_dwordx4 v5, s[8:11], s28 offen lds
    s_waitcnt lgkmcnt(2)
    v_mfma_f32_32x32x16_bf16 v[16:31], v[64:67], v[72:75], v[16:31]
    ds_read_b128 v[68:71], v10 offset:0
    ds_read_b64_tr_b16 v[84:85], v13 offset:6144
    ds_read_b64_tr_b16 v[86:87], v13 offset:7680
    s_add_u32 m0, s27, 49152
    s_add_u32 s28, s25, 1105920
    buffer_load_dwordx4 v6, s[12:15], s28 offen lds
    s_waitcnt lgkmcnt(3)
    v_mfma_f32_32x32x16_bf16 v[32:47], v[64:67], v[76:79], v[32:47]
    ds_read_b64_tr_b16 v[88:89], v14 offset:6144
    ds_read_b64_tr_b16 v[90:91], v14 offset:7680
    s_waitcnt lgkmcnt(2)
    v_mfma_f32_32x32x16_bf16 v[16:31], v[68:71], v[84:87], v[16:31]
    ds_read_b128 v[64:67], v11 offset:0
    ds_read_b64_tr_b16 v[72:73], v13 offset:12288
    ds_read_b64_tr_b16 v[74:75], v13 offset:13824
    s_add_u32 m0, s27, 50176
    s_add_u32 s28, s25, 1105920
    buffer_load_dwordx4 v7, s[12:15], s28 offen lds
    s_waitcnt lgkmcnt(3)
    v_mfma_f32_32x32x16_bf16 v[32:47], v[68:71], v[88:91], v[32:47]
    ds_read_b64_tr_b16 v[76:77], v14 offset:12288
    ds_read_b64_tr_b16 v[78:79], v14 offset:13824
    s_waitcnt lgkmcnt(2)
    v_mfma_f32_32x32x16_bf16 v[16:31], v[64:67], v[72:75], v[16:31]
    ds_read_b128 v[68:71], v12 offset:0
    ds_read_b64_tr_b16 v[84:85], v13 offset:18432
    ds_read_b64_tr_b16 v[86:87], v13 offset:19968
    s_add_u32 m0, s27, 51200
    s_add_u32 s28, s25, 1105920
    buffer_load_dwordx4 v8, s[12:15], s28 offen lds
    s_waitcnt lgkmcnt(3)
    v_mfma_f32_32x32x16_bf16 v[32:47], v[64:67], v[76:79], v[32:47]
    ds_read_b64_tr_b16 v[88:89], v14 offset:18432
    ds_read_b64_tr_b16 v[90:91], v14 offset:19968
    s_waitcnt vmcnt(5)
    s_waitcnt lgkmcnt(0)
    s_barrier
    ds_read_b128 v[64:67], v9 offset:16384
    ds_read_b64_tr_b16 v[72:73], v13 offset:24576
    ds_read_b64_tr_b16 v[74:75], v13 offset:26112
    ds_read_b64_tr_b16 v[76:77], v14 offset:24576
    ds_read_b64_tr_b16 v[78:79], v14 offset:26112
    v_mfma_f32_32x32x16_bf16 v[16:31], v[68:71], v[84:87], v[16:31]
    s_add_u32 m0, s48, 0
    s_add_u32 s28, s24, 768
    buffer_load_dwordx4 v4, s[8:11], s28 offen lds
    v_mfma_f32_32x32x16_bf16 v[32:47], v[68:71], v[88:91], v[32:47]
    s_add_u32 m0, s48, 1024
    s_add_u32 s28, s24, 9984
    buffer_load_dwordx4 v5, s[8:11], s28 offen lds
    s_waitcnt lgkmcnt(2)
    v_mfma_f32_32x32x16_bf16 v[16:31], v[64:67], v[72:75], v[16:31]
    ds_read_b128 v[68:71], v10 offset:16384
    ds_read_b64_tr_b16 v[84:85], v13 offset:30720
    ds_read_b64_tr_b16 v[86:87], v13 offset:32256
    s_add_u32 m0, s27, 0
    s_add_u32 s28, s25, 1327104
    buffer_load_dwordx4 v6, s[12:15], s28 offen lds
    s_waitcnt lgkmcnt(3)
    v_mfma_f32_32x32x16_bf16 v[32:47], v[64:67], v[76:79], v[32:47]
    ds_read_b64_tr_b16 v[88:89], v14 offset:30720
    ds_read_b64_tr_b16 v[90:91], v14 offset:32256
    s_waitcnt lgkmcnt(2)
    v_mfma_f32_32x32x16_bf16 v[16:31], v[68:71], v[84:87], v[16:31]
    ds_read_b128 v[64:67], v11 offset:16384
    ds_read_b64_tr_b16 v[72:73], v13 offset:36864
    ds_read_b64_tr_b16 v[74:75], v13 offset:38400
    s_add_u32 m0, s27, 1024
    s_add_u32 s28, s25, 1327104
    buffer_load_dwordx4 v7, s[12:15], s28 offen lds
    s_waitcnt lgkmcnt(3)
    v_mfma_f32_32x32x16_bf16 v[32:47], v[68:71], v[88:91], v[32:47]
    ds_read_b64_tr_b16 v[76:77], v14 offset:36864
    ds_read_b64_tr_b16 v[78:79], v14 offset:38400
    s_waitcnt lgkmcnt(2)
    v_mfma_f32_32x32x16_bf16 v[16:31], v[64:67], v[72:75], v[16:31]
    ds_read_b128 v[68:71], v12 offset:16384
    ds_read_b64_tr_b16 v[84:85], v13 offset:43008
    ds_read_b64_tr_b16 v[86:87], v13 offset:44544
    s_add_u32 m0, s27, 2048
    s_add_u32 s28, s25, 1327104
    buffer_load_dwordx4 v8, s[12:15], s28 offen lds
    s_waitcnt lgkmcnt(3)
    v_mfma_f32_32x32x16_bf16 v[32:47], v[64:67], v[76:79], v[32:47]
    ds_read_b64_tr_b16 v[88:89], v14 offset:43008
    ds_read_b64_tr_b16 v[90:91], v14 offset:44544
    s_waitcnt vmcnt(5)
    s_waitcnt lgkmcnt(0)
    s_barrier
    ds_read_b128 v[64:67], v9 offset:32768
    ds_read_b64_tr_b16 v[72:73], v96 offset:0
    ds_read_b64_tr_b16 v[74:75], v96 offset:1536
    ds_read_b64_tr_b16 v[76:77], v97 offset:0
    ds_read_b64_tr_b16 v[78:79], v97 offset:1536
    v_mfma_f32_32x32x16_bf16 v[16:31], v[68:71], v[84:87], v[16:31]
    s_add_u32 m0, s48, 16384
    s_add_u32 s28, s24, 896
    buffer_load_dwordx4 v4, s[8:11], s28 offen lds
    v_mfma_f32_32x32x16_bf16 v[32:47], v[68:71], v[88:91], v[32:47]
    s_add_u32 m0, s48, 17408
    s_add_u32 s28, s24, 10112
    buffer_load_dwordx4 v5, s[8:11], s28 offen lds
    s_waitcnt lgkmcnt(2)
    v_mfma_f32_32x32x16_bf16 v[16:31], v[64:67], v[72:75], v[16:31]
    ds_read_b128 v[68:71], v10 offset:32768
    ds_read_b64_tr_b16 v[84:85], v96 offset:6144
    ds_read_b64_tr_b16 v[86:87], v96 offset:7680
    s_add_u32 m0, s27, 24576
    s_add_u32 s28, s25, 1548288
    buffer_load_dwordx4 v6, s[12:15], s28 offen lds
    s_waitcnt lgkmcnt(3)
    v_mfma_f32_32x32x16_bf16 v[32:47], v[64:67], v[76:79], v[32:47]
    ds_read_b64_tr_b16 v[88:89], v97 offset:6144
    ds_read_b64_tr_b16 v[90:91], v97 offset:7680
    s_waitcnt lgkmcnt(2)
    v_mfma_f32_32x32x16_bf16 v[16:31], v[68:71], v[84:87], v[16:31]
    ds_read_b128 v[64:67], v11 offset:32768
    ds_read_b64_tr_b16 v[72:73], v96 offset:12288
    ds_read_b64_tr_b16 v[74:75], v96 offset:13824
    s_add_u32 m0, s27, 25600
    s_add_u32 s28, s25, 1548288
    buffer_load_dwordx4 v7, s[12:15], s28 offen lds
    s_waitcnt lgkmcnt(3)
    v_mfma_f32_32x32x16_bf16 v[32:47], v[68:71], v[88:91], v[32:47]
    ds_read_b64_tr_b16 v[76:77], v97 offset:12288
    ds_read_b64_tr_b16 v[78:79], v97 offset:13824
    s_waitcnt lgkmcnt(2)
    v_mfma_f32_32x32x16_bf16 v[16:31], v[64:67], v[72:75], v[16:31]
    ds_read_b128 v[68:71], v12 offset:32768
    ds_read_b64_tr_b16 v[84:85], v96 offset:18432
    ds_read_b64_tr_b16 v[86:87], v96 offset:19968
    s_add_u32 m0, s27, 26624
    s_add_u32 s28, s25, 1548288
    buffer_load_dwordx4 v8, s[12:15], s28 offen lds
    s_waitcnt lgkmcnt(3)
    v_mfma_f32_32x32x16_bf16 v[32:47], v[64:67], v[76:79], v[32:47]
    ds_read_b64_tr_b16 v[88:89], v97 offset:18432
    ds_read_b64_tr_b16 v[90:91], v97 offset:19968
    s_waitcnt vmcnt(5)
    s_waitcnt lgkmcnt(0)
    s_barrier
    ds_read_b128 v[64:67], v9 offset:0
    ds_read_b64_tr_b16 v[72:73], v13 offset:0
    ds_read_b64_tr_b16 v[74:75], v13 offset:1536
    ds_read_b64_tr_b16 v[76:77], v14 offset:0
    ds_read_b64_tr_b16 v[78:79], v14 offset:1536
    v_mfma_f32_32x32x16_bf16 v[16:31], v[68:71], v[84:87], v[16:31]
    s_add_u32 m0, s48, 32768
    s_add_u32 s28, s24, 1024
    buffer_load_dwordx4 v4, s[8:11], s28 offen lds
    v_mfma_f32_32x32x16_bf16 v[32:47], v[68:71], v[88:91], v[32:47]
    s_add_u32 m0, s48, 33792
    s_add_u32 s28, s24, 10240
    buffer_load_dwordx4 v5, s[8:11], s28 offen lds
    s_waitcnt lgkmcnt(2)
    v_mfma_f32_32x32x16_bf16 v[16:31], v[64:67], v[72:75], v[16:31]
    ds_read_b128 v[68:71], v10 offset:0
    ds_read_b64_tr_b16 v[84:85], v13 offset:6144
    ds_read_b64_tr_b16 v[86:87], v13 offset:7680
    s_add_u32 m0, s27, 49152
    s_add_u32 s28, s25, 1769472
    buffer_load_dwordx4 v6, s[12:15], s28 offen lds
    s_waitcnt lgkmcnt(3)
    v_mfma_f32_32x32x16_bf16 v[32:47], v[64:67], v[76:79], v[32:47]
    ds_read_b64_tr_b16 v[88:89], v14 offset:6144
    ds_read_b64_tr_b16 v[90:91], v14 offset:7680
    s_waitcnt lgkmcnt(2)
    v_mfma_f32_32x32x16_bf16 v[16:31], v[68:71], v[84:87], v[16:31]
    ds_read_b128 v[64:67], v11 offset:0
    ds_read_b64_tr_b16 v[72:73], v13 offset:12288
    ds_read_b64_tr_b16 v[74:75], v13 offset:13824
    s_add_u32 m0, s27, 50176
    s_add_u32 s28, s25, 1769472
    buffer_load_dwordx4 v7, s[12:15], s28 offen lds
    s_waitcnt lgkmcnt(3)
    v_mfma_f32_32x32x16_bf16 v[32:47], v[68:71], v[88:91], v[32:47]
    ds_read_b64_tr_b16 v[76:77], v14 offset:12288
    ds_read_b64_tr_b16 v[78:79], v14 offset:13824
    s_waitcnt lgkmcnt(2)
    v_mfma_f32_32x32x16_bf16 v[16:31], v[64:67], v[72:75], v[16:31]
    ds_read_b128 v[68:71], v12 offset:0
    ds_read_b64_tr_b16 v[84:85], v13 offset:18432
    ds_read_b64_tr_b16 v[86:87], v13 offset:19968
    s_add_u32 m0, s27, 51200
    s_add_u32 s28, s25, 1769472
    buffer_load_dwordx4 v8, s[12:15], s28 offen lds
    s_waitcnt lgkmcnt(3)
    v_mfma_f32_32x32x16_bf16 v[32:47], v[64:67], v[76:79], v[32:47]
    ds_read_b64_tr_b16 v[88:89], v14 offset:18432
    ds_read_b64_tr_b16 v[90:91], v14 offset:19968
    s_waitcnt vmcnt(5)
    s_waitcnt lgkmcnt(0)
    s_barrier
    ds_read_b128 v[64:67], v9 offset:16384
    ds_read_b64_tr_b16 v[72:73], v13 offset:24576
    ds_read_b64_tr_b16 v[74:75], v13 offset:26112
    ds_read_b64_tr_b16 v[76:77], v14 offset:24576
    ds_read_b64_tr_b16 v[78:79], v14 offset:26112
    v_mfma_f32_32x32x16_bf16 v[16:31], v[68:71], v[84:87], v[16:31]
    v_mfma_f32_32x32x16_bf16 v[32:47], v[68:71], v[88:91], v[32:47]
    s_waitcnt lgkmcnt(2)
    v_mfma_f32_32x32x16_bf16 v[16:31], v[64:67], v[72:75], v[16:31]
    ds_read_b128 v[68:71], v10 offset:16384
    ds_read_b64_tr_b16 v[84:85], v13 offset:30720
    ds_read_b64_tr_b16 v[86:87], v13 offset:32256
    s_waitcnt lgkmcnt(3)
    v_mfma_f32_32x32x16_bf16 v[32:47], v[64:67], v[76:79], v[32:47]
    ds_read_b64_tr_b16 v[88:89], v14 offset:30720
    ds_read_b64_tr_b16 v[90:91], v14 offset:32256
    s_waitcnt lgkmcnt(2)
    v_mfma_f32_32x32x16_bf16 v[16:31], v[68:71], v[84:87], v[16:31]
    ds_read_b128 v[64:67], v11 offset:16384
    ds_read_b64_tr_b16 v[72:73], v13 offset:36864
    ds_read_b64_tr_b16 v[74:75], v13 offset:38400
    s_waitcnt lgkmcnt(3)
    v_mfma_f32_32x32x16_bf16 v[32:47], v[68:71], v[88:91], v[32:47]
    ds_read_b64_tr_b16 v[76:77], v14 offset:36864
    ds_read_b64_tr_b16 v[78:79], v14 offset:38400
    s_waitcnt lgkmcnt(2)
    v_mfma_f32_32x32x16_bf16 v[16:31], v[64:67], v[72:75], v[16:31]
    ds_read_b128 v[68:71], v12 offset:16384
    ds_read_b64_tr_b16 v[84:85], v13 offset:43008
    ds_read_b64_tr_b16 v[86:87], v13 offset:44544
    s_waitcnt lgkmcnt(3)
    v_mfma_f32_32x32x16_bf16 v[32:47], v[64:67], v[76:79], v[32:47]
    ds_read_b64_tr_b16 v[88:89], v14 offset:43008
    ds_read_b64_tr_b16 v[90:91], v14 offset:44544
    s_waitcnt vmcnt(0)
    s_waitcnt lgkmcnt(0)
    s_barrier
    ds_read_b128 v[64:67], v9 offset:32768
    ds_read_b64_tr_b16 v[72:73], v96 offset:0
    ds_read_b64_tr_b16 v[74:75], v96 offset:1536
    ds_read_b64_tr_b16 v[76:77], v97 offset:0
    ds_read_b64_tr_b16 v[78:79], v97 offset:1536
    v_mfma_f32_32x32x16_bf16 v[16:31], v[68:71], v[84:87], v[16:31]
    v_mfma_f32_32x32x16_bf16 v[32:47], v[68:71], v[88:91], v[32:47]
    s_waitcnt lgkmcnt(2)
    v_mfma_f32_32x32x16_bf16 v[16:31], v[64:67], v[72:75], v[16:31]
    ds_read_b128 v[68:71], v10 offset:32768
    ds_read_b64_tr_b16 v[84:85], v96 offset:6144
    ds_read_b64_tr_b16 v[86:87], v96 offset:7680
    s_waitcnt lgkmcnt(3)
    v_mfma_f32_32x32x16_bf16 v[32:47], v[64:67], v[76:79], v[32:47]
    ds_read_b64_tr_b16 v[88:89], v97 offset:6144
    ds_read_b64_tr_b16 v[90:91], v97 offset:7680
    s_waitcnt lgkmcnt(2)
    v_mfma_f32_32x32x16_bf16 v[16:31], v[68:71], v[84:87], v[16:31]
    ds_read_b128 v[64:67], v11 offset:32768
    ds_read_b64_tr_b16 v[72:73], v96 offset:12288
    ds_read_b64_tr_b16 v[74:75], v96 offset:13824
    s_waitcnt lgkmcnt(3)
    v_mfma_f32_32x32x16_bf16 v[32:47], v[68:71], v[88:91], v[32:47]
    ds_read_b64_tr_b16 v[76:77], v97 offset:12288
    ds_read_b64_tr_b16 v[78:79], v97 offset:13824
    s_waitcnt lgkmcnt(2)
    v_mfma_f32_32x32x16_bf16 v[16:31], v[64:67], v[72:75], v[16:31]
    ds_read_b128 v[68:71], v12 offset:32768
    ds_read_b64_tr_b16 v[84:85], v96 offset:18432
    ds_read_b64_tr_b16 v[86:87], v96 offset:19968
    s_waitcnt lgkmcnt(3)
    v_mfma_f32_32x32x16_bf16 v[32:47], v[64:67], v[76:79], v[32:47]
    ds_read_b64_tr_b16 v[88:89], v97 offset:18432
    ds_read_b64_tr_b16 v[90:91], v97 offset:19968
    s_waitcnt lgkmcnt(2)
    v_mfma_f32_32x32x16_bf16 v[16:31], v[68:71], v[84:87], v[16:31]
    s_waitcnt lgkmcnt(0)
    v_mfma_f32_32x32x16_bf16 v[32:47], v[68:71], v[88:91], v[32:47]
    s_lshl_b32 s30, s21, 2
    s_add_u32 s30, s30, s20
    s_lshr_b32 s31, s30, 3
    s_and_b32 s32, s30, 7
    s_mul_i32 s36, s31, 19456
    s_mul_i32 s37, s32, 1280
    s_add_u32 s37, s37, s36
    s_add_u32 s37, s37, 9216
    s_lshl_b32 s41, s23, 3
    s_mul_i32 s42, s41, 155648
    s_add_u32 s38, s37, s42
    s_add_u32 s37, s38, 933888
    s_mov_b32 s34, 155648
    v_bfe_u32 v100, v2, 4, 1
    v_bfe_u32 v101, v2, 2, 1
    v_bfe_u32 v102, v2, 3, 1
    v_and_b32 v103, 3, v2
    v_lshrrev_b32 v104, 5, v2
    v_mul_u32_u24 v104, 320, v104
    v_lshl_add_u32 v105, v101, 3, v103
    v_lshl_add_u32 v105, v102, 2, v105
    v_lshl_add_u32 v105, v105, 4, v104
    v_mul_lo_u32 v106, v100, s34
    v_add_u32 v105, v105, v106
    v_bfe_u32 v107, v2, 2, 2
    v_lshl_add_u32 v107, v100, 2, v107
    v_mul_lo_u32 v107, v107, s34
    v_add_u32 v108, 16, v103
    v_lshl_add_u32 v108, v108, 4, v104
    v_add_u32 v107, v107, v108
    v_cvt_pk_bf16_f32 v64, v16, v17
    v_cvt_pk_bf16_f32 v65, v18, v19
    v_cvt_pk_bf16_f32 v66, v20, v21
    v_cvt_pk_bf16_f32 v67, v22, v23
    buffer_store_dwordx4 v[64:67], v105, s[16:19], s37 offen offset:0
    v_cvt_pk_bf16_f32 v72, v24, v25
    v_cvt_pk_bf16_f32 v73, v26, v27
    v_cvt_pk_bf16_f32 v74, v28, v29
    v_cvt_pk_bf16_f32 v75, v30, v31
    buffer_store_dwordx4 v[72:75], v105, s[16:19], s37 offen offset:640
    s_add_u32 s37, s37, s34
    s_add_u32 s37, s37, s34
    v_mov_b32 v109, 0x3f803f80
    v_mov_b32 v110, 0
    v_cmp_eq_u32 s[44:45], 3, v103
    v_cmp_le_u32 s[46:47], 2, v103
    s_nop 1
    v_cndmask_b32_e64 v109, v109, v110, s[44:45]
    v_cvt_pk_bf16_f32 v80, v32, v33
    v_cvt_pk_bf16_f32 v81, v34, v35
    v_cvt_pk_bf16_f32 v82, v36, v37
    v_cvt_pk_bf16_f32 v83, v38, v39
    v_cndmask_b32_e64 v80, v80, v109, s[46:47]
    v_cndmask_b32_e64 v81, v81, v109, s[46:47]
    v_cndmask_b32_e64 v82, v82, v109, s[46:47]
    v_cndmask_b32_e64 v83, v83, v109, s[46:47]
    v_cvt_pk_bf16_f32 v84, v40, v41
    v_cvt_pk_bf16_f32 v85, v42, v43
    v_cvt_pk_bf16_f32 v86, v44, v45
    v_cvt_pk_bf16_f32 v87, v46, v47
    v_cndmask_b32_e64 v84, v84, v109, s[46:47]
    v_cndmask_b32_e64 v85, v85, v109, s[46:47]
    v_cndmask_b32_e64 v86, v86, v109, s[46:47]
    v_cndmask_b32_e64 v87, v87, v109, s[46:47]
    buffer_store_dwordx4 v[80:83], v107, s[16:19], s38 offen offset:0
    buffer_store_dwordx4 v[84:87], v107, s[16:19], s38 offen offset:640
L_k1_kernel_end_7:
    s_branch L_k1_kernel_k1end_3
L_k1_kernel_pf_6:
    s_load_dwordx4 s[60:63], s[0:1], 56
    s_and_b32 s65, s2, 7
    s_lshr_b32 s64, s2, 3
    s_mul_i32 s64, s64, 3
    s_add_u32 s64, s64, s49
    s_sub_u32 s64, s64, 8
    s_mov_b32 m0, 122880
    v_add_u32 v4, 0, v2
    v_mul_u32_u24 v5, 586, v4
    v_lshrrev_b32 v5, 16, v5
    v_mul_u32_u24 v6, 112, v5
    v_sub_u32 v6, v4, v6
    v_mul_u32_u24 v5, 3456, v5
    v_lshl_add_u32 v8, v6, 4, v5
    v_add_u32 v4, 64, v2
    v_mul_u32_u24 v5, 586, v4
    v_lshrrev_b32 v5, 16, v5
    v_mul_u32_u24 v6, 112, v5
    v_sub_u32 v6, v4, v6
    v_mul_u32_u24 v5, 3456, v5
    v_lshl_add_u32 v9, v6, 4, v5
    v_add_u32 v4, 128, v2
    v_mul_u32_u24 v5, 586, v4
    v_lshrrev_b32 v5, 16, v5
    v_mul_u32_u24 v6, 112, v5
    v_sub_u32 v6, v4, v6
    v_mul_u32_u24 v5, 3456, v5
    v_lshl_add_u32 v10, v6, 4, v5
    v_add_u32 v4, 192, v2
    v_mul_u32_u24 v5, 586, v4
    v_lshrrev_b32 v5, 16, v5
    v_mul_u32_u24 v6, 112, v5
    v_sub_u32 v6, v4, v6
    v_mul_u32_u24 v5, 3456, v5
    v_lshl_add_u32 v11, v6, 4, v5
    v_add_u32 v4, 256, v2
    v_mul_u32_u24 v5, 586, v4
    v_lshrrev_b32 v5, 16, v5
    v_mul_u32_u24 v6, 112, v5
    v_sub_u32 v6, v4, v6
    v_mul_u32_u24 v5, 3456, v5
    v_lshl_add_u32 v12, v6, 4, v5
    v_add_u32 v4, 320, v2
    v_mul_u32_u24 v5, 586, v4
    v_lshrrev_b32 v5, 16, v5
    v_mul_u32_u24 v6, 112, v5
    v_sub_u32 v6, v4, v6
    v_mul_u32_u24 v5, 3456, v5
    v_lshl_add_u32 v13, v6, 4, v5
    v_add_u32 v4, 384, v2
    v_mul_u32_u24 v5, 586, v4
    v_lshrrev_b32 v5, 16, v5
    v_mul_u32_u24 v6, 112, v5
    v_sub_u32 v6, v4, v6
    v_mul_u32_u24 v5, 3456, v5
    v_lshl_add_u32 v14, v6, 4, v5
    v_lshrrev_b32 v5, 3, v2
    v_mul_u32_u24 v5, 1152, v5
    v_and_b32 v6, 7, v2
    v_lshl_add_u32 v16, v6, 4, v5
    s_waitcnt lgkmcnt(0)
    s_mov_b32 s68, s60
    s_and_b32 s69, s61, 0xffff
    s_mov_b32 s70, 2359296
    s_mov_b32 s71, 0x00020000
    s_mov_b32 s72, s62
    s_and_b32 s73, s63, 0xffff
    s_mov_b32 s74, 1990656
    s_mov_b32 s75, 0x00020000
    s_and_b32 s79, s65, 1
    s_mul_i32 s79, s79, 1664
    s_lshr_b32 s78, s65, 1
    s_mul_i32 s78, s78, 589824
    s_barrier
    s_add_u32 s66, s64, 0
    s_cmp_ge_u32 s66, 24
    s_cbranch_scc1 L_k1_kernel_pd_12
    s_mul_i32 s67, s66, 2731
    s_lshr_b32 s67, s67, 16
    s_mul_i32 s76, s67, 24
    s_sub_u32 s76, s66, s76
    s_add_u32 s67, s67, 2
    s_cmp_ge_u32 s76, 16
    s_cbranch_scc1 L_k1_kernel_px_11
    s_lshl_b32 s77, s67, 6
    s_lshl_b32 s76, s76, 2
    s_add_u32 s77, s77, s76
    s_mul_i32 s77, s77, 3456
    s_add_u32 s77, s77, s79
    buffer_load_dwordx4 v8, s[72:75], s77 offen lds
    buffer_load_dwordx4 v9, s[72:75], s77 offen lds
    buffer_load_dwordx4 v10, s[72:75], s77 offen lds
    buffer_load_dwordx4 v11, s[72:75], s77 offen lds
    buffer_load_dwordx4 v12, s[72:75], s77 offen lds
    buffer_load_dwordx4 v13, s[72:75], s77 offen lds
    buffer_load_dwordx4 v14, s[72:75], s77 offen lds
    s_branch L_k1_kernel_pd_12
L_k1_kernel_px_11:
    s_sub_u32 s76, s76, 16
    s_mul_i32 s76, s76, 73728
    s_lshl_b32 s77, s67, 7
    s_add_u32 s77, s77, s76
    s_add_u32 s77, s77, s78
    buffer_load_dwordx4 v16, s[68:71], s77 offen lds
    s_add_u32 s77, s77, 9216
    buffer_load_dwordx4 v16, s[68:71], s77 offen lds
    s_add_u32 s77, s77, 9216
    buffer_load_dwordx4 v16, s[68:71], s77 offen lds
    s_add_u32 s77, s77, 9216
    buffer_load_dwordx4 v16, s[68:71], s77 offen lds
    s_add_u32 s77, s77, 9216
    buffer_load_dwordx4 v16, s[68:71], s77 offen lds
    s_add_u32 s77, s77, 9216
    buffer_load_dwordx4 v16, s[68:71], s77 offen lds
    s_add_u32 s77, s77, 9216
    buffer_load_dwordx4 v16, s[68:71], s77 offen lds
    s_add_u32 s77, s77, 9216
    buffer_load_dwordx4 v16, s[68:71], s77 offen lds
L_k1_kernel_pd_12:
    s_barrier
    s_add_u32 s66, s64, 0
    s_cmp_ge_u32 s66, 168
    s_cbranch_scc1 L_k1_kernel_pd_14
    s_cmp_lt_u32 s66, 24
    s_cbranch_scc1 L_k1_kernel_pd_14
    s_mul_i32 s67, s66, 2731
    s_lshr_b32 s67, s67, 16
    s_mul_i32 s76, s67, 24
    s_sub_u32 s76, s66, s76
    s_add_u32 s67, s67, 2
    s_cmp_ge_u32 s76, 16
    s_cbranch_scc1 L_k1_kernel_px_13
    s_lshl_b32 s77, s67, 6
    s_lshl_b32 s76, s76, 2
    s_add_u32 s77, s77, s76
    s_mul_i32 s77, s77, 3456
    s_add_u32 s77, s77, s79
    buffer_load_dwordx4 v8, s[72:75], s77 offen lds
    buffer_load_dwordx4 v9, s[72:75], s77 offen lds
    buffer_load_dwordx4 v10, s[72:75], s77 offen lds
    buffer_load_dwordx4 v11, s[72:75], s77 offen lds
    buffer_load_dwordx4 v12, s[72:75], s77 offen lds
    buffer_load_dwordx4 v13, s[72:75], s77 offen lds
    buffer_load_dwordx4 v14, s[72:75], s77 offen lds
    s_branch L_k1_kernel_pd_14
L_k1_kernel_px_13:
    s_sub_u32 s76, s76, 16
    s_mul_i32 s76, s76, 73728
    s_lshl_b32 s77, s67, 7
    s_add_u32 s77, s77, s76
    s_add_u32 s77, s77, s78
    buffer_load_dwordx4 v16, s[68:71], s77 offen lds
    s_add_u32 s77, s77, 9216
    buffer_load_dwordx4 v16, s[68:71], s77 offen lds
    s_add_u32 s77, s77, 9216
    buffer_load_dwordx4 v16, s[68:71], s77 offen lds
    s_add_u32 s77, s77, 9216
    buffer_load_dwordx4 v16, s[68:71], s77 offen lds
    s_add_u32 s77, s77, 9216
    buffer_load_dwordx4 v16, s[68:71], s77 offen lds
    s_add_u32 s77, s77, 9216
    buffer_load_dwordx4 v16, s[68:71], s77 offen lds
    s_add_u32 s77, s77, 9216
    buffer_load_dwordx4 v16, s[68:71], s77 offen lds
    s_add_u32 s77, s77, 9216
    buffer_load_dwordx4 v16, s[68:71], s77 offen lds
L_k1_kernel_pd_14:
    s_add_u32 s66, s64, 72
    s_cmp_ge_u32 s66, 168
    s_cbranch_scc1 L_k1_kernel_pd_16
    s_mul_i32 s67, s66, 2731
    s_lshr_b32 s67, s67, 16
    s_mul_i32 s76, s67, 24
    s_sub_u32 s76, s66, s76
    s_add_u32 s67, s67, 2
    s_cmp_ge_u32 s76, 16
    s_cbranch_scc1 L_k1_kernel_px_15
    s_lshl_b32 s77, s67, 6
    s_lshl_b32 s76, s76, 2
    s_add_u32 s77, s77, s76
    s_mul_i32 s77, s77, 3456
    s_add_u32 s77, s77, s79
    buffer_load_dwordx4 v8, s[72:75], s77 offen lds
    buffer_load_dwordx4 v9, s[72:75], s77 offen lds
    buffer_load_dwordx4 v10, s[72:75], s77 offen lds
    buffer_load_dwordx4 v11, s[72:75], s77 offen lds
    buffer_load_dwordx4 v12, s[72:75], s77 offen lds
    buffer_load_dwordx4 v13, s[72:75], s77 offen lds
    buffer_load_dwordx4 v14, s[72:75], s77 offen lds
    s_branch L_k1_kernel_pd_16
L_k1_kernel_px_15:
    s_sub_u32 s76, s76, 16
    s_mul_i32 s76, s76, 73728
    s_lshl_b32 s77, s67, 7
    s_add_u32 s77, s77, s76
    s_add_u32 s77, s77, s78
    buffer_load_dwordx4 v16, s[68:71], s77 offen lds
    s_add_u32 s77, s77, 9216
    buffer_load_dwordx4 v16, s[68:71], s77 offen lds
    s_add_u32 s77, s77, 9216
    buffer_load_dwordx4 v16, s[68:71], s77 offen lds
    s_add_u32 s77, s77, 9216
    buffer_load_dwordx4 v16, s[68:71], s77 offen lds
    s_add_u32 s77, s77, 9216
    buffer_load_dwordx4 v16, s[68:71], s77 offen lds
    s_add_u32 s77, s77, 9216
    buffer_load_dwordx4 v16, s[68:71], s77 offen lds
    s_add_u32 s77, s77, 9216
    buffer_load_dwordx4 v16, s[68:71], s77 offen lds
    s_add_u32 s77, s77, 9216
    buffer_load_dwordx4 v16, s[68:71], s77 offen lds
L_k1_kernel_pd_16:
    s_add_u32 s66, s64, 144
    s_cmp_ge_u32 s66, 168
    s_cbranch_scc1 L_k1_kernel_pd_18
    s_mul_i32 s67, s66, 2731
    s_lshr_b32 s67, s67, 16
    s_mul_i32 s76, s67, 24
    s_sub_u32 s76, s66, s76
    s_add_u32 s67, s67, 2
    s_cmp_ge_u32 s76, 16
    s_cbranch_scc1 L_k1_kernel_px_17
    s_lshl_b32 s77, s67, 6
    s_lshl_b32 s76, s76, 2
    s_add_u32 s77, s77, s76
    s_mul_i32 s77, s77, 3456
    s_add_u32 s77, s77, s79
    buffer_load_dwordx4 v8, s[72:75], s77 offen lds
    buffer_load_dwordx4 v9, s[72:75], s77 offen lds
    buffer_load_dwordx4 v10, s[72:75], s77 offen lds
    buffer_load_dwordx4 v11, s[72:75], s77 offen lds
    buffer_load_dwordx4 v12, s[72:75], s77 offen lds
    buffer_load_dwordx4 v13, s[72:75], s77 offen lds
    buffer_load_dwordx4 v14, s[72:75], s77 offen lds
    s_branch L_k1_kernel_pd_18
L_k1_kernel_px_17:
    s_sub_u32 s76, s76, 16
    s_mul_i32 s76, s76, 73728
    s_lshl_b32 s77, s67, 7
    s_add_u32 s77, s77, s76
    s_add_u32 s77, s77, s78
    buffer_load_dwordx4 v16, s[68:71], s77 offen lds
    s_add_u32 s77, s77, 9216
    buffer_load_dwordx4 v16, s[68:71], s77 offen lds
    s_add_u32 s77, s77, 9216
    buffer_load_dwordx4 v16, s[68:71], s77 offen lds
    s_add_u32 s77, s77, 9216
    buffer_load_dwordx4 v16, s[68:71], s77 offen lds
    s_add_u32 s77, s77, 9216
    buffer_load_dwordx4 v16, s[68:71], s77 offen lds
    s_add_u32 s77, s77, 9216
    buffer_load_dwordx4 v16, s[68:71], s77 offen lds
    s_add_u32 s77, s77, 9216
    buffer_load_dwordx4 v16, s[68:71], s77 offen lds
    s_add_u32 s77, s77, 9216
    buffer_load_dwordx4 v16, s[68:71], s77 offen lds
L_k1_kernel_pd_18:
    s_barrier
    s_barrier
    s_barrier
    s_barrier
    s_barrier
    s_barrier
    s_barrier
    s_barrier
    s_branch L_k1_kernel_exit
L_k1_kernel_kg_2:
    s_cmp_ge_u32 s49, 9
    s_cbranch_scc1 L_k1_kernel_ut_1
    s_sub_u32 s20, s2, 192
    s_mul_i32 s20, s20, 9
    s_add_u32 s20, s20, s49
    s_mul_i32 s21, s49, 13568
    s_load_dwordx8 s[44:51], s[0:1], 8
    s_load_dwordx4 s[52:55], s[0:1], 40
    s_load_dwordx2 s[56:57], s[0:1], 96
    v_lshlrev_b32 v3, 1, v2
    s_lshl_b32 s22, s20, 8
    s_lshl_b32 s23, s20, 1
    v_mov_b32 v4, s23
    s_waitcnt lgkmcnt(0)
    s_mov_b32 s24, s44
    s_and_b32 s25, s45, 0xffff
    s_mov_b32 s26, 147456
    s_mov_b32 s27, 0x00020000
    s_mov_b32 s28, s46
    s_and_b32 s29, s47, 0xffff
    s_mov_b32 s30, 147456
    s_mov_b32 s31, 0x00020000
    s_mov_b32 s32, s48
    s_and_b32 s33, s49, 0xffff
    s_mov_b32 s34, 147456
    s_mov_b32 s35, 0x00020000
    s_mov_b32 s36, s50
    s_and_b32 s37, s51, 0xffff
    s_mov_b32 s38, 147456
    s_mov_b32 s39, 0x00020000
    s_mov_b32 s40, s52
    s_and_b32 s41, s53, 0xffff
    s_mov_b32 s42, 1152
    s_mov_b32 s43, 0x00020000
    s_mov_b32 s16, s54
    s_and_b32 s17, s55, 0xffff
    s_mov_b32 s18, 1152
    s_mov_b32 s19, 0x00020000
    s_mov_b32 s54, s56
    s_mov_b32 s55, s57
    buffer_load_ushort v33, v4, s[16:19], 0 offen
    buffer_load_ushort v5, v4, s[40:43], 0 offen
    buffer_load_ushort v8, v3, s[24:27], s22 offen offset:0
    buffer_load_ushort v9, v3, s[24:27], s22 offen offset:128
    buffer_load_ushort v10, v3, s[28:31], s22 offen offset:0
    buffer_load_ushort v11, v3, s[28:31], s22 offen offset:128
    buffer_load_ushort v12, v3, s[32:35], s22 offen offset:0
    buffer_load_ushort v13, v3, s[32:35], s22 offen offset:128
    buffer_load_ushort v14, v3, s[36:39], s22 offen offset:0
    buffer_load_ushort v15, v3, s[36:39], s22 offen offset:128
    v_lshlrev_b32 v6, 2, v2
    v_add_u32 v6, s21, v6
    v_xor_b32 v16, 0, v6
    v_xor_b32 v17, 16, v6
    v_xor_b32 v18, 32, v6
    v_xor_b32 v19, 48, v6
    v_xor_b32 v20, 64, v6
    v_xor_b32 v21, 80, v6
    v_xor_b32 v22, 96, v6
    v_xor_b32 v23, 112, v6
    v_xor_b32 v24, 128, v6
    v_xor_b32 v25, 144, v6
    v_xor_b32 v26, 160, v6
    v_xor_b32 v27, 176, v6
    v_xor_b32 v28, 192, v6
    v_xor_b32 v29, 208, v6
    v_xor_b32 v30, 224, v6
    v_xor_b32 v31, 240, v6
    v_and_b32 v6, 31, v2
    v_lshrrev_b32 v7, 5, v2
    v_bfe_u32 v32, v6, 1, 4
    v_xor_b32 v32, v32, v7
    v_lshlrev_b32 v32, 4, v32
    v_lshl_add_u32 v32, v6, 8, v32
    v_add_u32 v32, s21, v32
    s_waitcnt vmcnt(0)
    v_lshlrev_b32 v5, 16, v5
    v_mul_f32 v5, 1069066811, v5
    v_exp_f32 v5, v5
    s_nop 0
    v_cvt_pk_bf16_f32 v5, v5, v5
    v_lshlrev_b32 v5, 16, v5
    s_setprio 3
    v_lshlrev_b32 v36, 16, v8
    v_mul_f32 v36, 1069066811, v36
    v_exp_f32 v36, v36
    v_lshlrev_b32 v37, 16, v10
    v_lshlrev_b32 v58, 16, v12
    v_cvt_pk_bf16_f32 v36, v36, v36
    v_lshlrev_b32 v36, 16, v36
    v_mul_f32 v36, v36, v5
    v_mul_f32 v37, v37, v5
    v_mul_f32 v40, 3216550459, v36
    v_mul_f32 v41, 1042479491, v37
    v_lshlrev_b32 v59, 16, v14
    v_mul_f32 v58, v58, v5
    v_mul_f32 v59, v59, v5
    v_add_f32 v58, v58, v58
    v_add_f32 v59, v59, v59
    v_mul_f32 v36, 1065353216, v40
    v_mul_f32 v37, 1065353216, v41
    v_exp_f32 v36, v36
    v_fract_f32 v37, v37
    v_cos_f32 v38, v37
    v_sin_f32 v39, v37
    s_nop 0
    v_mul_f32 v42, v36, v38
    v_mul_f32 v43, v36, v39
    v_mul_f32 v36, 1090519040, v40
    v_mul_f32 v37, 1090519040, v41
    v_exp_f32 v36, v36
    v_fract_f32 v37, v37
    v_cos_f32 v38, v37
    v_sin_f32 v39, v37
    s_nop 0
    v_mul_f32 v48, v36, v38
    v_mul_f32 v49, v36, v39
    v_mul_f32 v36, 1132462080, v40
    v_mul_f32 v37, 1132462080, v41
    v_exp_f32 v36, v36
    v_fract_f32 v37, v37
    v_cos_f32 v38, v37
    v_sin_f32 v39, v37
    s_nop 0
    v_mul_f32 v50, v36, v38
    v_mul_f32 v51, v36, v39
    v_mul_f32 v36, v43, v43
    v_mul_f32 v37, v43, v42
    v_fma_f32 v44, v42, v42, -v36
    v_fma_f32 v45, v42, v43, v37
    v_mul_f32 v36, v45, v45
    v_mul_f32 v37, v45, v44
    v_fma_f32 v46, v44, v44, -v36
    v_fma_f32 v47, v44, v45, v37
    v_mul_f32 v36, v51, v51
    v_mul_f32 v37, v51, v50
    v_fma_f32 v52, v50, v50, -v36
    v_fma_f32 v53, v50, v51, v37
    v_mul_f32 v36, v53, v51
    v_mul_f32 v37, v53, v50
    v_fma_f32 v54, v52, v50, -v36
    v_fma_f32 v55, v52, v51, v37
    v_mul_f32 v36, v53, v53
    v_mul_f32 v37, v53, v52
    v_fma_f32 v56, v52, v52, -v36
    v_fma_f32 v57, v52, v53, v37
    v_mov_b32 v64, 1.0
    v_mov_b32 v65, 0
    v_cvt_pk_bf16_f32 v74, v64, v65
    v_cvt_pk_bf16_f32 v72, v58, -v59
    v_mov_b32 v66, v48
    v_mov_b32 v67, v49
    v_cvt_pk_bf16_f32 v75, v66, v67
    ds_write2st64_b32 v16, v74, v75 offset0:21 offset1:22
    v_mul_f32 v76, v67, v49
    v_mul_f32 v77, v67, v48
    v_fma_f32 v64, v66, v48, -v76
    v_fma_f32 v65, v66, v49, v77
    v_cvt_pk_bf16_f32 v74, v64, v65
    v_mul_f32 v78, v59, v43
    v_mul_f32 v79, v59, v42
    v_fma_f32 v62, v58, v42, -v78
    v_fma_f32 v63, v58, v43, v79
    v_cvt_pk_bf16_f32 v73, v62, -v63
    ds_write2st64_b32 v16, v72, v73 offset0:0 offset1:1
    v_mul_f32 v76, v65, v49
    v_mul_f32 v77, v65, v48
    v_fma_f32 v66, v64, v48, -v76
    v_fma_f32 v67, v64, v49, v77
    v_cvt_pk_bf16_f32 v75, v66, v67
    ds_write2st64_b32 v17, v74, v75 offset0:23 offset1:24
    v_mul_f32 v76, v67, v49
    v_mul_f32 v77, v67, v48
    v_fma_f32 v64, v66, v48, -v76
    v_fma_f32 v65, v66, v49, v77
    v_cvt_pk_bf16_f32 v74, v64, v65
    v_mul_f32 v78, v63, v43
    v_mul_f32 v79, v63, v42
    v_fma_f32 v60, v62, v42, -v78
    v_fma_f32 v61, v62, v43, v79
    v_cvt_pk_bf16_f32 v72, v60, -v61
    v_mul_f32 v76, v65, v49
    v_mul_f32 v77, v65, v48
    v_fma_f32 v66, v64, v48, -v76
    v_fma_f32 v67, v64, v49, v77
    v_cvt_pk_bf16_f32 v75, v66, v67
    ds_write2st64_b32 v18, v74, v75 offset0:25 offset1:26
    v_mul_f32 v78, v61, v43
    v_mul_f32 v79, v61, v42
    v_fma_f32 v62, v60, v42, -v78
    v_fma_f32 v63, v60, v43, v79
    v_cvt_pk_bf16_f32 v73, v62, -v63
    ds_write2st64_b32 v17, v72, v73 offset0:2 offset1:3
    v_mul_f32 v76, v67, v49
    v_mul_f32 v77, v67, v48
    v_fma_f32 v64, v66, v48, -v76
    v_fma_f32 v65, v66, v49, v77
    v_cvt_pk_bf16_f32 v74, v64, v65
    v_mul_f32 v76, v65, v49
    v_mul_f32 v77, v65, v48
    v_fma_f32 v66, v64, v48, -v76
    v_fma_f32 v67, v64, v49, v77
    v_cvt_pk_bf16_f32 v75, v66, v67
    ds_write2st64_b32 v19, v74, v75 offset0:27 offset1:28
    v_mul_f32 v78, v63, v43
    v_mul_f32 v79, v63, v42
    v_fma_f32 v60, v62, v42, -v78
    v_fma_f32 v61, v62, v43, v79
    v_cvt_pk_bf16_f32 v72, v60, -v61
    v_mul_f32 v76, v67, v49
    v_mul_f32 v77, v67, v48
    v_fma_f32 v64, v66, v48, -v76
    v_fma_f32 v65, v66, v49, v77
    v_cvt_pk_bf16_f32 v74, v64, v65
    v_mul_f32 v78, v61, v43
    v_mul_f32 v79, v61, v42
    v_fma_f32 v62, v60, v42, -v78
    v_fma_f32 v63, v60, v43, v79
    v_cvt_pk_bf16_f32 v73, v62, -v63
    ds_write2st64_b32 v18, v72, v73 offset0:4 offset1:5
    v_mul_f32 v76, v65, v49
    v_mul_f32 v77, v65, v48
    v_fma_f32 v66, v64, v48, -v76
    v_fma_f32 v67, v64, v49, v77
    v_cvt_pk_bf16_f32 v75, v66, v67
    ds_write2st64_b32 v20, v74, v75 offset0:29 offset1:30
    v_mul_f32 v76, v67, v49
    v_mul_f32 v77, v67, v48
    v_fma_f32 v64, v66, v48, -v76
    v_fma_f32 v65, v66, v49, v77
    v_cvt_pk_bf16_f32 v74, v64, v65
    v_mul_f32 v78, v63, v43
    v_mul_f32 v79, v63, v42
    v_fma_f32 v60, v62, v42, -v78
    v_fma_f32 v61, v62, v43, v79
    v_cvt_pk_bf16_f32 v72, v60, -v61
    v_mul_f32 v76, v65, v49
    v_mul_f32 v77, v65, v48
    v_fma_f32 v66, v64, v48, -v76
    v_fma_f32 v67, v64, v49, v77
    v_cvt_pk_bf16_f32 v75, v66, v67
    ds_write2st64_b32 v21, v74, v75 offset0:31 offset1:32
    v_mul_f32 v78, v61, v43
    v_mul_f32 v79, v61, v42
    v_fma_f32 v62, v60, v42, -v78
    v_fma_f32 v63, v60, v43, v79
    v_cvt_pk_bf16_f32 v73, v62, -v63
    ds_write2st64_b32 v19, v72, v73 offset0:6 offset1:7
    v_mul_f32 v76, v67, v49
    v_mul_f32 v77, v67, v48
    v_fma_f32 v64, v66, v48, -v76
    v_fma_f32 v65, v66, v49, v77
    v_cvt_pk_bf16_f32 v74, v64, v65
    v_mul_f32 v76, v65, v49
    v_mul_f32 v77, v65, v48
    v_fma_f32 v66, v64, v48, -v76
    v_fma_f32 v67, v64, v49, v77
    v_cvt_pk_bf16_f32 v75, v66, v67
    ds_write2st64_b32 v22, v74, v75 offset0:33 offset1:34
    v_mul_f32 v78, v59, v51
    v_mul_f32 v79, v59, v50
    v_fma_f32 v60, v58, v50, -v78
    v_fma_f32 v61, v58, v51, v79
    v_cvt_pk_bf16_f32 v72, v60, -v61
    v_mul_f32 v76, v67, v49
    v_mul_f32 v77, v67, v48
    v_fma_f32 v64, v66, v48, -v76
    v_fma_f32 v65, v66, v49, v77
    v_cvt_pk_bf16_f32 v74, v64, v65
    v_mul_f32 v78, v61, v45
    v_mul_f32 v79, v61, v44
    v_fma_f32 v62, v60, v44, -v78
    v_fma_f32 v63, v60, v45, v79
    v_cvt_pk_bf16_f32 v73, v62, -v63
    ds_write2st64_b32 v20, v72, v73 offset0:8 offset1:9
    v_mul_f32 v76, v65, v49
    v_mul_f32 v77, v65, v48
    v_fma_f32 v66, v64, v48, -v76
    v_fma_f32 v67, v64, v49, v77
    v_cvt_pk_bf16_f32 v75, v66, v67
    ds_write2st64_b32 v23, v74, v75 offset0:35 offset1:36
    v_mul_f32 v76, v67, v49
    v_mul_f32 v77, v67, v48
    v_fma_f32 v64, v66, v48, -v76
    v_fma_f32 v65, v66, v49, v77
    v_cvt_pk_bf16_f32 v74, v64, v65
    v_mul_f32 v78, v63, v45
    v_mul_f32 v79, v63, v44
    v_fma_f32 v60, v62, v44, -v78
    v_fma_f32 v61, v62, v45, v79
    v_cvt_pk_bf16_f32 v72, v60, -v61
    v_mul_f32 v76, v65, v49
    v_mul_f32 v77, v65, v48
    v_fma_f32 v66, v64, v48, -v76
    v_fma_f32 v67, v64, v49, v77
    v_cvt_pk_bf16_f32 v75, v66, v67
    ds_write2st64_b32 v24, v74, v75 offset0:37 offset1:38
    v_mul_f32 v78, v61, v45
    v_mul_f32 v79, v61, v44
    v_fma_f32 v62, v60, v44, -v78
    v_fma_f32 v63, v60, v45, v79
    v_cvt_pk_bf16_f32 v73, v62, -v63
    ds_write2st64_b32 v21, v72, v73 offset0:10 offset1:11
    v_mul_f32 v76, v67, v49
    v_mul_f32 v77, v67, v48
    v_fma_f32 v64, v66, v48, -v76
    v_fma_f32 v65, v66, v49, v77
    v_cvt_pk_bf16_f32 v74, v64, v65
    v_mul_f32 v76, v65, v49
    v_mul_f32 v77, v65, v48
    v_fma_f32 v66, v64, v48, -v76
    v_fma_f32 v67, v64, v49, v77
    v_cvt_pk_bf16_f32 v75, v66, v67
    ds_write2st64_b32 v25, v74, v75 offset0:39 offset1:40
    v_mul_f32 v78, v59, v53
    v_mul_f32 v79, v59, v52
    v_fma_f32 v60, v58, v52, -v78
    v_fma_f32 v61, v58, v53, v79
    v_cvt_pk_bf16_f32 v72, v60, -v61
    v_mul_f32 v76, v67, v49
    v_mul_f32 v77, v67, v48
    v_fma_f32 v64, v66, v48, -v76
    v_fma_f32 v65, v66, v49, v77
    v_cvt_pk_bf16_f32 v74, v64, v65
    v_mul_f32 v78, v61, v47
    v_mul_f32 v79, v61, v46
    v_fma_f32 v62, v60, v46, -v78
    v_fma_f32 v63, v60, v47, v79
    v_cvt_pk_bf16_f32 v73, v62, -v63
    ds_write2st64_b32 v22, v72, v73 offset0:12 offset1:13
    v_mul_f32 v76, v65, v49
    v_mul_f32 v77, v65, v48
    v_fma_f32 v66, v64, v48, -v76
    v_fma_f32 v67, v64, v49, v77
    v_cvt_pk_bf16_f32 v75, v66, v67
    ds_write2st64_b32 v26, v74, v75 offset0:41 offset1:42
    v_mul_f32 v76, v67, v49
    v_mul_f32 v77, v67, v48
    v_fma_f32 v64, v66, v48, -v76
    v_fma_f32 v65, v66, v49, v77
    v_cvt_pk_bf16_f32 v74, v64, v65
    v_mul_f32 v78, v59, v55
    v_mul_f32 v79, v59, v54
    v_fma_f32 v60, v58, v54, -v78
    v_fma_f32 v61, v58, v55, v79
    v_cvt_pk_bf16_f32 v72, v60, -v61
    v_mul_f32 v76, v65, v49
    v_mul_f32 v77, v65, v48
    v_fma_f32 v66, v64, v48, -v76
    v_fma_f32 v67, v64, v49, v77
    v_cvt_pk_bf16_f32 v75, v66, v67
    ds_write2st64_b32 v27, v74, v75 offset0:43 offset1:44
    v_mul_f32 v78, v61, v47
    v_mul_f32 v79, v61, v46
    v_fma_f32 v62, v60, v46, -v78
    v_fma_f32 v63, v60, v47, v79
    v_cvt_pk_bf16_f32 v73, v62, -v63
    ds_write2st64_b32 v23, v72, v73 offset0:14 offset1:15
    v_mul_f32 v76, v67, v49
    v_mul_f32 v77, v67, v48
    v_fma_f32 v64, v66, v48, -v76
    v_fma_f32 v65, v66, v49, v77
    v_cvt_pk_bf16_f32 v74, v64, v65
    v_mul_f32 v76, v65, v49
    v_mul_f32 v77, v65, v48
    v_fma_f32 v66, v64, v48, -v76
    v_fma_f32 v67, v64, v49, v77
    v_cvt_pk_bf16_f32 v75, v66, v67
    ds_write2st64_b32 v28, v74, v75 offset0:45 offset1:46
    v_mul_f32 v78, v59, v57
    v_mul_f32 v79, v59, v56
    v_fma_f32 v60, v58, v56, -v78
    v_fma_f32 v61, v58, v57, v79
    v_cvt_pk_bf16_f32 v72, v60, -v61
    v_mul_f32 v76, v67, v49
    v_mul_f32 v77, v67, v48
    v_fma_f32 v64, v66, v48, -v76
    v_fma_f32 v65, v66, v49, v77
    v_cvt_pk_bf16_f32 v74, v64, v65
    v_mul_f32 v78, v61, v51
    v_mul_f32 v79, v61, v50
    v_fma_f32 v62, v60, v50, -v78
    v_fma_f32 v63, v60, v51, v79
    v_cvt_pk_bf16_f32 v73, v62, -v63
    ds_write2st64_b32 v24, v72, v73 offset0:16 offset1:17
    v_mul_f32 v76, v65, v49
    v_mul_f32 v77, v65, v48
    v_fma_f32 v66, v64, v48, -v76
    v_fma_f32 v67, v64, v49, v77
    v_cvt_pk_bf16_f32 v75, v66, v67
    ds_write2st64_b32 v29, v74, v75 offset0:47 offset1:48
    v_mul_f32 v76, v67, v49
    v_mul_f32 v77, v67, v48
    v_fma_f32 v64, v66, v48, -v76
    v_fma_f32 v65, v66, v49, v77
    v_cvt_pk_bf16_f32 v74, v64, v65
    v_mul_f32 v78, v61, v53
    v_mul_f32 v79, v61, v52
    v_fma_f32 v68, v60, v52, -v78
    v_fma_f32 v69, v60, v53, v79
    v_cvt_pk_bf16_f32 v72, v68, -v69
    v_mul_f32 v76, v65, v49
    v_mul_f32 v77, v65, v48
    v_fma_f32 v66, v64, v48, -v76
    v_fma_f32 v67, v64, v49, v77
    v_cvt_pk_bf16_f32 v75, v66, v67
    ds_write2st64_b32 v30, v74, v75 offset0:49 offset1:50
    v_mul_f32 v78, v61, v55
    v_mul_f32 v79, v61, v54
    v_fma_f32 v62, v60, v54, -v78
    v_fma_f32 v63, v60, v55, v79
    v_cvt_pk_bf16_f32 v73, v62, -v63
    ds_write2st64_b32 v25, v72, v73 offset0:18 offset1:19
    v_mul_f32 v76, v67, v49
    v_mul_f32 v77, v67, v48
    v_fma_f32 v64, v66, v48, -v76
    v_fma_f32 v65, v66, v49, v77
    v_cvt_pk_bf16_f32 v74, v64, v65
    v_mul_f32 v76, v65, v49
    v_mul_f32 v77, v65, v48
    v_fma_f32 v66, v64, v48, -v76
    v_fma_f32 v67, v64, v49, v77
    v_cvt_pk_bf16_f32 v75, v66, v67
    ds_write2st64_b32 v31, v74, v75 offset0:51 offset1:52
    v_mul_f32 v78, v61, v57
    v_mul_f32 v79, v61, v56
    v_fma_f32 v68, v60, v56, -v78
    v_fma_f32 v69, v60, v57, v79
    v_cvt_pk_bf16_f32 v72, v68, -v69
    ds_write_b32 v26, v72 offset:5120
    s_waitcnt lgkmcnt(0)
    v_xor_b32 v36, 0, v32
    ds_read_b128 v[80:83], v36
    ds_read_b128 v[96:99], v36 offset:5376
    v_xor_b32 v36, 32, v32
    ds_read_b128 v[84:87], v36
    ds_read_b128 v[100:103], v36 offset:5376
    v_xor_b32 v36, 64, v32
    ds_read_b128 v[88:91], v36
    ds_read_b128 v[104:107], v36 offset:5376
    v_xor_b32 v36, 96, v32
    ds_read_b128 v[92:95], v36
    ds_read_b128 v[108:111], v36 offset:5376
    s_waitcnt lgkmcnt(0)
    v_mfma_f32_32x32x16_bf16 v[112:127], v[80:83], v[96:99], 0
    v_mfma_f32_32x32x16_bf16 v[112:127], v[84:87], v[100:103], v[112:127]
    v_mfma_f32_32x32x16_bf16 v[112:127], v[88:91], v[104:107], v[112:127]
    v_mfma_f32_32x32x16_bf16 v[112:127], v[92:95], v[108:111], v[112:127]
    v_xor_b32 v36, 128, v32
    ds_read_b128 v[80:83], v36
    ds_read_b128 v[96:99], v36 offset:5376
    v_xor_b32 v36, 160, v32
    ds_read_b128 v[84:87], v36
    ds_read_b128 v[100:103], v36 offset:5376
    v_xor_b32 v36, 192, v32
    ds_read_b128 v[88:91], v36
    ds_read_b128 v[104:107], v36 offset:5376
    v_xor_b32 v36, 224, v32
    ds_read_b128 v[92:95], v36
    ds_read_b128 v[108:111], v36 offset:5376
    s_waitcnt lgkmcnt(0)
    v_mfma_f32_32x32x16_bf16 v[112:127], v[80:83], v[96:99], v[112:127]
    v_mfma_f32_32x32x16_bf16 v[112:127], v[84:87], v[100:103], v[112:127]
    v_mfma_f32_32x32x16_bf16 v[112:127], v[88:91], v[104:107], v[112:127]
    v_mfma_f32_32x32x16_bf16 v[112:127], v[92:95], v[108:111], v[112:127]
    s_setprio 2
    v_lshlrev_b32 v36, 16, v9
    v_mul_f32 v36, 1069066811, v36
    v_exp_f32 v36, v36
    v_lshlrev_b32 v37, 16, v11
    v_lshlrev_b32 v58, 16, v13
    v_cvt_pk_bf16_f32 v36, v36, v36
    v_lshlrev_b32 v36, 16, v36
    v_mul_f32 v36, v36, v5
    v_mul_f32 v37, v37, v5
    v_mul_f32 v40, 3216550459, v36
    v_mul_f32 v41, 1042479491, v37
    v_lshlrev_b32 v59, 16, v15
    v_mul_f32 v58, v58, v5
    v_mul_f32 v59, v59, v5
    v_add_f32 v58, v58, v58
    v_add_f32 v59, v59, v59
    v_mul_f32 v36, 1065353216, v40
    v_mul_f32 v37, 1065353216, v41
    v_exp_f32 v36, v36
    v_fract_f32 v37, v37
    v_cos_f32 v38, v37
    v_sin_f32 v39, v37
    s_nop 0
    v_mul_f32 v42, v36, v38
    v_mul_f32 v43, v36, v39
    v_mul_f32 v36, 1090519040, v40
    v_mul_f32 v37, 1090519040, v41
    v_exp_f32 v36, v36
    v_fract_f32 v37, v37
    v_cos_f32 v38, v37
    v_sin_f32 v39, v37
    s_nop 0
    v_mul_f32 v48, v36, v38
    v_mul_f32 v49, v36, v39
    v_mul_f32 v36, 1132462080, v40
    v_mul_f32 v37, 1132462080, v41
    v_exp_f32 v36, v36
    v_fract_f32 v37, v37
    v_cos_f32 v38, v37
    v_sin_f32 v39, v37
    s_nop 0
    v_mul_f32 v50, v36, v38
    v_mul_f32 v51, v36, v39
    v_mul_f32 v36, v43, v43
    v_mul_f32 v37, v43, v42
    v_fma_f32 v44, v42, v42, -v36
    v_fma_f32 v45, v42, v43, v37
    v_mul_f32 v36, v45, v45
    v_mul_f32 v37, v45, v44
    v_fma_f32 v46, v44, v44, -v36
    v_fma_f32 v47, v44, v45, v37
    v_mul_f32 v36, v51, v51
    v_mul_f32 v37, v51, v50
    v_fma_f32 v52, v50, v50, -v36
    v_fma_f32 v53, v50, v51, v37
    v_mul_f32 v36, v53, v51
    v_mul_f32 v37, v53, v50
    v_fma_f32 v54, v52, v50, -v36
    v_fma_f32 v55, v52, v51, v37
    v_mul_f32 v36, v53, v53
    v_mul_f32 v37, v53, v52
    v_fma_f32 v56, v52, v52, -v36
    v_fma_f32 v57, v52, v53, v37
    v_mov_b32 v64, 1.0
    v_mov_b32 v65, 0
    v_cvt_pk_bf16_f32 v74, v64, v65
    v_cvt_pk_bf16_f32 v72, v58, -v59
    v_mov_b32 v66, v48
    v_mov_b32 v67, v49
    v_cvt_pk_bf16_f32 v75, v66, v67
    ds_write2st64_b32 v16, v74, v75 offset0:21 offset1:22
    v_mul_f32 v76, v67, v49
    v_mul_f32 v77, v67, v48
    v_fma_f32 v64, v66, v48, -v76
    v_fma_f32 v65, v66, v49, v77
    v_cvt_pk_bf16_f32 v74, v64, v65
    v_mul_f32 v78, v59, v43
    v_mul_f32 v79, v59, v42
    v_fma_f32 v62, v58, v42, -v78
    v_fma_f32 v63, v58, v43, v79
    v_cvt_pk_bf16_f32 v73, v62, -v63
    ds_write2st64_b32 v16, v72, v73 offset0:0 offset1:1
    v_mul_f32 v76, v65, v49
    v_mul_f32 v77, v65, v48
    v_fma_f32 v66, v64, v48, -v76
    v_fma_f32 v67, v64, v49, v77
    v_cvt_pk_bf16_f32 v75, v66, v67
    ds_write2st64_b32 v17, v74, v75 offset0:23 offset1:24
    v_mul_f32 v76, v67, v49
    v_mul_f32 v77, v67, v48
    v_fma_f32 v64, v66, v48, -v76
    v_fma_f32 v65, v66, v49, v77
    v_cvt_pk_bf16_f32 v74, v64, v65
    v_mul_f32 v78, v63, v43
    v_mul_f32 v79, v63, v42
    v_fma_f32 v60, v62, v42, -v78
    v_fma_f32 v61, v62, v43, v79
    v_cvt_pk_bf16_f32 v72, v60, -v61
    v_mul_f32 v76, v65, v49
    v_mul_f32 v77, v65, v48
    v_fma_f32 v66, v64, v48, -v76
    v_fma_f32 v67, v64, v49, v77
    v_cvt_pk_bf16_f32 v75, v66, v67
    ds_write2st64_b32 v18, v74, v75 offset0:25 offset1:26
    v_mul_f32 v78, v61, v43
    v_mul_f32 v79, v61, v42
    v_fma_f32 v62, v60, v42, -v78
    v_fma_f32 v63, v60, v43, v79
    v_cvt_pk_bf16_f32 v73, v62, -v63
    ds_write2st64_b32 v17, v72, v73 offset0:2 offset1:3
    v_mul_f32 v76, v67, v49
    v_mul_f32 v77, v67, v48
    v_fma_f32 v64, v66, v48, -v76
    v_fma_f32 v65, v66, v49, v77
    v_cvt_pk_bf16_f32 v74, v64, v65
    v_mul_f32 v76, v65, v49
    v_mul_f32 v77, v65, v48
    v_fma_f32 v66, v64, v48, -v76
    v_fma_f32 v67, v64, v49, v77
    v_cvt_pk_bf16_f32 v75, v66, v67
    ds_write2st64_b32 v19, v74, v75 offset0:27 offset1:28
    v_mul_f32 v78, v63, v43
    v_mul_f32 v79, v63, v42
    v_fma_f32 v60, v62, v42, -v78
    v_fma_f32 v61, v62, v43, v79
    v_cvt_pk_bf16_f32 v72, v60, -v61
    v_mul_f32 v76, v67, v49
    v_mul_f32 v77, v67, v48
    v_fma_f32 v64, v66, v48, -v76
    v_fma_f32 v65, v66, v49, v77
    v_cvt_pk_bf16_f32 v74, v64, v65
    v_mul_f32 v78, v61, v43
    v_mul_f32 v79, v61, v42
    v_fma_f32 v62, v60, v42, -v78
    v_fma_f32 v63, v60, v43, v79
    v_cvt_pk_bf16_f32 v73, v62, -v63
    ds_write2st64_b32 v18, v72, v73 offset0:4 offset1:5
    v_mul_f32 v76, v65, v49
    v_mul_f32 v77, v65, v48
    v_fma_f32 v66, v64, v48, -v76
    v_fma_f32 v67, v64, v49, v77
    v_cvt_pk_bf16_f32 v75, v66, v67
    ds_write2st64_b32 v20, v74, v75 offset0:29 offset1:30
    v_mul_f32 v76, v67, v49
    v_mul_f32 v77, v67, v48
    v_fma_f32 v64, v66, v48, -v76
    v_fma_f32 v65, v66, v49, v77
    v_cvt_pk_bf16_f32 v74, v64, v65
    v_mul_f32 v78, v63, v43
    v_mul_f32 v79, v63, v42
    v_fma_f32 v60, v62, v42, -v78
    v_fma_f32 v61, v62, v43, v79
    v_cvt_pk_bf16_f32 v72, v60, -v61
    v_mul_f32 v76, v65, v49
    v_mul_f32 v77, v65, v48
    v_fma_f32 v66, v64, v48, -v76
    v_fma_f32 v67, v64, v49, v77
    v_cvt_pk_bf16_f32 v75, v66, v67
    ds_write2st64_b32 v21, v74, v75 offset0:31 offset1:32
    v_mul_f32 v78, v61, v43
    v_mul_f32 v79, v61, v42
    v_fma_f32 v62, v60, v42, -v78
    v_fma_f32 v63, v60, v43, v79
    v_cvt_pk_bf16_f32 v73, v62, -v63
    ds_write2st64_b32 v19, v72, v73 offset0:6 offset1:7
    v_mul_f32 v76, v67, v49
    v_mul_f32 v77, v67, v48
    v_fma_f32 v64, v66, v48, -v76
    v_fma_f32 v65, v66, v49, v77
    v_cvt_pk_bf16_f32 v74, v64, v65
    v_mul_f32 v76, v65, v49
    v_mul_f32 v77, v65, v48
    v_fma_f32 v66, v64, v48, -v76
    v_fma_f32 v67, v64, v49, v77
    v_cvt_pk_bf16_f32 v75, v66, v67
    ds_write2st64_b32 v22, v74, v75 offset0:33 offset1:34
    v_mul_f32 v78, v59, v51
    v_mul_f32 v79, v59, v50
    v_fma_f32 v60, v58, v50, -v78
    v_fma_f32 v61, v58, v51, v79
    v_cvt_pk_bf16_f32 v72, v60, -v61
    v_mul_f32 v76, v67, v49
    v_mul_f32 v77, v67, v48
    v_fma_f32 v64, v66, v48, -v76
    v_fma_f32 v65, v66, v49, v77
    v_cvt_pk_bf16_f32 v74, v64, v65
    v_mul_f32 v78, v61, v45
    v_mul_f32 v79, v61, v44
    v_fma_f32 v62, v60, v44, -v78
    v_fma_f32 v63, v60, v45, v79
    v_cvt_pk_bf16_f32 v73, v62, -v63
    ds_write2st64_b32 v20, v72, v73 offset0:8 offset1:9
    v_mul_f32 v76, v65, v49
    v_mul_f32 v77, v65, v48
    v_fma_f32 v66, v64, v48, -v76
    v_fma_f32 v67, v64, v49, v77
    v_cvt_pk_bf16_f32 v75, v66, v67
    ds_write2st64_b32 v23, v74, v75 offset0:35 offset1:36
    v_mul_f32 v76, v67, v49
    v_mul_f32 v77, v67, v48
    v_fma_f32 v64, v66, v48, -v76
    v_fma_f32 v65, v66, v49, v77
    v_cvt_pk_bf16_f32 v74, v64, v65
    v_mul_f32 v78, v63, v45
    v_mul_f32 v79, v63, v44
    v_fma_f32 v60, v62, v44, -v78
    v_fma_f32 v61, v62, v45, v79
    v_cvt_pk_bf16_f32 v72, v60, -v61
    v_mul_f32 v76, v65, v49
    v_mul_f32 v77, v65, v48
    v_fma_f32 v66, v64, v48, -v76
    v_fma_f32 v67, v64, v49, v77
    v_cvt_pk_bf16_f32 v75, v66, v67
    ds_write2st64_b32 v24, v74, v75 offset0:37 offset1:38
    v_mul_f32 v78, v61, v45
    v_mul_f32 v79, v61, v44
    v_fma_f32 v62, v60, v44, -v78
    v_fma_f32 v63, v60, v45, v79
    v_cvt_pk_bf16_f32 v73, v62, -v63
    ds_write2st64_b32 v21, v72, v73 offset0:10 offset1:11
    v_mul_f32 v76, v67, v49
    v_mul_f32 v77, v67, v48
    v_fma_f32 v64, v66, v48, -v76
    v_fma_f32 v65, v66, v49, v77
    v_cvt_pk_bf16_f32 v74, v64, v65
    v_mul_f32 v76, v65, v49
    v_mul_f32 v77, v65, v48
    v_fma_f32 v66, v64, v48, -v76
    v_fma_f32 v67, v64, v49, v77
    v_cvt_pk_bf16_f32 v75, v66, v67
    ds_write2st64_b32 v25, v74, v75 offset0:39 offset1:40
    v_mul_f32 v78, v59, v53
    v_mul_f32 v79, v59, v52
    v_fma_f32 v60, v58, v52, -v78
    v_fma_f32 v61, v58, v53, v79
    v_cvt_pk_bf16_f32 v72, v60, -v61
    v_mul_f32 v76, v67, v49
    v_mul_f32 v77, v67, v48
    v_fma_f32 v64, v66, v48, -v76
    v_fma_f32 v65, v66, v49, v77
    v_cvt_pk_bf16_f32 v74, v64, v65
    v_mul_f32 v78, v61, v47
    v_mul_f32 v79, v61, v46
    v_fma_f32 v62, v60, v46, -v78
    v_fma_f32 v63, v60, v47, v79
    v_cvt_pk_bf16_f32 v73, v62, -v63
    ds_write2st64_b32 v22, v72, v73 offset0:12 offset1:13
    v_mul_f32 v76, v65, v49
    v_mul_f32 v77, v65, v48
    v_fma_f32 v66, v64, v48, -v76
    v_fma_f32 v67, v64, v49, v77
    v_cvt_pk_bf16_f32 v75, v66, v67
    ds_write2st64_b32 v26, v74, v75 offset0:41 offset1:42
    v_mul_f32 v76, v67, v49
    v_mul_f32 v77, v67, v48
    v_fma_f32 v64, v66, v48, -v76
    v_fma_f32 v65, v66, v49, v77
    v_cvt_pk_bf16_f32 v74, v64, v65
    v_mul_f32 v78, v59, v55
    v_mul_f32 v79, v59, v54
    v_fma_f32 v60, v58, v54, -v78
    v_fma_f32 v61, v58, v55, v79
    v_cvt_pk_bf16_f32 v72, v60, -v61
    v_mul_f32 v76, v65, v49
    v_mul_f32 v77, v65, v48
    v_fma_f32 v66, v64, v48, -v76
    v_fma_f32 v67, v64, v49, v77
    v_cvt_pk_bf16_f32 v75, v66, v67
    ds_write2st64_b32 v27, v74, v75 offset0:43 offset1:44
    v_mul_f32 v78, v61, v47
    v_mul_f32 v79, v61, v46
    v_fma_f32 v62, v60, v46, -v78
    v_fma_f32 v63, v60, v47, v79
    v_cvt_pk_bf16_f32 v73, v62, -v63
    ds_write2st64_b32 v23, v72, v73 offset0:14 offset1:15
    v_mul_f32 v76, v67, v49
    v_mul_f32 v77, v67, v48
    v_fma_f32 v64, v66, v48, -v76
    v_fma_f32 v65, v66, v49, v77
    v_cvt_pk_bf16_f32 v74, v64, v65
    v_mul_f32 v76, v65, v49
    v_mul_f32 v77, v65, v48
    v_fma_f32 v66, v64, v48, -v76
    v_fma_f32 v67, v64, v49, v77
    v_cvt_pk_bf16_f32 v75, v66, v67
    ds_write2st64_b32 v28, v74, v75 offset0:45 offset1:46
    v_mul_f32 v78, v59, v57
    v_mul_f32 v79, v59, v56
    v_fma_f32 v60, v58, v56, -v78
    v_fma_f32 v61, v58, v57, v79
    v_cvt_pk_bf16_f32 v72, v60, -v61
    v_mul_f32 v76, v67, v49
    v_mul_f32 v77, v67, v48
    v_fma_f32 v64, v66, v48, -v76
    v_fma_f32 v65, v66, v49, v77
    v_cvt_pk_bf16_f32 v74, v64, v65
    v_mul_f32 v78, v61, v51
    v_mul_f32 v79, v61, v50
    v_fma_f32 v62, v60, v50, -v78
    v_fma_f32 v63, v60, v51, v79
    v_cvt_pk_bf16_f32 v73, v62, -v63
    ds_write2st64_b32 v24, v72, v73 offset0:16 offset1:17
    v_mul_f32 v76, v65, v49
    v_mul_f32 v77, v65, v48
    v_fma_f32 v66, v64, v48, -v76
    v_fma_f32 v67, v64, v49, v77
    v_cvt_pk_bf16_f32 v75, v66, v67
    ds_write2st64_b32 v29, v74, v75 offset0:47 offset1:48
    v_mul_f32 v76, v67, v49
    v_mul_f32 v77, v67, v48
    v_fma_f32 v64, v66, v48, -v76
    v_fma_f32 v65, v66, v49, v77
    v_cvt_pk_bf16_f32 v74, v64, v65
    v_mul_f32 v78, v61, v53
    v_mul_f32 v79, v61, v52
    v_fma_f32 v68, v60, v52, -v78
    v_fma_f32 v69, v60, v53, v79
    v_cvt_pk_bf16_f32 v72, v68, -v69
    v_mul_f32 v76, v65, v49
    v_mul_f32 v77, v65, v48
    v_fma_f32 v66, v64, v48, -v76
    v_fma_f32 v67, v64, v49, v77
    v_cvt_pk_bf16_f32 v75, v66, v67
    ds_write2st64_b32 v30, v74, v75 offset0:49 offset1:50
    v_mul_f32 v78, v61, v55
    v_mul_f32 v79, v61, v54
    v_fma_f32 v62, v60, v54, -v78
    v_fma_f32 v63, v60, v55, v79
    v_cvt_pk_bf16_f32 v73, v62, -v63
    ds_write2st64_b32 v25, v72, v73 offset0:18 offset1:19
    v_mul_f32 v76, v67, v49
    v_mul_f32 v77, v67, v48
    v_fma_f32 v64, v66, v48, -v76
    v_fma_f32 v65, v66, v49, v77
    v_cvt_pk_bf16_f32 v74, v64, v65
    v_mul_f32 v76, v65, v49
    v_mul_f32 v77, v65, v48
    v_fma_f32 v66, v64, v48, -v76
    v_fma_f32 v67, v64, v49, v77
    v_cvt_pk_bf16_f32 v75, v66, v67
    ds_write2st64_b32 v31, v74, v75 offset0:51 offset1:52
    v_mul_f32 v78, v61, v57
    v_mul_f32 v79, v61, v56
    v_fma_f32 v68, v60, v56, -v78
    v_fma_f32 v69, v60, v57, v79
    v_cvt_pk_bf16_f32 v72, v68, -v69
    ds_write_b32 v26, v72 offset:5120
    s_waitcnt lgkmcnt(0)
    v_xor_b32 v36, 0, v32
    ds_read_b128 v[80:83], v36
    ds_read_b128 v[96:99], v36 offset:5376
    v_xor_b32 v36, 32, v32
    ds_read_b128 v[84:87], v36
    ds_read_b128 v[100:103], v36 offset:5376
    v_xor_b32 v36, 64, v32
    ds_read_b128 v[88:91], v36
    ds_read_b128 v[104:107], v36 offset:5376
    v_xor_b32 v36, 96, v32
    ds_read_b128 v[92:95], v36
    ds_read_b128 v[108:111], v36 offset:5376
    s_waitcnt lgkmcnt(0)
    v_mfma_f32_32x32x16_bf16 v[112:127], v[80:83], v[96:99], v[112:127]
    v_mfma_f32_32x32x16_bf16 v[112:127], v[84:87], v[100:103], v[112:127]
    v_mfma_f32_32x32x16_bf16 v[112:127], v[88:91], v[104:107], v[112:127]
    v_mfma_f32_32x32x16_bf16 v[112:127], v[92:95], v[108:111], v[112:127]
    v_xor_b32 v36, 128, v32
    ds_read_b128 v[80:83], v36
    ds_read_b128 v[96:99], v36 offset:5376
    v_xor_b32 v36, 160, v32
    ds_read_b128 v[84:87], v36
    ds_read_b128 v[100:103], v36 offset:5376
    v_xor_b32 v36, 192, v32
    ds_read_b128 v[88:91], v36
    ds_read_b128 v[104:107], v36 offset:5376
    v_xor_b32 v36, 224, v32
    ds_read_b128 v[92:95], v36
    ds_read_b128 v[108:111], v36 offset:5376
    s_waitcnt lgkmcnt(0)
    v_mfma_f32_32x32x16_bf16 v[112:127], v[80:83], v[96:99], v[112:127]
    v_mfma_f32_32x32x16_bf16 v[112:127], v[84:87], v[100:103], v[112:127]
    v_mfma_f32_32x32x16_bf16 v[112:127], v[88:91], v[104:107], v[112:127]
    v_mfma_f32_32x32x16_bf16 v[112:127], v[92:95], v[108:111], v[112:127]
    s_setprio 1
    v_and_b32 v6, 31, v2
    v_lshrrev_b32 v7, 5, v2
    v_lshlrev_b32 v40, 4, v6
    v_lshl_add_u32 v40, v7, 3, v40
    v_add_u32 v40, s21, v40
    v_lshlrev_b32 v41, 3, v6
    v_add_u32 v41, 512, v41
    v_lshlrev_b32 v42, 2, v6
    v_add_u32 v42, 768, v42
    v_cmp_eq_u32 vcc, 1, v7
    v_mov_b32 v44, 4
    v_mov_b32 v45, 128
    v_cndmask_b32_e64 v41, v41, v42, vcc
    v_cndmask_b32_e64 v44, v44, v45, vcc
    v_add_u32 v41, s21, v41
    v_add_u32 v42, v41, v44
    v_lshlrev_b32 v43, 1, v6
    v_add_u32 v43, 1024, v43
    v_mov_b32 v45, 1400
    v_mov_b32 v46, 1280
    v_cmp_eq_u32 s[56:57], 0, v6
    s_nop 1
    v_cndmask_b32_e64 v45, v45, v46, s[56:57]
    v_cndmask_b32_e64 v43, v43, v45, vcc
    v_add_u32 v43, s21, v43
    s_nop 7
    v_lshlrev_b32 v33, 16, v33
    v_cmp_eq_u32 s[56:57], 0, v2
    v_mov_b32 v34, 0
    s_nop 0
    v_cndmask_b32_e64 v33, v34, v33, s[56:57]
    v_add_f32 v112, v112, v33
    v_cvt_pk_bf16_f32 v48, v112, v113
    v_cvt_pk_bf16_f32 v49, v114, v115
    v_cvt_pk_bf16_f32 v50, v116, v117
    v_cvt_pk_bf16_f32 v51, v118, v119
    v_cvt_pk_bf16_f32 v52, v120, v121
    v_cvt_pk_bf16_f32 v53, v122, v123
    ds_write_b16 v40, v48
    ds_write_b16_d16_hi v40, v48 offset:2
    ds_write_b16 v40, v49 offset:4
    ds_write_b16_d16_hi v40, v49 offset:6
    ds_write_b16 v41, v50
    ds_write_b16_d16_hi v41, v50 offset:2
    ds_write_b16 v42, v51
    ds_write_b16_d16_hi v42, v51 offset:2
    ds_write_b16 v43, v52
    ds_write_b16_d16_hi v43, v52 offset:64
    ds_write_b16 v43, v53 offset:128
    ds_write_b16_d16_hi v43, v53 offset:192
    v_lshlrev_b32 v6, 3, v2
    v_sub_u32 v6, 2047, v6
    v_add_u32 v40, -1, v6
    v_lshl_or_b32 v40, v40, 16, v6
    s_lshr_b32 s58, s21, 1
    v_cmp_gt_u32 s[56:57], 32, v2
    v_mov_b32 v41, 0
    v_mov_b32 v42, 0x00010001
    v_mov_b32 v43, s58
    v_add_u32 v44, 128, v43
    v_cndmask_b32_e64 v41, v41, v42, s[56:57]
    v_cndmask_b32_e64 v43, v43, v44, s[56:57]
    v_lshl_or_b32 v43, v43, 16, v43
    s_add_u32 s59, s58, 384
    s_lshl_b32 s57, s59, 16
    s_or_b32 s59, s59, s57
    s_add_u32 s58, s58, 256
    s_lshl_b32 s57, s58, 16
    s_or_b32 s58, s58, s57
    v_mov_b32 v45, s59
    v_mov_b32 v46, s58
    v_mov_b32 v47, 0x00030003
    v_mov_b32 v48, 0x00020002
    s_waitcnt lgkmcnt(0)
    s_setprio 0
    v_add_u32 v80, 0, v40
    v_lshrrev_b32 v81, 3, v80
    v_and_b32 v81, 0x00010001, v81
    v_add_u32 v80, 196611, v80
    v_add_u32 v80, v80, v81
    v_pk_lshrrev_b16 v80, v47, v80
    v_add_u32 v80, v80, v45
    v_add_u32 v81, v80, v80
    v_and_b32 v81, 0x1fffe, v81
    v_lshrrev_b32 v80, 15, v80
    v_and_b32 v80, 0x1fffe, v80
    ds_read_u16 v60, v81
    ds_read_u16_d16_hi v96, v80
    v_add_u32 v84, 4294836222, v40
    v_lshrrev_b32 v85, 3, v84
    v_and_b32 v85, 0x00010001, v85
    v_add_u32 v84, 196611, v84
    v_add_u32 v84, v84, v85
    v_pk_lshrrev_b16 v84, v47, v84
    v_add_u32 v84, v84, v45
    v_add_u32 v85, v84, v84
    v_and_b32 v85, 0x1fffe, v85
    v_lshrrev_b32 v84, 15, v84
    v_and_b32 v84, 0x1fffe, v84
    ds_read_u16 v61, v85
    ds_read_u16_d16_hi v97, v84
    v_add_u32 v88, 4294705148, v40
    v_lshrrev_b32 v89, 3, v88
    v_and_b32 v89, 0x00010001, v89
    v_add_u32 v88, 196611, v88
    v_add_u32 v88, v88, v89
    v_pk_lshrrev_b16 v88, v47, v88
    v_add_u32 v88, v88, v45
    v_add_u32 v89, v88, v88
    v_and_b32 v89, 0x1fffe, v89
    v_lshrrev_b32 v88, 15, v88
    v_and_b32 v88, 0x1fffe, v88
    ds_read_u16 v62, v89
    ds_read_u16_d16_hi v98, v88
    v_add_u32 v92, 4294574074, v40
    v_lshrrev_b32 v93, 3, v92
    v_and_b32 v93, 0x00010001, v93
    v_add_u32 v92, 196611, v92
    v_add_u32 v92, v92, v93
    v_pk_lshrrev_b16 v92, v47, v92
    v_add_u32 v92, v92, v45
    v_add_u32 v93, v92, v92
    v_and_b32 v93, 0x1fffe, v93
    v_lshrrev_b32 v92, 15, v92
    v_and_b32 v92, 0x1fffe, v92
    ds_read_u16 v63, v93
    ds_read_u16_d16_hi v99, v92
    s_waitcnt lgkmcnt(4)
    v_add_u32 v80, 4261412352, v40
    v_lshrrev_b32 v81, 3, v80
    v_and_b32 v81, 0x00010001, v81
    v_add_u32 v80, 196611, v80
    v_add_u32 v80, v80, v81
    v_pk_lshrrev_b16 v80, v47, v80
    v_add_u32 v80, v80, v45
    v_add_u32 v81, v80, v80
    v_and_b32 v81, 0x1fffe, v81
    v_lshrrev_b32 v80, 15, v80
    v_and_b32 v80, 0x1fffe, v80
    ds_read_u16 v64, v81
    ds_read_u16_d16_hi v100, v80
    v_add_u32 v84, 4261281278, v40
    v_lshrrev_b32 v85, 3, v84
    v_and_b32 v85, 0x00010001, v85
    v_add_u32 v84, 196611, v84
    v_add_u32 v84, v84, v85
    v_pk_lshrrev_b16 v84, v47, v84
    v_add_u32 v84, v84, v45
    v_add_u32 v85, v84, v84
    v_and_b32 v85, 0x1fffe, v85
    v_lshrrev_b32 v84, 15, v84
    v_and_b32 v84, 0x1fffe, v84
    ds_read_u16 v65, v85
    ds_read_u16_d16_hi v101, v84
    v_add_u32 v88, 4261150204, v40
    v_lshrrev_b32 v89, 3, v88
    v_and_b32 v89, 0x00010001, v89
    v_add_u32 v88, 196611, v88
    v_add_u32 v88, v88, v89
    v_pk_lshrrev_b16 v88, v47, v88
    v_add_u32 v88, v88, v45
    v_add_u32 v89, v88, v88
    v_and_b32 v89, 0x1fffe, v89
    v_lshrrev_b32 v88, 15, v88
    v_and_b32 v88, 0x1fffe, v88
    ds_read_u16 v66, v89
    ds_read_u16_d16_hi v102, v88
    v_add_u32 v92, 4261019130, v40
    v_lshrrev_b32 v93, 3, v92
    v_and_b32 v93, 0x00010001, v93
    v_add_u32 v92, 196611, v92
    v_add_u32 v92, v92, v93
    v_pk_lshrrev_b16 v92, v47, v92
    v_add_u32 v92, v92, v45
    v_add_u32 v93, v92, v92
    v_and_b32 v93, 0x1fffe, v93
    v_lshrrev_b32 v92, 15, v92
    v_and_b32 v92, 0x1fffe, v92
    ds_read_u16 v67, v93
    ds_read_u16_d16_hi v103, v92
    s_waitcnt lgkmcnt(4)
    v_add_u32 v80, 4227857408, v40
    v_lshrrev_b32 v81, 2, v80
    v_and_b32 v81, 0x00010001, v81
    v_add_u32 v80, 65537, v80
    v_add_u32 v80, v80, v81
    v_pk_lshrrev_b16 v80, v48, v80
    v_add_u32 v80, v80, v46
    v_add_u32 v81, v80, v80
    v_and_b32 v81, 0x1fffe, v81
    v_lshrrev_b32 v80, 15, v80
    v_and_b32 v80, 0x1fffe, v80
    ds_read_u16 v68, v81
    ds_read_u16_d16_hi v104, v80
    v_add_u32 v84, 4227726334, v40
    v_lshrrev_b32 v85, 2, v84
    v_and_b32 v85, 0x00010001, v85
    v_add_u32 v84, 65537, v84
    v_add_u32 v84, v84, v85
    v_pk_lshrrev_b16 v84, v48, v84
    v_add_u32 v84, v84, v46
    v_add_u32 v85, v84, v84
    v_and_b32 v85, 0x1fffe, v85
    v_lshrrev_b32 v84, 15, v84
    v_and_b32 v84, 0x1fffe, v84
    ds_read_u16 v69, v85
    ds_read_u16_d16_hi v105, v84
    v_add_u32 v88, 4227595260, v40
    v_lshrrev_b32 v89, 2, v88
    v_and_b32 v89, 0x00010001, v89
    v_add_u32 v88, 65537, v88
    v_add_u32 v88, v88, v89
    v_pk_lshrrev_b16 v88, v48, v88
    v_add_u32 v88, v88, v46
    v_add_u32 v89, v88, v88
    v_and_b32 v89, 0x1fffe, v89
    v_lshrrev_b32 v88, 15, v88
    v_and_b32 v88, 0x1fffe, v88
    ds_read_u16 v70, v89
    ds_read_u16_d16_hi v106, v88
    v_add_u32 v92, 4227464186, v40
    v_lshrrev_b32 v93, 2, v92
    v_and_b32 v93, 0x00010001, v93
    v_add_u32 v92, 65537, v92
    v_add_u32 v92, v92, v93
    v_pk_lshrrev_b16 v92, v48, v92
    v_add_u32 v92, v92, v46
    v_add_u32 v93, v92, v92
    v_and_b32 v93, 0x1fffe, v93
    v_lshrrev_b32 v92, 15, v92
    v_and_b32 v92, 0x1fffe, v92
    ds_read_u16 v71, v93
    ds_read_u16_d16_hi v107, v92
    s_waitcnt lgkmcnt(4)
    v_add_u32 v80, 4194302464, v40
    v_lshrrev_b32 v81, 1, v80
    v_and_b32 v81, v41, v81
    v_add_u32 v80, v80, v81
    v_pk_lshrrev_b16 v80, v41, v80
    v_add_u32 v80, v80, v43
    v_add_u32 v81, v80, v80
    v_and_b32 v81, 0x1fffe, v81
    v_lshrrev_b32 v80, 15, v80
    v_and_b32 v80, 0x1fffe, v80
    ds_read_u16 v72, v81
    ds_read_u16_d16_hi v108, v80
    v_add_u32 v84, 4194171390, v40
    v_lshrrev_b32 v85, 1, v84
    v_and_b32 v85, v41, v85
    v_add_u32 v84, v84, v85
    v_pk_lshrrev_b16 v84, v41, v84
    v_add_u32 v84, v84, v43
    v_add_u32 v85, v84, v84
    v_and_b32 v85, 0x1fffe, v85
    v_lshrrev_b32 v84, 15, v84
    v_and_b32 v84, 0x1fffe, v84
    ds_read_u16 v73, v85
    ds_read_u16_d16_hi v109, v84
    v_add_u32 v88, 4194040316, v40
    v_lshrrev_b32 v89, 1, v88
    v_and_b32 v89, v41, v89
    v_add_u32 v88, v88, v89
    v_pk_lshrrev_b16 v88, v41, v88
    v_add_u32 v88, v88, v43
    v_add_u32 v89, v88, v88
    v_and_b32 v89, 0x1fffe, v89
    v_lshrrev_b32 v88, 15, v88
    v_and_b32 v88, 0x1fffe, v88
    ds_read_u16 v74, v89
    ds_read_u16_d16_hi v110, v88
    v_add_u32 v92, 4193909242, v40
    v_lshrrev_b32 v93, 1, v92
    v_and_b32 v93, v41, v93
    v_add_u32 v92, v92, v93
    v_pk_lshrrev_b16 v92, v41, v92
    v_add_u32 v92, v92, v43
    v_add_u32 v93, v92, v92
    v_and_b32 v93, 0x1fffe, v93
    v_lshrrev_b32 v92, 15, v92
    v_and_b32 v92, 0x1fffe, v92
    ds_read_u16 v75, v93
    ds_read_u16_d16_hi v111, v92
    s_waitcnt lgkmcnt(4)
    s_waitcnt lgkmcnt(0)
    v_and_b32 v96, 0xffff0000, v96
    v_or_b32 v60, v60, v96
    v_and_b32 v97, 0xffff0000, v97
    v_or_b32 v61, v61, v97
    v_and_b32 v98, 0xffff0000, v98
    v_or_b32 v62, v62, v98
    v_and_b32 v99, 0xffff0000, v99
    v_or_b32 v63, v63, v99
    v_and_b32 v100, 0xffff0000, v100
    v_or_b32 v64, v64, v100
    v_and_b32 v101, 0xffff0000, v101
    v_or_b32 v65, v65, v101
    v_and_b32 v102, 0xffff0000, v102
    v_or_b32 v66, v66, v102
    v_and_b32 v103, 0xffff0000, v103
    v_or_b32 v67, v67, v103
    v_and_b32 v104, 0xffff0000, v104
    v_or_b32 v68, v68, v104
    v_and_b32 v105, 0xffff0000, v105
    v_or_b32 v69, v69, v105
    v_and_b32 v106, 0xffff0000, v106
    v_or_b32 v70, v70, v106
    v_and_b32 v107, 0xffff0000, v107
    v_or_b32 v71, v71, v107
    v_and_b32 v108, 0xffff0000, v108
    v_or_b32 v72, v72, v108
    v_and_b32 v109, 0xffff0000, v109
    v_or_b32 v73, v73, v109
    v_and_b32 v110, 0xffff0000, v110
    v_or_b32 v74, v74, v110
    v_and_b32 v111, 0xffff0000, v111
    v_or_b32 v75, v75, v111
    s_nop 1
    v_mov_b32_dpp v76, v60 wave_shl:1 row_mask:0xf bank_mask:0xf bound_ctrl:0
    v_mov_b32_dpp v77, v64 wave_shl:1 row_mask:0xf bank_mask:0xf bound_ctrl:0
    v_mov_b32_dpp v78, v68 wave_shl:1 row_mask:0xf bank_mask:0xf bound_ctrl:0
    v_mov_b32_dpp v79, v72 wave_shl:1 row_mask:0xf bank_mask:0xf bound_ctrl:0
    v_readlane_b32 s56, v64, 0
    s_nop 3
    v_writelane_b32 v76, s56, 63
    v_readlane_b32 s56, v68, 0
    s_nop 3
    v_writelane_b32 v77, s56, 63
    v_readlane_b32 s56, v72, 0
    s_nop 3
    v_writelane_b32 v78, s56, 63
    v_alignbit_b32 v96, v61, v60, 16
    v_alignbit_b32 v97, v62, v61, 16
    v_alignbit_b32 v98, v63, v62, 16
    v_alignbit_b32 v99, v76, v63, 16
    v_alignbit_b32 v100, v65, v64, 16
    v_alignbit_b32 v101, v66, v65, 16
    v_alignbit_b32 v102, v67, v66, 16
    v_alignbit_b32 v103, v77, v67, 16
    v_alignbit_b32 v104, v69, v68, 16
    v_alignbit_b32 v105, v70, v69, 16
    v_alignbit_b32 v106, v71, v70, 16
    v_alignbit_b32 v107, v78, v71, 16
    v_alignbit_b32 v108, v73, v72, 16
    v_alignbit_b32 v109, v74, v73, 16
    v_alignbit_b32 v110, v75, v74, 16
    v_alignbit_b32 v111, v79, v75, 16
    s_mov_b32 s24, s54
    s_and_b32 s25, s55, 0xffff
    s_mov_b32 s26, 26214400
    s_mov_b32 s27, 0x00020000
    s_mul_i32 s40, s20, 8448
    s_add_u32 s40, s40, 15728640
    s_add_u32 s41, s40, 4224
    v_lshlrev_b32 v7, 4, v2
    v_mov_b32 v8, 0
    v_mov_b32 v9, 0
    v_mov_b32 v10, 0
    v_mov_b32 v11, 0
    buffer_store_dwordx4 v[60:63], v7, s[24:27], s40 offen offset:0
    buffer_store_dwordx4 v[96:99], v7, s[24:27], s41 offen offset:0
    buffer_store_dwordx4 v[64:67], v7, s[24:27], s40 offen offset:1024
    buffer_store_dwordx4 v[100:103], v7, s[24:27], s41 offen offset:1024
    buffer_store_dwordx4 v[68:71], v7, s[24:27], s40 offen offset:2048
    buffer_store_dwordx4 v[104:107], v7, s[24:27], s41 offen offset:2048
    buffer_store_dwordx4 v[72:75], v7, s[24:27], s40 offen offset:3072
    buffer_store_dwordx4 v[108:111], v7, s[24:27], s41 offen offset:3072
    s_add_u32 s40, s40, 4096
    s_add_u32 s41, s41, 4096
    s_mul_i32 s42, s20, 6144
    s_add_u32 s42, s42, 11534336
    v_lshrrev_b32 v6, 5, v2
    v_mul_u32_u24 v6, 1536, v6
    v_and_b32 v12, 31, v2
    v_lshl_add_u32 v6, v12, 4, v6
    buffer_store_dwordx4 v[8:11], v6, s[24:27], s42 offen
    buffer_store_dwordx4 v[8:11], v6, s[24:27], s42 offen offset:3072
    s_mov_b64 exec, 0xff
    buffer_store_dwordx4 v[8:11], v7, s[24:27], s40 offen
    buffer_store_dwordx4 v[8:11], v7, s[24:27], s41 offen
    s_mov_b64 exec, -1
    s_branch L_k1_kernel_k1end_3
L_k1_kernel_ut_1:
    s_sub_u32 s40, s2, 192
    s_and_b32 s41, s40, 3
    s_lshr_b32 s40, s40, 2
    s_lshl_b32 s40, s40, 1
    s_sub_u32 s42, s49, 9
    s_add_u32 s40, s40, s42
    s_mul_i32 s42, s42, 18432
    s_add_u32 s42, s42, 122112
    s_load_dwordx2 s[4:5], s[0:1], 0
    s_load_dwordx2 s[6:7], s[0:1], 96
    s_mul_i32 s24, s40, 73728
    s_mul_i32 s25, s41, 288
    s_add_u32 s24, s24, s25
    s_mov_b32 s30, 3641
    s_waitcnt lgkmcnt(0)
    s_mov_b32 s8, s4
    s_and_b32 s9, s5, 0xffff
    s_mov_b32 s10, 2359296
    s_mov_b32 s11, 0x00020000
    s_mov_b32 s12, s6
    s_and_b32 s13, s7, 0xffff
    s_mov_b32 s14, 26214400
    s_mov_b32 s15, 0x00020000
    v_add_u32 v4, 0, v2
    v_mul_lo_u32 v5, v4, s30
    v_lshrrev_b32 v5, 16, v5
    v_mul_u32_u24 v6, 18, v5
    v_sub_u32 v6, v4, v6
    v_mul_u32_u24 v5, 1152, v5
    v_lshl_add_u32 v5, v6, 4, v5
    s_add_u32 m0, s42, 0
    s_nop 0
    buffer_load_dwordx4 v5, s[8:11], s24 offen lds
    v_add_u32 v4, 64, v2
    v_mul_lo_u32 v5, v4, s30
    v_lshrrev_b32 v5, 16, v5
    v_mul_u32_u24 v6, 18, v5
    v_sub_u32 v6, v4, v6
    v_mul_u32_u24 v5, 1152, v5
    v_lshl_add_u32 v5, v6, 4, v5
    s_add_u32 m0, s42, 1024
    s_nop 0
    buffer_load_dwordx4 v5, s[8:11], s24 offen lds
    v_add_u32 v4, 128, v2
    v_mul_lo_u32 v5, v4, s30
    v_lshrrev_b32 v5, 16, v5
    v_mul_u32_u24 v6, 18, v5
    v_sub_u32 v6, v4, v6
    v_mul_u32_u24 v5, 1152, v5
    v_lshl_add_u32 v5, v6, 4, v5
    s_add_u32 m0, s42, 2048
    s_nop 0
    buffer_load_dwordx4 v5, s[8:11], s24 offen lds
    v_add_u32 v4, 192, v2
    v_mul_lo_u32 v5, v4, s30
    v_lshrrev_b32 v5, 16, v5
    v_mul_u32_u24 v6, 18, v5
    v_sub_u32 v6, v4, v6
    v_mul_u32_u24 v5, 1152, v5
    v_lshl_add_u32 v5, v6, 4, v5
    s_add_u32 m0, s42, 3072
    s_nop 0
    buffer_load_dwordx4 v5, s[8:11], s24 offen lds
    v_add_u32 v4, 256, v2
    v_mul_lo_u32 v5, v4, s30
    v_lshrrev_b32 v5, 16, v5
    v_mul_u32_u24 v6, 18, v5
    v_sub_u32 v6, v4, v6
    v_mul_u32_u24 v5, 1152, v5
    v_lshl_add_u32 v5, v6, 4, v5
    s_add_u32 m0, s42, 4096
    s_nop 0
    buffer_load_dwordx4 v5, s[8:11], s24 offen lds
    v_add_u32 v4, 320, v2
    v_mul_lo_u32 v5, v4, s30
    v_lshrrev_b32 v5, 16, v5
    v_mul_u32_u24 v6, 18, v5
    v_sub_u32 v6, v4, v6
    v_mul_u32_u24 v5, 1152, v5
    v_lshl_add_u32 v5, v6, 4, v5
    s_add_u32 m0, s42, 5120
    s_nop 0
    buffer_load_dwordx4 v5, s[8:11], s24 offen lds
    v_add_u32 v4, 384, v2
    v_mul_lo_u32 v5, v4, s30
    v_lshrrev_b32 v5, 16, v5
    v_mul_u32_u24 v6, 18, v5
    v_sub_u32 v6, v4, v6
    v_mul_u32_u24 v5, 1152, v5
    v_lshl_add_u32 v5, v6, 4, v5
    s_add_u32 m0, s42, 6144
    s_nop 0
    buffer_load_dwordx4 v5, s[8:11], s24 offen lds
    v_add_u32 v4, 448, v2
    v_mul_lo_u32 v5, v4, s30
    v_lshrrev_b32 v5, 16, v5
    v_mul_u32_u24 v6, 18, v5
    v_sub_u32 v6, v4, v6
    v_mul_u32_u24 v5, 1152, v5
    v_lshl_add_u32 v5, v6, 4, v5
    s_add_u32 m0, s42, 7168
    s_nop 0
    buffer_load_dwordx4 v5, s[8:11], s24 offen lds
    v_add_u32 v4, 512, v2
    v_mul_lo_u32 v5, v4, s30
    v_lshrrev_b32 v5, 16, v5
    v_mul_u32_u24 v6, 18, v5
    v_sub_u32 v6, v4, v6
    v_mul_u32_u24 v5, 1152, v5
    v_lshl_add_u32 v5, v6, 4, v5
    s_add_u32 m0, s42, 8192
    s_nop 0
    buffer_load_dwordx4 v5, s[8:11], s24 offen lds
    v_add_u32 v4, 576, v2
    v_mul_lo_u32 v5, v4, s30
    v_lshrrev_b32 v5, 16, v5
    v_mul_u32_u24 v6, 18, v5
    v_sub_u32 v6, v4, v6
    v_mul_u32_u24 v5, 1152, v5
    v_lshl_add_u32 v5, v6, 4, v5
    s_add_u32 m0, s42, 9216
    s_nop 0
    buffer_load_dwordx4 v5, s[8:11], s24 offen lds
    v_add_u32 v4, 640, v2
    v_mul_lo_u32 v5, v4, s30
    v_lshrrev_b32 v5, 16, v5
    v_mul_u32_u24 v6, 18, v5
    v_sub_u32 v6, v4, v6
    v_mul_u32_u24 v5, 1152, v5
    v_lshl_add_u32 v5, v6, 4, v5
    s_add_u32 m0, s42, 10240
    s_nop 0
    buffer_load_dwordx4 v5, s[8:11], s24 offen lds
    v_add_u32 v4, 704, v2
    v_mul_lo_u32 v5, v4, s30
    v_lshrrev_b32 v5, 16, v5
    v_mul_u32_u24 v6, 18, v5
    v_sub_u32 v6, v4, v6
    v_mul_u32_u24 v5, 1152, v5
    v_lshl_add_u32 v5, v6, 4, v5
    s_add_u32 m0, s42, 11264
    s_nop 0
    buffer_load_dwordx4 v5, s[8:11], s24 offen lds
    v_add_u32 v4, 768, v2
    v_mul_lo_u32 v5, v4, s30
    v_lshrrev_b32 v5, 16, v5
    v_mul_u32_u24 v6, 18, v5
    v_sub_u32 v6, v4, v6
    v_mul_u32_u24 v5, 1152, v5
    v_lshl_add_u32 v5, v6, 4, v5
    s_add_u32 m0, s42, 12288
    s_nop 0
    buffer_load_dwordx4 v5, s[8:11], s24 offen lds
    v_add_u32 v4, 832, v2
    v_mul_lo_u32 v5, v4, s30
    v_lshrrev_b32 v5, 16, v5
    v_mul_u32_u24 v6, 18, v5
    v_sub_u32 v6, v4, v6
    v_mul_u32_u24 v5, 1152, v5
    v_lshl_add_u32 v5, v6, 4, v5
    s_add_u32 m0, s42, 13312
    s_nop 0
    buffer_load_dwordx4 v5, s[8:11], s24 offen lds
    v_add_u32 v4, 896, v2
    v_mul_lo_u32 v5, v4, s30
    v_lshrrev_b32 v5, 16, v5
    v_mul_u32_u24 v6, 18, v5
    v_sub_u32 v6, v4, v6
    v_mul_u32_u24 v5, 1152, v5
    v_lshl_add_u32 v5, v6, 4, v5
    s_add_u32 m0, s42, 14336
    s_nop 0
    buffer_load_dwordx4 v5, s[8:11], s24 offen lds
    v_add_u32 v4, 960, v2
    v_mul_lo_u32 v5, v4, s30
    v_lshrrev_b32 v5, 16, v5
    v_mul_u32_u24 v6, 18, v5
    v_sub_u32 v6, v4, v6
    v_mul_u32_u24 v5, 1152, v5
    v_lshl_add_u32 v5, v6, 4, v5
    s_add_u32 m0, s42, 15360
    s_nop 0
    buffer_load_dwordx4 v5, s[8:11], s24 offen lds
    v_add_u32 v4, 1024, v2
    v_mul_lo_u32 v5, v4, s30
    v_lshrrev_b32 v5, 16, v5
    v_mul_u32_u24 v6, 18, v5
    v_sub_u32 v6, v4, v6
    v_mul_u32_u24 v5, 1152, v5
    v_lshl_add_u32 v5, v6, 4, v5
    s_add_u32 m0, s42, 16384
    s_nop 0
    buffer_load_dwordx4 v5, s[8:11], s24 offen lds
    v_add_u32 v4, 1088, v2
    v_mul_lo_u32 v5, v4, s30
    v_lshrrev_b32 v5, 16, v5
    v_mul_u32_u24 v6, 18, v5
    v_sub_u32 v6, v4, v6
    v_mul_u32_u24 v5, 1152, v5
    v_lshl_add_u32 v5, v6, 4, v5
    s_add_u32 m0, s42, 17408
    s_nop 0
    buffer_load_dwordx4 v5, s[8:11], s24 offen lds
    v_and_b32 v4, 15, v2
    v_mul_u32_u24 v4, 6144, v4
    v_lshrrev_b32 v5, 4, v2
    s_mul_i32 s27, s41, 884736
    s_add_u32 s27, s27, 11534336
    v_and_b32 v7, 1, v5
    v_lshrrev_b32 v12, 1, v5
    v_lshlrev_b32 v13, 5, v7
    v_lshl_add_u32 v13, v12, 3, v13
    v_bfe_u32 v14, v2, 2, 2
    v_add_u32 v13, v13, v14
    v_mul_u32_u24 v13, 288, v13
    v_and_b32 v14, 3, v2
    v_lshl_add_u32 v13, v14, 3, v13
    v_add_u32 v13, s42, v13
    v_mul_u32_u24 v12, 1536, v12
    v_lshl_add_u32 v12, v7, 4, v12
    v_add_u32 v12, v12, v4
    s_lshl_b32 s28, s40, 5
    s_add_u32 s28, s28, s27
    s_add_u32 s28, s28, 512
    s_waitcnt vmcnt(0)
    ds_read_b64_tr_b16 v[16:17], v13 offset:0
    ds_read_b64_tr_b16 v[18:19], v13 offset:1152
    s_waitcnt lgkmcnt(0)
    buffer_store_dwordx4 v[16:19], v12, s[12:15], s28 offen offset:0
    ds_read_b64_tr_b16 v[20:21], v13 offset:4608
    ds_read_b64_tr_b16 v[22:23], v13 offset:5760
    s_waitcnt lgkmcnt(0)
    buffer_store_dwordx4 v[20:23], v12, s[12:15], s28 offen offset:3072
    s_add_u32 s28, s28, 98304
    ds_read_b64_tr_b16 v[24:25], v13 offset:32
    ds_read_b64_tr_b16 v[26:27], v13 offset:1184
    s_waitcnt lgkmcnt(0)
    buffer_store_dwordx4 v[24:27], v12, s[12:15], s28 offen offset:0
    ds_read_b64_tr_b16 v[28:29], v13 offset:4640
    ds_read_b64_tr_b16 v[30:31], v13 offset:5792
    s_waitcnt lgkmcnt(0)
    buffer_store_dwordx4 v[28:31], v12, s[12:15], s28 offen offset:3072
    s_add_u32 s28, s28, 98304
    ds_read_b64_tr_b16 v[16:17], v13 offset:64
    ds_read_b64_tr_b16 v[18:19], v13 offset:1216
    s_waitcnt lgkmcnt(0)
    buffer_store_dwordx4 v[16:19], v12, s[12:15], s28 offen offset:0
    ds_read_b64_tr_b16 v[20:21], v13 offset:4672
    ds_read_b64_tr_b16 v[22:23], v13 offset:5824
    s_waitcnt lgkmcnt(0)
    buffer_store_dwordx4 v[20:23], v12, s[12:15], s28 offen offset:3072
    s_add_u32 s28, s28, 98304
    ds_read_b64_tr_b16 v[24:25], v13 offset:96
    ds_read_b64_tr_b16 v[26:27], v13 offset:1248
    s_waitcnt lgkmcnt(0)
    buffer_store_dwordx4 v[24:27], v12, s[12:15], s28 offen offset:0
    ds_read_b64_tr_b16 v[28:29], v13 offset:4704
    ds_read_b64_tr_b16 v[30:31], v13 offset:5856
    s_waitcnt lgkmcnt(0)
    buffer_store_dwordx4 v[28:31], v12, s[12:15], s28 offen offset:3072
    s_add_u32 s28, s28, 98304
    ds_read_b64_tr_b16 v[16:17], v13 offset:128
    ds_read_b64_tr_b16 v[18:19], v13 offset:1280
    s_waitcnt lgkmcnt(0)
    buffer_store_dwordx4 v[16:19], v12, s[12:15], s28 offen offset:0
    ds_read_b64_tr_b16 v[20:21], v13 offset:4736
    ds_read_b64_tr_b16 v[22:23], v13 offset:5888
    s_waitcnt lgkmcnt(0)
    buffer_store_dwordx4 v[20:23], v12, s[12:15], s28 offen offset:3072
    s_add_u32 s28, s28, 98304
    ds_read_b64_tr_b16 v[24:25], v13 offset:160
    ds_read_b64_tr_b16 v[26:27], v13 offset:1312
    s_waitcnt lgkmcnt(0)
    buffer_store_dwordx4 v[24:27], v12, s[12:15], s28 offen offset:0
    ds_read_b64_tr_b16 v[28:29], v13 offset:4768
    ds_read_b64_tr_b16 v[30:31], v13 offset:5920
    s_waitcnt lgkmcnt(0)
    buffer_store_dwordx4 v[28:31], v12, s[12:15], s28 offen offset:3072
    s_add_u32 s28, s28, 98304
    ds_read_b64_tr_b16 v[16:17], v13 offset:192
    ds_read_b64_tr_b16 v[18:19], v13 offset:1344
    s_waitcnt lgkmcnt(0)
    buffer_store_dwordx4 v[16:19], v12, s[12:15], s28 offen offset:0
    ds_read_b64_tr_b16 v[20:21], v13 offset:4800
    ds_read_b64_tr_b16 v[22:23], v13 offset:5952
    s_waitcnt lgkmcnt(0)
    buffer_store_dwordx4 v[20:23], v12, s[12:15], s28 offen offset:3072
    s_add_u32 s28, s28, 98304
    ds_read_b64_tr_b16 v[24:25], v13 offset:224
    ds_read_b64_tr_b16 v[26:27], v13 offset:1376
    s_waitcnt lgkmcnt(0)
    buffer_store_dwordx4 v[24:27], v12, s[12:15], s28 offen offset:0
    ds_read_b64_tr_b16 v[28:29], v13 offset:4832
    ds_read_b64_tr_b16 v[30:31], v13 offset:5984
    s_waitcnt lgkmcnt(0)
    buffer_store_dwordx4 v[28:31], v12, s[12:15], s28 offen offset:3072
    s_add_u32 s28, s28, 98304
    ds_read_b64_tr_b16 v[16:17], v13 offset:256
    ds_read_b64_tr_b16 v[18:19], v13 offset:1408
    s_waitcnt lgkmcnt(0)
    buffer_store_dwordx4 v[16:19], v12, s[12:15], s28 offen offset:0
    ds_read_b64_tr_b16 v[20:21], v13 offset:4864
    ds_read_b64_tr_b16 v[22:23], v13 offset:6016
    s_waitcnt lgkmcnt(0)
    buffer_store_dwordx4 v[20:23], v12, s[12:15], s28 offen offset:3072
    s_add_u32 s28, s28, 98304
L_k1_kernel_k1end_3:
L_k1_kernel_exit:
    s_endpgm

.text
.globl k2_kernel
.p2align 8
.type k2_kernel,@function
k2_kernel:
    s_cmp_ge_u32 s2, 256
    s_cbranch_scc1 L_k2_kernel_exit
    s_load_dwordx2 s[4:5], s[0:1], 96
    v_lshrrev_b32 v1, 6, v0
    v_and_b32 v2, 63, v0
    s_and_b32 s20, s2, 7
    v_readfirstlane_b32 s19, v1
    s_lshr_b32 s21, s2, 3
    s_and_b32 s22, s21, 3
    s_lshl_b32 s20, s20, 2
    s_add_u32 s20, s20, s22
    s_lshr_b32 s21, s21, 2
    s_lshl_b32 s21, s21, 3
    s_add_u32 s21, s21, s19
    s_lshl_b32 s26, s20, 16
    s_lshl_b32 s27, s21, 10
    s_add_u32 s26, s26, s27
    s_add_u32 s26, s26, 5242880
    s_lshl_b32 s28, s20, 13
    s_lshl_b32 s27, s21, 7
    s_add_u32 s28, s28, s27
    s_add_u32 s28, s28, 7340032
    s_mul_i32 s24, s20, 155648
    v_lshlrev_b32 v84, 4, v2
    v_lshlrev_b32 v217, 4, v2
    v_and_b32 v88, 31, v2
    v_lshlrev_b32 v89, 2, v88
    v_mov_b32 v90, -1
    v_cmp_gt_u32 vcc, 32, v2
    v_mov_b32 v9, 0
    v_mov_b32 v10, 0
    v_cndmask_b32_e64 v90, v90, v89, vcc
    s_add_u32 s44, s19, 4
    s_add_u32 s45, s19, 12
    s_cmp_lt_u32 s19, 4
    s_cselect_b32 s44, s19, s44
    s_cselect_b32 s45, s45, s19
    s_lshl_b32 s44, s44, 10
    s_lshl_b32 s45, s45, 10
    s_lshl_b32 s46, s19, 10
    s_add_u32 s46, s46, 16384
    s_add_u32 s47, s46, 8192
    s_waitcnt lgkmcnt(0)
    s_mov_b32 s8, s4
    s_and_b32 s9, s5, 0xffff
    s_mov_b32 s10, 26214400
    s_mov_b32 s11, 0x00020000
    buffer_load_dwordx4 v[4:7], v84, s[8:11], s26 offen
    buffer_load_dword v8, v90, s[8:11], s28 offen
    s_mov_b32 m0, s44
    s_add_u32 s27, s24, s44
    buffer_load_dwordx4 v217, s[8:11], s27 offen lds
    s_mov_b32 m0, s45
    s_add_u32 s27, s24, s45
    buffer_load_dwordx4 v217, s[8:11], s27 offen lds
    s_mov_b32 m0, s46
    s_add_u32 s27, s24, s46
    buffer_load_dwordx4 v217, s[8:11], s27 offen lds
    s_mov_b32 m0, s47
    s_add_u32 s27, s24, s47
    buffer_load_dwordx4 v217, s[8:11], s27 offen lds
    s_mov_b32 s35, 3
    s_mov_b32 s30, 0
    s_mov_b32 s31, 0
    s_cmp_ge_u32 s19, 4
    s_cbranch_scc1 L_k2_kernel_ud_2
    s_cmp_eq_u32 s19, 3
    s_cbranch_scc1 L_k2_kernel_w3_1
    s_and_b32 s30, s2, 7
    s_lshl_b32 s30, s30, 6
    s_lshr_b32 s31, s2, 3
    s_lshl_b32 s31, s31, 1
    s_add_u32 s30, s30, s31
    s_add_u32 s31, s30, 1
    s_mov_b32 s35, 1
    s_cmp_eq_u32 s19, 2
    s_cbranch_scc1 L_k2_kernel_ud_2
    s_add_u32 s30, s30, s19
    s_mov_b32 s31, s30
    s_mov_b32 s35, 0
    s_branch L_k2_kernel_ud_2
L_k2_kernel_w3_1:
    s_cmp_ge_u32 s2, 96
    s_cbranch_scc1 L_k2_kernel_ud_2
    s_cmp_ge_u32 s2, 64
    s_cbranch_scc1 L_k2_kernel_x96_4
    s_add_u32 s30, s2, 512
    s_mov_b32 s31, s30
    s_mov_b32 s35, 0
    s_branch L_k2_kernel_ud_2
L_k2_kernel_x96_4:
    s_sub_u32 s30, s2, 64
    s_lshl_b32 s30, s30, 1
    s_add_u32 s30, s30, 512
    s_add_u32 s31, s30, 1
    s_mov_b32 s35, 1
L_k2_kernel_ud_2:
    v_and_b32 v93, 3, v88
    v_lshlrev_b32 v93, 1, v93
    v_bfe_u32 v94, v88, 2, 1
    v_or_b32 v93, v93, v94
    v_lshrrev_b32 v94, 3, v88
    v_lshl_or_b32 v93, v94, 3, v93
    v_and_b32 v94, 1, v93
    v_xor_b32 v94, 1, v94
    v_sub_u32 v95, 2047, v93
    v_sub_u32 v95, v95, v94
    v_lshrrev_b32 v92, 5, v2
    v_lshl_add_u32 v95, v92, 3, v95
    v_lshlrev_b32 v95, 1, v95
    v_mul_u32_u24 v94, 4224, v94
    v_add_u32 v95, v95, v94
    v_mul_u32_u24 v94, 1536, v92
    v_lshl_add_u32 v94, v88, 4, v94
    v_lshlrev_b32 v96, 6, v88
    v_lshl_add_u32 v216, v92, 4, v96
    s_mul_i32 s36, s30, 8448
    s_add_u32 s36, s36, 15724352
    s_mul_i32 s37, s31, 8448
    s_add_u32 s37, s37, 15724352
    s_sub_u32 s40, s37, 2048
    s_cmp_eq_u32 s35, 0
    s_cselect_b32 s37, s40, s37
    v_add_u32 v212, s36, v95
    v_add_u32 v214, s37, v95
    s_mul_i32 s36, s30, 6144
    s_add_u32 s36, s36, 11533776
    s_mul_i32 s37, s31, 6144
    s_add_u32 s37, s37, 11533776
    s_cmp_eq_u32 s35, 0
    s_cselect_b32 s40, 0, 512
    s_add_u32 s36, s36, s40
    s_add_u32 s37, s37, s40
    v_add_u32 v213, s36, v94
    v_add_u32 v215, s37, v94
    s_mul_i32 s33, s30, 4096
    s_add_u32 s33, s33, 20971520
    s_mul_i32 s34, s31, 4096
    s_add_u32 s34, s34, 20973568
    s_mul_i32 s36, s30, 2048
    s_add_u32 s36, s36, 24117248
    s_add_u32 s37, s33, 2048
    s_cmp_eq_u32 s35, 0
    s_cselect_b32 s34, s36, s34
    s_cselect_b32 s33, s33, s37
    s_mov_b32 s38, 4032
    s_mov_b32 s39, 1008
    v_mov_b32 v100, 0
    v_mov_b32 v101, 0
    v_mov_b32 v102, 0
    v_mov_b32 v103, 0
    v_mov_b32 v104, 0
    v_mov_b32 v105, 0
    v_mov_b32 v106, 0
    v_mov_b32 v107, 0
    v_mov_b32 v108, 0
    v_mov_b32 v109, 0
    v_mov_b32 v110, 0
    v_mov_b32 v111, 0
    v_mov_b32 v112, 0
    v_mov_b32 v113, 0
    v_mov_b32 v114, 0
    v_mov_b32 v115, 0
    v_mov_b32 v116, 0
    v_mov_b32 v117, 0
    v_mov_b32 v118, 0
    v_mov_b32 v119, 0
    v_mov_b32 v120, 0
    v_mov_b32 v121, 0
    v_mov_b32 v122, 0
    v_mov_b32 v123, 0
    v_mov_b32 v124, 0
    v_mov_b32 v125, 0
    v_mov_b32 v126, 0
    v_mov_b32 v127, 0
    v_mov_b32 v128, 0
    v_mov_b32 v129, 0
    v_mov_b32 v130, 0
    v_mov_b32 v131, 0
    v_mov_b32 v132, 0
    v_mov_b32 v133, 0
    v_mov_b32 v134, 0
    v_mov_b32 v135, 0
    v_mov_b32 v136, 0
    v_mov_b32 v137, 0
    v_mov_b32 v138, 0
    v_mov_b32 v139, 0
    v_mov_b32 v140, 0
    v_mov_b32 v141, 0
    v_mov_b32 v142, 0
    v_mov_b32 v143, 0
    v_mov_b32 v144, 0
    v_mov_b32 v145, 0
    v_mov_b32 v146, 0
    v_mov_b32 v147, 0
    v_mov_b32 v148, 0
    v_mov_b32 v149, 0
    v_mov_b32 v150, 0
    v_mov_b32 v151, 0
    v_mov_b32 v152, 0
    v_mov_b32 v153, 0
    v_mov_b32 v154, 0
    v_mov_b32 v155, 0
    v_mov_b32 v156, 0
    v_mov_b32 v157, 0
    v_mov_b32 v158, 0
    v_mov_b32 v159, 0
    v_mov_b32 v160, 0
    v_mov_b32 v161, 0
    v_mov_b32 v162, 0
    v_mov_b32 v163, 0
    v_mov_b32 v164, 0
    v_mov_b32 v165, 0
    v_mov_b32 v166, 0
    v_mov_b32 v167, 0
    v_mov_b32 v168, 0
    v_mov_b32 v169, 0
    v_mov_b32 v170, 0
    v_mov_b32 v171, 0
    v_mov_b32 v172, 0
    v_mov_b32 v173, 0
    v_mov_b32 v174, 0
    v_mov_b32 v175, 0
    v_mov_b32 v176, 0
    v_mov_b32 v177, 0
    v_mov_b32 v178, 0
    v_mov_b32 v179, 0
    v_mov_b32 v180, 0
    v_mov_b32 v181, 0
    v_mov_b32 v182, 0
    v_mov_b32 v183, 0
    v_mov_b32 v184, 0
    v_mov_b32 v185, 0
    v_mov_b32 v186, 0
    v_mov_b32 v187, 0
    v_mov_b32 v188, 0
    v_mov_b32 v189, 0
    v_mov_b32 v190, 0
    v_mov_b32 v191, 0
    v_mov_b32 v192, 0
    v_mov_b32 v193, 0
    v_mov_b32 v194, 0
    v_mov_b32 v195, 0
    v_mov_b32 v196, 0
    v_mov_b32 v197, 0
    v_mov_b32 v198, 0
    v_mov_b32 v199, 0
    v_mov_b32 v200, 0
    v_mov_b32 v201, 0
    v_mov_b32 v202, 0
    v_mov_b32 v203, 0
    v_mov_b32 v204, 0
    v_mov_b32 v205, 0
    v_mov_b32 v206, 0
    v_mov_b32 v207, 0
    v_mov_b32 v208, 0
    v_mov_b32 v209, 0
    v_mov_b32 v210, 0
    v_mov_b32 v211, 0
    v_lshrrev_b32 v91, 5, v2
    v_mul_u32_u24 v91, 320, v91
    v_min_u32 v93, 19, v88
    v_lshl_add_u32 v93, v93, 4, v91
    v_add_u32 v86, 9216, v93
    v_lshlrev_b32 v85, 4, v88
    v_add_u32 v85, 8192, v85
    s_and_b32 s25, s19, 3
    s_lshl_b32 s25, s25, 10
    s_add_u32 s25, s25, 32768
    s_add_u32 s24, s24, s25
    v_mov_b32 v68, 0
    v_mov_b32 v69, 0
    v_mov_b32 v70, 0
    v_mov_b32 v71, 0
    v_mov_b32 v72, 0
    v_mov_b32 v73, 0
    v_mov_b32 v74, 0
    v_mov_b32 v75, 0
    v_mov_b32 v76, 0
    v_mov_b32 v77, 0
    v_mov_b32 v78, 0
    v_mov_b32 v79, 0
    v_mov_b32 v80, 0
    v_mov_b32 v81, 0
    v_mov_b32 v82, 0
    v_mov_b32 v83, 0
    v_mov_b32 v32, 0
    v_mov_b32 v33, 0
    v_mov_b32 v34, 0
    v_mov_b32 v35, 0
    v_mov_b32 v24, 0
    v_mov_b32 v25, 0
    v_mov_b32 v26, 0
    v_mov_b32 v27, 0
    s_waitcnt vmcnt(2)
    v_mov_b32 v11, v8
    s_barrier
    ds_read_b128 v[16:19], v85
    ds_read_b128 v[12:15], v84
    s_waitcnt lgkmcnt(0)
    v_mfma_f32_32x32x16_bf16 v[36:51], v[12:15], v[4:7], 0
    v_mfma_f32_32x32x8_bf16 v[36:51], v[16:17], v[8:9], v[36:51]
    ds_read_b128 v[12:15], v84 offset:1024
    ds_read_b128 v[20:23], v86
    s_waitcnt lgkmcnt(0)
    s_nop 7
    s_mov_b32 s51, 0x07060302
    s_cmp_ge_u32 s19, 4
    s_cbranch_scc1 L_k2_kernel_dma_5
    s_waitcnt lgkmcnt(2)
    v_mfma_f32_32x32x16_bf16 v[52:67], v[12:15], v[4:7], 0
    ds_read_b128 v[12:15], v84 offset:2048
    v_exp_f32 v36, v36
    v_exp_f32 v37, v37
    v_exp_f32 v38, v38
    v_exp_f32 v39, v39
    s_add_u32 m0, s25, 0
    s_add_u32 s27, s24, 0
    buffer_load_dwordx4 v217, s[8:11], s27 offen lds
    v_cvt_pk_bf16_f32 v28, v36, v37
    v_cvt_pk_bf16_f32 v29, v38, v39
    s_add_u32 m0, s25, 4096
    s_add_u32 s27, s24, 4096
    buffer_load_dwordx4 v217, s[8:11], s27 offen lds
    s_waitcnt lgkmcnt(2)
    v_mfma_f32_32x32x16_bf16 v[68:83], v[24:27], v[32:35], v[68:83]
    ds_read_b128 v[24:27], v86 offset:640
    v_exp_f32 v40, v40
    v_exp_f32 v41, v41
    v_exp_f32 v42, v42
    v_exp_f32 v43, v43
    v_cvt_pk_bf16_f32 v30, v40, v41
    v_cvt_pk_bf16_f32 v31, v42, v43
    v_mfma_f32_32x32x8_bf16 v[52:67], v[16:17], v[10:11], v[52:67]
    v_exp_f32 v44, v44
    v_exp_f32 v45, v45
    v_exp_f32 v46, v46
    v_exp_f32 v47, v47
    s_add_u32 m0, s25, 8192
    s_add_u32 s27, s24, 8192
    buffer_load_dwordx4 v217, s[8:11], s27 offen lds
    v_cvt_pk_bf16_f32 v32, v44, v45
    v_cvt_pk_bf16_f32 v33, v46, v47
    s_add_u32 m0, s25, 12288
    s_add_u32 s27, s24, 12288
    buffer_load_dwordx4 v217, s[8:11], s27 offen lds
    s_waitcnt lgkmcnt(2)
    v_mfma_f32_32x32x16_bf16 v[68:83], v[20:23], v[28:31], v[68:83]
    ds_read_b128 v[20:23], v86 offset:1280
    v_exp_f32 v48, v48
    v_exp_f32 v49, v49
    v_exp_f32 v50, v50
    v_exp_f32 v51, v51
    v_cvt_pk_bf16_f32 v34, v48, v49
    v_cvt_pk_bf16_f32 v35, v50, v51
    s_waitcnt lgkmcnt(2)
    v_mfma_f32_32x32x16_bf16 v[36:51], v[12:15], v[4:7], 0
    ds_read_b128 v[12:15], v84 offset:3072
    v_exp_f32 v52, v52
    v_exp_f32 v53, v53
    v_exp_f32 v54, v54
    v_exp_f32 v55, v55
    s_add_u32 m0, s25, 16384
    s_add_u32 s27, s24, 16384
    buffer_load_dwordx4 v217, s[8:11], s27 offen lds
    v_cvt_pk_bf16_f32 v28, v52, v53
    v_cvt_pk_bf16_f32 v29, v54, v55
    s_add_u32 m0, s25, 20480
    s_add_u32 s27, s24, 20480
    buffer_load_dwordx4 v217, s[8:11], s27 offen lds
    s_waitcnt lgkmcnt(2)
    v_mfma_f32_32x32x16_bf16 v[68:83], v[24:27], v[32:35], v[68:83]
    ds_read_b128 v[24:27], v86 offset:1920
    v_exp_f32 v56, v56
    v_exp_f32 v57, v57
    v_exp_f32 v58, v58
    v_exp_f32 v59, v59
    v_cvt_pk_bf16_f32 v30, v56, v57
    v_cvt_pk_bf16_f32 v31, v58, v59
    v_mfma_f32_32x32x8_bf16 v[36:51], v[18:19], v[8:9], v[36:51]
    v_exp_f32 v60, v60
    v_exp_f32 v61, v61
    v_exp_f32 v62, v62
    v_exp_f32 v63, v63
    s_add_u32 m0, s25, 24576
    s_add_u32 s27, s24, 24576
    buffer_load_dwordx4 v217, s[8:11], s27 offen lds
    v_cvt_pk_bf16_f32 v32, v60, v61
    v_cvt_pk_bf16_f32 v33, v62, v63
    s_add_u32 m0, s25, 28672
    s_add_u32 s27, s24, 28672
    buffer_load_dwordx4 v217, s[8:11], s27 offen lds
    s_waitcnt lgkmcnt(2)
    v_mfma_f32_32x32x16_bf16 v[68:83], v[20:23], v[28:31], v[68:83]
    ds_read_b128 v[20:23], v86 offset:2560
    v_exp_f32 v64, v64
    v_exp_f32 v65, v65
    v_exp_f32 v66, v66
    v_exp_f32 v67, v67
    v_cvt_pk_bf16_f32 v34, v64, v65
    v_cvt_pk_bf16_f32 v35, v66, v67
    s_waitcnt vmcnt(8)
    s_barrier
    s_waitcnt lgkmcnt(2)
    v_mfma_f32_32x32x16_bf16 v[52:67], v[12:15], v[4:7], 0
    ds_read_b128 v[12:15], v84 offset:4096
    v_exp_f32 v36, v36
    v_exp_f32 v37, v37
    v_exp_f32 v38, v38
    v_exp_f32 v39, v39
    s_add_u32 m0, s25, 32768
    s_add_u32 s27, s24, 32768
    buffer_load_dwordx4 v217, s[8:11], s27 offen lds
    v_cvt_pk_bf16_f32 v28, v36, v37
    v_cvt_pk_bf16_f32 v29, v38, v39
    s_add_u32 m0, s25, 36864
    s_add_u32 s27, s24, 36864
    buffer_load_dwordx4 v217, s[8:11], s27 offen lds
    s_waitcnt lgkmcnt(2)
    v_mfma_f32_32x32x16_bf16 v[68:83], v[24:27], v[32:35], v[68:83]
    ds_read_b128 v[24:27], v86 offset:3200
    v_exp_f32 v40, v40
    v_exp_f32 v41, v41
    v_exp_f32 v42, v42
    v_exp_f32 v43, v43
    v_cvt_pk_bf16_f32 v30, v40, v41
    v_cvt_pk_bf16_f32 v31, v42, v43
    v_mfma_f32_32x32x8_bf16 v[52:67], v[18:19], v[10:11], v[52:67]
    ds_read_b128 v[16:19], v85 offset:512
    v_exp_f32 v44, v44
    v_exp_f32 v45, v45
    v_exp_f32 v46, v46
    v_exp_f32 v47, v47
    s_add_u32 m0, s25, 40960
    s_add_u32 s27, s24, 40960
    buffer_load_dwordx4 v217, s[8:11], s27 offen lds
    v_cvt_pk_bf16_f32 v32, v44, v45
    v_cvt_pk_bf16_f32 v33, v46, v47
    s_add_u32 m0, s25, 45056
    s_add_u32 s27, s24, 45056
    buffer_load_dwordx4 v217, s[8:11], s27 offen lds
    s_waitcnt lgkmcnt(3)
    v_mfma_f32_32x32x16_bf16 v[68:83], v[20:23], v[28:31], v[68:83]
    ds_read_b128 v[20:23], v86 offset:3840
    v_exp_f32 v48, v48
    v_exp_f32 v49, v49
    v_exp_f32 v50, v50
    v_exp_f32 v51, v51
    v_cvt_pk_bf16_f32 v34, v48, v49
    v_cvt_pk_bf16_f32 v35, v50, v51
    s_waitcnt lgkmcnt(3)
    v_mfma_f32_32x32x16_bf16 v[36:51], v[12:15], v[4:7], 0
    ds_read_b128 v[12:15], v84 offset:5120
    v_exp_f32 v52, v52
    v_exp_f32 v53, v53
    v_exp_f32 v54, v54
    v_exp_f32 v55, v55
    s_add_u32 m0, s25, 49152
    s_add_u32 s27, s24, 49152
    buffer_load_dwordx4 v217, s[8:11], s27 offen lds
    v_cvt_pk_bf16_f32 v28, v52, v53
    v_cvt_pk_bf16_f32 v29, v54, v55
    s_add_u32 m0, s25, 53248
    s_add_u32 s27, s24, 53248
    buffer_load_dwordx4 v217, s[8:11], s27 offen lds
    s_waitcnt lgkmcnt(3)
    v_mfma_f32_32x32x16_bf16 v[68:83], v[24:27], v[32:35], v[68:83]
    ds_read_b128 v[24:27], v86 offset:4480
    v_exp_f32 v56, v56
    v_exp_f32 v57, v57
    v_exp_f32 v58, v58
    v_exp_f32 v59, v59
    v_cvt_pk_bf16_f32 v30, v56, v57
    v_cvt_pk_bf16_f32 v31, v58, v59
    s_waitcnt lgkmcnt(3)
    v_mfma_f32_32x32x8_bf16 v[36:51], v[16:17], v[8:9], v[36:51]
    v_exp_f32 v60, v60
    v_exp_f32 v61, v61
    v_exp_f32 v62, v62
    v_exp_f32 v63, v63
    s_add_u32 m0, s25, 57344
    s_add_u32 s27, s24, 57344
    buffer_load_dwordx4 v217, s[8:11], s27 offen lds
    v_cvt_pk_bf16_f32 v32, v60, v61
    v_cvt_pk_bf16_f32 v33, v62, v63
    s_add_u32 m0, s25, 61440
    s_add_u32 s27, s24, 61440
    buffer_load_dwordx4 v217, s[8:11], s27 offen lds
    s_waitcnt lgkmcnt(2)
    v_mfma_f32_32x32x16_bf16 v[68:83], v[20:23], v[28:31], v[68:83]
    ds_read_b128 v[20:23], v86 offset:5120
    v_exp_f32 v64, v64
    v_exp_f32 v65, v65
    v_exp_f32 v66, v66
    v_exp_f32 v67, v67
    v_cvt_pk_bf16_f32 v34, v64, v65
    v_cvt_pk_bf16_f32 v35, v66, v67
    s_waitcnt lgkmcnt(2)
    v_mfma_f32_32x32x16_bf16 v[52:67], v[12:15], v[4:7], 0
    ds_read_b128 v[12:15], v84 offset:6144
    v_exp_f32 v36, v36
    v_exp_f32 v37, v37
    v_exp_f32 v38, v38
    v_exp_f32 v39, v39
    s_add_u32 m0, s25, 65536
    s_add_u32 s27, s24, 65536
    buffer_load_dwordx4 v217, s[8:11], s27 offen lds
    v_cvt_pk_bf16_f32 v28, v36, v37
    v_cvt_pk_bf16_f32 v29, v38, v39
    s_add_u32 m0, s25, 69632
    s_add_u32 s27, s24, 69632
    buffer_load_dwordx4 v217, s[8:11], s27 offen lds
    s_waitcnt lgkmcnt(2)
    v_mfma_f32_32x32x16_bf16 v[68:83], v[24:27], v[32:35], v[68:83]
    ds_read_b128 v[24:27], v86 offset:5760
    v_exp_f32 v40, v40
    v_exp_f32 v41, v41
    v_exp_f32 v42, v42
    v_exp_f32 v43, v43
    v_cvt_pk_bf16_f32 v30, v40, v41
    v_cvt_pk_bf16_f32 v31, v42, v43
    v_mfma_f32_32x32x8_bf16 v[52:67], v[16:17], v[10:11], v[52:67]
    v_exp_f32 v44, v44
    v_exp_f32 v45, v45
    v_exp_f32 v46, v46
    v_exp_f32 v47, v47
    s_add_u32 m0, s25, 73728
    s_add_u32 s27, s24, 73728
    buffer_load_dwordx4 v217, s[8:11], s27 offen lds
    v_cvt_pk_bf16_f32 v32, v44, v45
    v_cvt_pk_bf16_f32 v33, v46, v47
    s_add_u32 m0, s25, 77824
    s_add_u32 s27, s24, 77824
    buffer_load_dwordx4 v217, s[8:11], s27 offen lds
    s_waitcnt lgkmcnt(2)
    v_mfma_f32_32x32x16_bf16 v[68:83], v[20:23], v[28:31], v[68:83]
    ds_read_b128 v[20:23], v86 offset:6400
    v_exp_f32 v48, v48
    v_exp_f32 v49, v49
    v_exp_f32 v50, v50
    v_exp_f32 v51, v51
    v_cvt_pk_bf16_f32 v34, v48, v49
    v_cvt_pk_bf16_f32 v35, v50, v51
    s_waitcnt lgkmcnt(2)
    v_mfma_f32_32x32x16_bf16 v[36:51], v[12:15], v[4:7], 0
    ds_read_b128 v[12:15], v84 offset:7168
    v_exp_f32 v52, v52
    v_exp_f32 v53, v53
    v_exp_f32 v54, v54
    v_exp_f32 v55, v55
    s_add_u32 m0, s25, 81920
    s_add_u32 s27, s24, 81920
    buffer_load_dwordx4 v217, s[8:11], s27 offen lds
    v_cvt_pk_bf16_f32 v28, v52, v53
    v_cvt_pk_bf16_f32 v29, v54, v55
    s_add_u32 m0, s25, 86016
    s_add_u32 s27, s24, 86016
    buffer_load_dwordx4 v217, s[8:11], s27 offen lds
    s_waitcnt lgkmcnt(2)
    v_mfma_f32_32x32x16_bf16 v[68:83], v[24:27], v[32:35], v[68:83]
    ds_read_b128 v[24:27], v86 offset:7040
    v_exp_f32 v56, v56
    v_exp_f32 v57, v57
    v_exp_f32 v58, v58
    v_exp_f32 v59, v59
    v_cvt_pk_bf16_f32 v30, v56, v57
    v_cvt_pk_bf16_f32 v31, v58, v59
    v_mfma_f32_32x32x8_bf16 v[36:51], v[18:19], v[8:9], v[36:51]
    v_exp_f32 v60, v60
    v_exp_f32 v61, v61
    v_exp_f32 v62, v62
    v_exp_f32 v63, v63
    s_add_u32 m0, s25, 90112
    s_add_u32 s27, s24, 90112
    buffer_load_dwordx4 v217, s[8:11], s27 offen lds
    v_cvt_pk_bf16_f32 v32, v60, v61
    v_cvt_pk_bf16_f32 v33, v62, v63
    s_add_u32 m0, s25, 94208
    s_add_u32 s27, s24, 94208
    buffer_load_dwordx4 v217, s[8:11], s27 offen lds
    s_waitcnt lgkmcnt(2)
    v_mfma_f32_32x32x16_bf16 v[68:83], v[20:23], v[28:31], v[68:83]
    ds_read_b128 v[20:23], v86 offset:7680
    v_exp_f32 v64, v64
    v_exp_f32 v65, v65
    v_exp_f32 v66, v66
    v_exp_f32 v67, v67
    v_cvt_pk_bf16_f32 v34, v64, v65
    v_cvt_pk_bf16_f32 v35, v66, v67
    s_waitcnt lgkmcnt(2)
    v_mfma_f32_32x32x16_bf16 v[52:67], v[12:15], v[4:7], 0
    ds_read_b128 v[12:15], v84 offset:19456
    v_exp_f32 v36, v36
    v_exp_f32 v37, v37
    v_exp_f32 v38, v38
    v_exp_f32 v39, v39
    s_add_u32 m0, s25, 98304
    s_add_u32 s27, s24, 98304
    buffer_load_dwordx4 v217, s[8:11], s27 offen lds
    v_cvt_pk_bf16_f32 v28, v36, v37
    v_cvt_pk_bf16_f32 v29, v38, v39
    s_add_u32 m0, s25, 102400
    s_add_u32 s27, s24, 102400
    buffer_load_dwordx4 v217, s[8:11], s27 offen lds
    s_waitcnt lgkmcnt(2)
    v_mfma_f32_32x32x16_bf16 v[68:83], v[24:27], v[32:35], v[68:83]
    ds_read_b128 v[24:27], v86 offset:8320
    v_exp_f32 v40, v40
    v_exp_f32 v41, v41
    v_exp_f32 v42, v42
    v_exp_f32 v43, v43
    v_cvt_pk_bf16_f32 v30, v40, v41
    v_cvt_pk_bf16_f32 v31, v42, v43
    v_mfma_f32_32x32x8_bf16 v[52:67], v[18:19], v[10:11], v[52:67]
    ds_read_b128 v[16:19], v85 offset:19456
    v_exp_f32 v44, v44
    v_exp_f32 v45, v45
    v_exp_f32 v46, v46
    v_exp_f32 v47, v47
    s_add_u32 m0, s25, 106496
    s_add_u32 s27, s24, 106496
    buffer_load_dwordx4 v217, s[8:11], s27 offen lds
    v_cvt_pk_bf16_f32 v32, v44, v45
    v_cvt_pk_bf16_f32 v33, v46, v47
    s_add_u32 m0, s25, 110592
    s_add_u32 s27, s24, 110592
    buffer_load_dwordx4 v217, s[8:11], s27 offen lds
    s_waitcnt lgkmcnt(3)
    v_mfma_f32_32x32x16_bf16 v[68:83], v[20:23], v[28:31], v[68:83]
    ds_read_b128 v[20:23], v86 offset:8960
    v_exp_f32 v48, v48
    v_exp_f32 v49, v49
    v_exp_f32 v50, v50
    v_exp_f32 v51, v51
    v_cvt_pk_bf16_f32 v34, v48, v49
    v_cvt_pk_bf16_f32 v35, v50, v51
    s_waitcnt lgkmcnt(3)
    v_mfma_f32_32x32x16_bf16 v[36:51], v[12:15], v[4:7], 0
    ds_read_b128 v[12:15], v84 offset:20480
    v_exp_f32 v52, v52
    v_exp_f32 v53, v53
    v_exp_f32 v54, v54
    v_exp_f32 v55, v55
    s_add_u32 m0, s25, 114688
    s_add_u32 s27, s24, 114688
    buffer_load_dwordx4 v217, s[8:11], s27 offen lds
    v_cvt_pk_bf16_f32 v28, v52, v53
    v_cvt_pk_bf16_f32 v29, v54, v55
    s_add_u32 m0, s25, 118784
    s_add_u32 s27, s24, 118784
    buffer_load_dwordx4 v217, s[8:11], s27 offen lds
    s_waitcnt lgkmcnt(3)
    v_mfma_f32_32x32x16_bf16 v[68:83], v[24:27], v[32:35], v[68:83]
    ds_read_b128 v[24:27], v86 offset:9600
    v_exp_f32 v56, v56
    v_exp_f32 v57, v57
    v_exp_f32 v58, v58
    v_exp_f32 v59, v59
    v_cvt_pk_bf16_f32 v30, v56, v57
    v_cvt_pk_bf16_f32 v31, v58, v59
    s_waitcnt lgkmcnt(3)
    v_mfma_f32_32x32x8_bf16 v[36:51], v[16:17], v[8:9], v[36:51]
    v_exp_f32 v60, v60
    v_exp_f32 v61, v61
    v_exp_f32 v62, v62
    v_exp_f32 v63, v63
    v_cvt_pk_bf16_f32 v32, v60, v61
    v_cvt_pk_bf16_f32 v33, v62, v63
    s_waitcnt lgkmcnt(2)
    v_mfma_f32_32x32x16_bf16 v[68:83], v[20:23], v[28:31], v[68:83]
    ds_read_b128 v[20:23], v86 offset:19456
    v_exp_f32 v64, v64
    v_exp_f32 v65, v65
    v_exp_f32 v66, v66
    v_exp_f32 v67, v67
    v_cvt_pk_bf16_f32 v34, v64, v65
    v_cvt_pk_bf16_f32 v35, v66, v67
    v_add_u32 v84, 19456, v84
    v_add_u32 v85, 19456, v85
    v_add_u32 v86, 19456, v86
    s_waitcnt vmcnt(25)
    s_barrier
    s_cmp_eq_u32 s35, 3
    s_cbranch_scc1 L_k2_kernel_Pl_8
    s_cmp_eq_u32 s35, 1
    s_cbranch_scc1 L_k2_kernel_N_7
    s_mov_b32 s41, 1
L_k2_kernel_loop_9:
    s_waitcnt lgkmcnt(2)
    v_mfma_f32_32x32x16_bf16 v[52:67], v[12:15], v[4:7], 0
    ds_read_b128 v[12:15], v84 offset:2048
    v_exp_f32 v36, v36
    v_exp_f32 v37, v37
    v_exp_f32 v38, v38
    v_exp_f32 v39, v39
    s_waitcnt lgkmcnt(2)
    v_mfma_f32_32x32x16_bf16 v[68:83], v[24:27], v[32:35], v[68:83]
    ds_read_b128 v[24:27], v86 offset:640
    v_cvt_pk_bf16_f32 v28, v36, v37
    v_cvt_pk_bf16_f32 v29, v38, v39
    v_exp_f32 v40, v40
    v_exp_f32 v41, v41
    v_mfma_f32_32x32x8_bf16 v[52:67], v[16:17], v[10:11], v[52:67]
    v_exp_f32 v42, v42
    v_exp_f32 v43, v43
    v_cvt_pk_bf16_f32 v30, v40, v41
    v_cvt_pk_bf16_f32 v31, v42, v43
    s_waitcnt vmcnt(12)
    v_mfma_f32_32x32x16_bf16 v[100:115], v[132:135], v[136:139], v[100:115]
    v_exp_f32 v44, v44
    v_exp_f32 v45, v45
    v_exp_f32 v46, v46
    v_exp_f32 v47, v47
    v_mfma_f32_32x32x16_bf16 v[116:131], v[140:143], v[136:139], v[116:131]
    buffer_load_dwordx4 v[132:135], v212, s[8:11], s38 offen offset:256
    buffer_load_dwordx4 v[136:139], v213, s[8:11], s39 offen offset:64
    buffer_load_dwordx4 v[140:143], v214, s[8:11], s38 offen offset:256
    v_cvt_pk_bf16_f32 v32, v44, v45
    v_cvt_pk_bf16_f32 v33, v46, v47
    v_exp_f32 v48, v48
    v_exp_f32 v49, v49
    s_waitcnt lgkmcnt(2)
    v_mfma_f32_32x32x16_bf16 v[68:83], v[20:23], v[28:31], v[68:83]
    ds_read_b128 v[20:23], v86 offset:1280
    v_exp_f32 v50, v50
    v_exp_f32 v51, v51
    v_cvt_pk_bf16_f32 v34, v48, v49
    v_cvt_pk_bf16_f32 v35, v50, v51
    s_waitcnt lgkmcnt(2)
    v_mfma_f32_32x32x16_bf16 v[36:51], v[12:15], v[4:7], 0
    ds_read_b128 v[12:15], v84 offset:3072
    v_exp_f32 v52, v52
    v_exp_f32 v53, v53
    v_exp_f32 v54, v54
    v_exp_f32 v55, v55
    s_waitcnt lgkmcnt(2)
    v_mfma_f32_32x32x16_bf16 v[68:83], v[24:27], v[32:35], v[68:83]
    ds_read_b128 v[24:27], v86 offset:1920
    v_cvt_pk_bf16_f32 v28, v52, v53
    v_cvt_pk_bf16_f32 v29, v54, v55
    v_exp_f32 v56, v56
    v_exp_f32 v57, v57
    v_mfma_f32_32x32x8_bf16 v[36:51], v[18:19], v[8:9], v[36:51]
    v_exp_f32 v58, v58
    v_exp_f32 v59, v59
    v_cvt_pk_bf16_f32 v30, v56, v57
    v_cvt_pk_bf16_f32 v31, v58, v59
    s_waitcnt vmcnt(12)
    v_mfma_f32_32x32x16_bf16 v[100:115], v[148:151], v[152:155], v[100:115]
    v_exp_f32 v60, v60
    v_exp_f32 v61, v61
    v_exp_f32 v62, v62
    v_exp_f32 v63, v63
    v_mfma_f32_32x32x16_bf16 v[116:131], v[156:159], v[152:155], v[116:131]
    buffer_load_dwordx4 v[148:151], v212, s[8:11], s38 offen offset:288
    buffer_load_dwordx4 v[152:155], v213, s[8:11], s39 offen offset:3136
    buffer_load_dwordx4 v[156:159], v214, s[8:11], s38 offen offset:288
    v_cvt_pk_bf16_f32 v32, v60, v61
    v_cvt_pk_bf16_f32 v33, v62, v63
    v_exp_f32 v64, v64
    v_exp_f32 v65, v65
    s_waitcnt lgkmcnt(2)
    v_mfma_f32_32x32x16_bf16 v[68:83], v[20:23], v[28:31], v[68:83]
    ds_read_b128 v[20:23], v86 offset:2560
    v_exp_f32 v66, v66
    v_exp_f32 v67, v67
    v_cvt_pk_bf16_f32 v34, v64, v65
    v_cvt_pk_bf16_f32 v35, v66, v67
    s_waitcnt lgkmcnt(2)
    v_mfma_f32_32x32x16_bf16 v[52:67], v[12:15], v[4:7], 0
    ds_read_b128 v[12:15], v84 offset:4096
    v_exp_f32 v36, v36
    v_exp_f32 v37, v37
    v_exp_f32 v38, v38
    s_waitcnt lgkmcnt(2)
    v_mfma_f32_32x32x16_bf16 v[68:83], v[24:27], v[32:35], v[68:83]
    ds_read_b128 v[24:27], v86 offset:3200
    v_exp_f32 v39, v39
    v_cvt_pk_bf16_f32 v28, v36, v37
    v_cvt_pk_bf16_f32 v29, v38, v39
    s_waitcnt vmcnt(12)
    v_mfma_f32_32x32x16_bf16 v[100:115], v[164:167], v[168:171], v[100:115]
    v_exp_f32 v40, v40
    v_exp_f32 v41, v41
    v_exp_f32 v42, v42
    v_mfma_f32_32x32x16_bf16 v[116:131], v[172:175], v[168:171], v[116:131]
    buffer_load_dwordx4 v[164:167], v212, s[8:11], s38 offen offset:192
    buffer_load_dwordx4 v[168:171], v213, s[8:11], s39 offen offset:48
    buffer_load_dwordx4 v[172:175], v214, s[8:11], s38 offen offset:192
    v_exp_f32 v43, v43
    v_cvt_pk_bf16_f32 v30, v40, v41
    v_cvt_pk_bf16_f32 v31, v42, v43
    v_mfma_f32_32x32x8_bf16 v[52:67], v[18:19], v[10:11], v[52:67]
    ds_read_b128 v[16:19], v85 offset:512
    v_exp_f32 v44, v44
    v_exp_f32 v45, v45
    v_exp_f32 v46, v46
    s_waitcnt vmcnt(12)
    v_mfma_f32_32x32x16_bf16 v[100:115], v[180:183], v[184:187], v[100:115]
    v_exp_f32 v47, v47
    v_cvt_pk_bf16_f32 v32, v44, v45
    v_cvt_pk_bf16_f32 v33, v46, v47
    v_mfma_f32_32x32x16_bf16 v[116:131], v[188:191], v[184:187], v[116:131]
    buffer_load_dwordx4 v[180:183], v212, s[8:11], s38 offen offset:224
    buffer_load_dwordx4 v[184:187], v213, s[8:11], s39 offen offset:3120
    buffer_load_dwordx4 v[188:191], v214, s[8:11], s38 offen offset:224
    v_exp_f32 v48, v48
    v_exp_f32 v49, v49
    v_exp_f32 v50, v50
    s_waitcnt lgkmcnt(3)
    v_mfma_f32_32x32x16_bf16 v[68:83], v[20:23], v[28:31], v[68:83]
    ds_read_b128 v[20:23], v86 offset:3840
    v_exp_f32 v51, v51
    v_cvt_pk_bf16_f32 v34, v48, v49
    v_cvt_pk_bf16_f32 v35, v50, v51
    s_waitcnt lgkmcnt(3)
    v_mfma_f32_32x32x16_bf16 v[36:51], v[12:15], v[4:7], 0
    ds_read_b128 v[12:15], v84 offset:5120
    v_exp_f32 v52, v52
    v_exp_f32 v53, v53
    v_exp_f32 v54, v54
    v_exp_f32 v55, v55
    s_waitcnt lgkmcnt(3)
    v_mfma_f32_32x32x16_bf16 v[68:83], v[24:27], v[32:35], v[68:83]
    ds_read_b128 v[24:27], v86 offset:4480
    v_cvt_pk_bf16_f32 v28, v52, v53
    v_cvt_pk_bf16_f32 v29, v54, v55
    v_exp_f32 v56, v56
    v_exp_f32 v57, v57
    s_waitcnt lgkmcnt(3)
    v_mfma_f32_32x32x8_bf16 v[36:51], v[16:17], v[8:9], v[36:51]
    v_exp_f32 v58, v58
    v_exp_f32 v59, v59
    v_cvt_pk_bf16_f32 v30, v56, v57
    v_cvt_pk_bf16_f32 v31, v58, v59
    s_waitcnt vmcnt(12)
    v_mfma_f32_32x32x16_bf16 v[100:115], v[196:199], v[200:203], v[100:115]
    v_exp_f32 v60, v60
    v_exp_f32 v61, v61
    v_exp_f32 v62, v62
    v_exp_f32 v63, v63
    v_mfma_f32_32x32x16_bf16 v[116:131], v[204:207], v[200:203], v[116:131]
    buffer_load_dwordx4 v[196:199], v212, s[8:11], s38 offen offset:128
    buffer_load_dwordx4 v[200:203], v213, s[8:11], s39 offen offset:32
    buffer_load_dwordx4 v[204:207], v214, s[8:11], s38 offen offset:128
    v_cvt_pk_bf16_f32 v32, v60, v61
    v_cvt_pk_bf16_f32 v33, v62, v63
    v_exp_f32 v64, v64
    v_exp_f32 v65, v65
    s_waitcnt lgkmcnt(2)
    v_mfma_f32_32x32x16_bf16 v[68:83], v[20:23], v[28:31], v[68:83]
    ds_read_b128 v[20:23], v86 offset:5120
    v_exp_f32 v66, v66
    v_exp_f32 v67, v67
    v_cvt_pk_bf16_f32 v34, v64, v65
    v_cvt_pk_bf16_f32 v35, v66, v67
    s_waitcnt lgkmcnt(2)
    v_mfma_f32_32x32x16_bf16 v[52:67], v[12:15], v[4:7], 0
    ds_read_b128 v[12:15], v84 offset:6144
    v_exp_f32 v36, v36
    v_exp_f32 v37, v37
    v_exp_f32 v38, v38
    v_exp_f32 v39, v39
    s_waitcnt lgkmcnt(2)
    v_mfma_f32_32x32x16_bf16 v[68:83], v[24:27], v[32:35], v[68:83]
    ds_read_b128 v[24:27], v86 offset:5760
    v_cvt_pk_bf16_f32 v28, v36, v37
    v_cvt_pk_bf16_f32 v29, v38, v39
    v_exp_f32 v40, v40
    v_exp_f32 v41, v41
    v_mfma_f32_32x32x8_bf16 v[52:67], v[16:17], v[10:11], v[52:67]
    v_exp_f32 v42, v42
    v_exp_f32 v43, v43
    v_cvt_pk_bf16_f32 v30, v40, v41
    v_cvt_pk_bf16_f32 v31, v42, v43
    s_waitcnt vmcnt(12)
    v_mfma_f32_32x32x16_bf16 v[100:115], v[132:135], v[136:139], v[100:115]
    v_exp_f32 v44, v44
    v_exp_f32 v45, v45
    v_exp_f32 v46, v46
    v_exp_f32 v47, v47
    v_mfma_f32_32x32x16_bf16 v[116:131], v[140:143], v[136:139], v[116:131]
    buffer_load_dwordx4 v[132:135], v212, s[8:11], s38 offen offset:160
    buffer_load_dwordx4 v[136:139], v213, s[8:11], s39 offen offset:3104
    buffer_load_dwordx4 v[140:143], v214, s[8:11], s38 offen offset:160
    v_cvt_pk_bf16_f32 v32, v44, v45
    v_cvt_pk_bf16_f32 v33, v46, v47
    v_exp_f32 v48, v48
    v_exp_f32 v49, v49
    s_waitcnt lgkmcnt(2)
    v_mfma_f32_32x32x16_bf16 v[68:83], v[20:23], v[28:31], v[68:83]
    ds_read_b128 v[20:23], v86 offset:6400
    v_exp_f32 v50, v50
    v_exp_f32 v51, v51
    v_cvt_pk_bf16_f32 v34, v48, v49
    v_cvt_pk_bf16_f32 v35, v50, v51
    s_waitcnt lgkmcnt(2)
    v_mfma_f32_32x32x16_bf16 v[36:51], v[12:15], v[4:7], 0
    ds_read_b128 v[12:15], v84 offset:7168
    v_exp_f32 v52, v52
    v_exp_f32 v53, v53
    v_exp_f32 v54, v54
    v_exp_f32 v55, v55
    s_waitcnt lgkmcnt(2)
    v_mfma_f32_32x32x16_bf16 v[68:83], v[24:27], v[32:35], v[68:83]
    ds_read_b128 v[24:27], v86 offset:7040
    v_cvt_pk_bf16_f32 v28, v52, v53
    v_cvt_pk_bf16_f32 v29, v54, v55
    v_exp_f32 v56, v56
    v_exp_f32 v57, v57
    v_mfma_f32_32x32x8_bf16 v[36:51], v[18:19], v[8:9], v[36:51]
    v_exp_f32 v58, v58
    v_exp_f32 v59, v59
    v_cvt_pk_bf16_f32 v30, v56, v57
    v_cvt_pk_bf16_f32 v31, v58, v59
    s_waitcnt vmcnt(12)
    v_mfma_f32_32x32x16_bf16 v[100:115], v[148:151], v[152:155], v[100:115]
    v_exp_f32 v60, v60
    v_exp_f32 v61, v61
    v_exp_f32 v62, v62
    v_exp_f32 v63, v63
    v_mfma_f32_32x32x16_bf16 v[116:131], v[156:159], v[152:155], v[116:131]
    buffer_load_dwordx4 v[148:151], v212, s[8:11], s38 offen offset:64
    buffer_load_dwordx4 v[152:155], v213, s[8:11], s39 offen offset:16
    buffer_load_dwordx4 v[156:159], v214, s[8:11], s38 offen offset:64
    v_cvt_pk_bf16_f32 v32, v60, v61
    v_cvt_pk_bf16_f32 v33, v62, v63
    v_exp_f32 v64, v64
    v_exp_f32 v65, v65
    s_waitcnt lgkmcnt(2)
    v_mfma_f32_32x32x16_bf16 v[68:83], v[20:23], v[28:31], v[68:83]
    ds_read_b128 v[20:23], v86 offset:7680
    v_exp_f32 v66, v66
    v_exp_f32 v67, v67
    v_cvt_pk_bf16_f32 v34, v64, v65
    v_cvt_pk_bf16_f32 v35, v66, v67
    s_waitcnt lgkmcnt(2)
    v_mfma_f32_32x32x16_bf16 v[52:67], v[12:15], v[4:7], 0
    ds_read_b128 v[12:15], v84 offset:19456
    v_exp_f32 v36, v36
    v_exp_f32 v37, v37
    v_exp_f32 v38, v38
    s_waitcnt lgkmcnt(2)
    v_mfma_f32_32x32x16_bf16 v[68:83], v[24:27], v[32:35], v[68:83]
    ds_read_b128 v[24:27], v86 offset:8320
    v_exp_f32 v39, v39
    v_cvt_pk_bf16_f32 v28, v36, v37
    v_cvt_pk_bf16_f32 v29, v38, v39
    s_waitcnt vmcnt(12)
    v_mfma_f32_32x32x16_bf16 v[100:115], v[164:167], v[168:171], v[100:115]
    v_exp_f32 v40, v40
    v_exp_f32 v41, v41
    v_exp_f32 v42, v42
    v_mfma_f32_32x32x16_bf16 v[116:131], v[172:175], v[168:171], v[116:131]
    buffer_load_dwordx4 v[164:167], v212, s[8:11], s38 offen offset:96
    buffer_load_dwordx4 v[168:171], v213, s[8:11], s39 offen offset:3088
    buffer_load_dwordx4 v[172:175], v214, s[8:11], s38 offen offset:96
    v_exp_f32 v43, v43
    v_cvt_pk_bf16_f32 v30, v40, v41
    v_cvt_pk_bf16_f32 v31, v42, v43
    v_mfma_f32_32x32x8_bf16 v[52:67], v[18:19], v[10:11], v[52:67]
    ds_read_b128 v[16:19], v85 offset:19456
    v_exp_f32 v44, v44
    v_exp_f32 v45, v45
    v_exp_f32 v46, v46
    s_waitcnt vmcnt(12)
    v_mfma_f32_32x32x16_bf16 v[100:115], v[180:183], v[184:187], v[100:115]
    v_exp_f32 v47, v47
    v_cvt_pk_bf16_f32 v32, v44, v45
    v_cvt_pk_bf16_f32 v33, v46, v47
    v_mfma_f32_32x32x16_bf16 v[116:131], v[188:191], v[184:187], v[116:131]
    buffer_load_dwordx4 v[180:183], v212, s[8:11], s38 offen offset:0
    buffer_load_dwordx4 v[184:187], v213, s[8:11], s39 offen offset:0
    buffer_load_dwordx4 v[188:191], v214, s[8:11], s38 offen offset:0
    v_exp_f32 v48, v48
    v_exp_f32 v49, v49
    v_exp_f32 v50, v50
    s_waitcnt lgkmcnt(3)
    v_mfma_f32_32x32x16_bf16 v[68:83], v[20:23], v[28:31], v[68:83]
    ds_read_b128 v[20:23], v86 offset:8960
    v_exp_f32 v51, v51
    v_cvt_pk_bf16_f32 v34, v48, v49
    v_cvt_pk_bf16_f32 v35, v50, v51
    s_waitcnt lgkmcnt(3)
    v_mfma_f32_32x32x16_bf16 v[36:51], v[12:15], v[4:7], 0
    ds_read_b128 v[12:15], v84 offset:20480
    v_exp_f32 v52, v52
    v_exp_f32 v53, v53
    v_exp_f32 v54, v54
    v_exp_f32 v55, v55
    s_waitcnt lgkmcnt(3)
    v_mfma_f32_32x32x16_bf16 v[68:83], v[24:27], v[32:35], v[68:83]
    ds_read_b128 v[24:27], v86 offset:9600
    v_cvt_pk_bf16_f32 v28, v52, v53
    v_cvt_pk_bf16_f32 v29, v54, v55
    v_exp_f32 v56, v56
    v_exp_f32 v57, v57
    s_waitcnt lgkmcnt(3)
    v_mfma_f32_32x32x8_bf16 v[36:51], v[16:17], v[8:9], v[36:51]
    v_exp_f32 v58, v58
    v_exp_f32 v59, v59
    v_cvt_pk_bf16_f32 v30, v56, v57
    v_cvt_pk_bf16_f32 v31, v58, v59
    s_waitcnt vmcnt(12)
    s_cmp_eq_u32 s41, 7
    s_cbranch_scc1 L_k2_kernel_skipx_10
    v_mfma_f32_32x32x16_bf16 v[100:115], v[196:199], v[200:203], v[100:115]
L_k2_kernel_skipx_10:
    v_exp_f32 v60, v60
    v_exp_f32 v61, v61
    v_exp_f32 v62, v62
    v_exp_f32 v63, v63
    s_cmp_eq_u32 s41, 7
    s_cbranch_scc1 L_k2_kernel_skipx_11
    v_mfma_f32_32x32x16_bf16 v[116:131], v[204:207], v[200:203], v[116:131]
L_k2_kernel_skipx_11:
    buffer_load_dwordx4 v[196:199], v212, s[8:11], s38 offen offset:32
    buffer_load_dwordx4 v[200:203], v213, s[8:11], s39 offen offset:3072
    buffer_load_dwordx4 v[204:207], v214, s[8:11], s38 offen offset:32
    v_cvt_pk_bf16_f32 v32, v60, v61
    v_cvt_pk_bf16_f32 v33, v62, v63
    v_exp_f32 v64, v64
    v_exp_f32 v65, v65
    s_waitcnt lgkmcnt(2)
    v_mfma_f32_32x32x16_bf16 v[68:83], v[20:23], v[28:31], v[68:83]
    ds_read_b128 v[20:23], v86 offset:19456
    v_exp_f32 v66, v66
    v_exp_f32 v67, v67
    v_cvt_pk_bf16_f32 v34, v64, v65
    v_cvt_pk_bf16_f32 v35, v66, v67
    v_add_u32 v84, 19456, v84
    v_add_u32 v85, 19456, v85
    v_add_u32 v86, 19456, v86
    s_sub_u32 s38, s38, 320
    s_sub_u32 s39, s39, 80
    s_add_u32 s41, s41, 1
    s_cmp_eq_u32 s41, 2
    s_cbranch_scc0 L_k2_kernel_nobar_12
    s_barrier
L_k2_kernel_nobar_12:
    s_cmp_lt_u32 s41, 8
    s_cbranch_scc1 L_k2_kernel_loop_9
    s_branch L_k2_kernel_join_6
L_k2_kernel_N_7:
    s_mov_b32 s41, 1
L_k2_kernel_loop_13:
    s_waitcnt lgkmcnt(2)
    v_mfma_f32_32x32x16_bf16 v[52:67], v[12:15], v[4:7], 0
    ds_read_b128 v[12:15], v84 offset:2048
    v_exp_f32 v36, v36
    v_exp_f32 v37, v37
    v_exp_f32 v38, v38
    v_exp_f32 v39, v39
    s_waitcnt lgkmcnt(2)
    v_mfma_f32_32x32x16_bf16 v[68:83], v[24:27], v[32:35], v[68:83]
    ds_read_b128 v[24:27], v86 offset:640
    v_cvt_pk_bf16_f32 v28, v36, v37
    v_cvt_pk_bf16_f32 v29, v38, v39
    v_exp_f32 v40, v40
    v_exp_f32 v41, v41
    v_mfma_f32_32x32x8_bf16 v[52:67], v[16:17], v[10:11], v[52:67]
    v_exp_f32 v42, v42
    v_exp_f32 v43, v43
    v_cvt_pk_bf16_f32 v30, v40, v41
    v_cvt_pk_bf16_f32 v31, v42, v43
    s_waitcnt vmcnt(16)
    v_mfma_f32_32x32x16_bf16 v[100:115], v[132:135], v[136:139], v[100:115]
    v_exp_f32 v44, v44
    v_exp_f32 v45, v45
    v_exp_f32 v46, v46
    v_exp_f32 v47, v47
    v_mfma_f32_32x32x16_bf16 v[116:131], v[140:143], v[144:147], v[116:131]
    buffer_load_dwordx4 v[132:135], v212, s[8:11], s38 offen offset:256
    buffer_load_dwordx4 v[136:139], v213, s[8:11], s39 offen offset:64
    buffer_load_dwordx4 v[140:143], v214, s[8:11], s38 offen offset:256
    buffer_load_dwordx4 v[144:147], v215, s[8:11], s39 offen offset:64
    v_cvt_pk_bf16_f32 v32, v44, v45
    v_cvt_pk_bf16_f32 v33, v46, v47
    v_exp_f32 v48, v48
    v_exp_f32 v49, v49
    s_waitcnt lgkmcnt(2)
    v_mfma_f32_32x32x16_bf16 v[68:83], v[20:23], v[28:31], v[68:83]
    ds_read_b128 v[20:23], v86 offset:1280
    v_exp_f32 v50, v50
    v_exp_f32 v51, v51
    v_cvt_pk_bf16_f32 v34, v48, v49
    v_cvt_pk_bf16_f32 v35, v50, v51
    s_waitcnt lgkmcnt(2)
    v_mfma_f32_32x32x16_bf16 v[36:51], v[12:15], v[4:7], 0
    ds_read_b128 v[12:15], v84 offset:3072
    v_exp_f32 v52, v52
    v_exp_f32 v53, v53
    v_exp_f32 v54, v54
    v_exp_f32 v55, v55
    s_waitcnt lgkmcnt(2)
    v_mfma_f32_32x32x16_bf16 v[68:83], v[24:27], v[32:35], v[68:83]
    ds_read_b128 v[24:27], v86 offset:1920
    v_cvt_pk_bf16_f32 v28, v52, v53
    v_cvt_pk_bf16_f32 v29, v54, v55
    v_exp_f32 v56, v56
    v_exp_f32 v57, v57
    v_mfma_f32_32x32x8_bf16 v[36:51], v[18:19], v[8:9], v[36:51]
    v_exp_f32 v58, v58
    v_exp_f32 v59, v59
    v_cvt_pk_bf16_f32 v30, v56, v57
    v_cvt_pk_bf16_f32 v31, v58, v59
    s_waitcnt vmcnt(16)
    v_mfma_f32_32x32x16_bf16 v[100:115], v[148:151], v[152:155], v[100:115]
    v_exp_f32 v60, v60
    v_exp_f32 v61, v61
    v_exp_f32 v62, v62
    v_exp_f32 v63, v63
    v_mfma_f32_32x32x16_bf16 v[116:131], v[156:159], v[160:163], v[116:131]
    buffer_load_dwordx4 v[148:151], v212, s[8:11], s38 offen offset:288
    buffer_load_dwordx4 v[152:155], v213, s[8:11], s39 offen offset:3136
    buffer_load_dwordx4 v[156:159], v214, s[8:11], s38 offen offset:288
    buffer_load_dwordx4 v[160:163], v215, s[8:11], s39 offen offset:3136
    v_cvt_pk_bf16_f32 v32, v60, v61
    v_cvt_pk_bf16_f32 v33, v62, v63
    v_exp_f32 v64, v64
    v_exp_f32 v65, v65
    s_waitcnt lgkmcnt(2)
    v_mfma_f32_32x32x16_bf16 v[68:83], v[20:23], v[28:31], v[68:83]
    ds_read_b128 v[20:23], v86 offset:2560
    v_exp_f32 v66, v66
    v_exp_f32 v67, v67
    v_cvt_pk_bf16_f32 v34, v64, v65
    v_cvt_pk_bf16_f32 v35, v66, v67
    s_waitcnt lgkmcnt(2)
    v_mfma_f32_32x32x16_bf16 v[52:67], v[12:15], v[4:7], 0
    ds_read_b128 v[12:15], v84 offset:4096
    v_exp_f32 v36, v36
    v_exp_f32 v37, v37
    v_exp_f32 v38, v38
    s_waitcnt lgkmcnt(2)
    v_mfma_f32_32x32x16_bf16 v[68:83], v[24:27], v[32:35], v[68:83]
    ds_read_b128 v[24:27], v86 offset:3200
    v_exp_f32 v39, v39
    v_cvt_pk_bf16_f32 v28, v36, v37
    v_cvt_pk_bf16_f32 v29, v38, v39
    s_waitcnt vmcnt(16)
    v_mfma_f32_32x32x16_bf16 v[100:115], v[164:167], v[168:171], v[100:115]
    v_exp_f32 v40, v40
    v_exp_f32 v41, v41
    v_exp_f32 v42, v42
    v_mfma_f32_32x32x16_bf16 v[116:131], v[172:175], v[176:179], v[116:131]
    buffer_load_dwordx4 v[164:167], v212, s[8:11], s38 offen offset:192
    buffer_load_dwordx4 v[168:171], v213, s[8:11], s39 offen offset:48
    buffer_load_dwordx4 v[172:175], v214, s[8:11], s38 offen offset:192
    buffer_load_dwordx4 v[176:179], v215, s[8:11], s39 offen offset:48
    v_exp_f32 v43, v43
    v_cvt_pk_bf16_f32 v30, v40, v41
    v_cvt_pk_bf16_f32 v31, v42, v43
    v_mfma_f32_32x32x8_bf16 v[52:67], v[18:19], v[10:11], v[52:67]
    ds_read_b128 v[16:19], v85 offset:512
    v_exp_f32 v44, v44
    v_exp_f32 v45, v45
    v_exp_f32 v46, v46
    s_waitcnt vmcnt(16)
    v_mfma_f32_32x32x16_bf16 v[100:115], v[180:183], v[184:187], v[100:115]
    v_exp_f32 v47, v47
    v_cvt_pk_bf16_f32 v32, v44, v45
    v_cvt_pk_bf16_f32 v33, v46, v47
    v_mfma_f32_32x32x16_bf16 v[116:131], v[188:191], v[192:195], v[116:131]
    buffer_load_dwordx4 v[180:183], v212, s[8:11], s38 offen offset:224
    buffer_load_dwordx4 v[184:187], v213, s[8:11], s39 offen offset:3120
    buffer_load_dwordx4 v[188:191], v214, s[8:11], s38 offen offset:224
    buffer_load_dwordx4 v[192:195], v215, s[8:11], s39 offen offset:3120
    v_exp_f32 v48, v48
    v_exp_f32 v49, v49
    v_exp_f32 v50, v50
    s_waitcnt lgkmcnt(3)
    v_mfma_f32_32x32x16_bf16 v[68:83], v[20:23], v[28:31], v[68:83]
    ds_read_b128 v[20:23], v86 offset:3840
    v_exp_f32 v51, v51
    v_cvt_pk_bf16_f32 v34, v48, v49
    v_cvt_pk_bf16_f32 v35, v50, v51
    s_waitcnt lgkmcnt(3)
    v_mfma_f32_32x32x16_bf16 v[36:51], v[12:15], v[4:7], 0
    ds_read_b128 v[12:15], v84 offset:5120
    v_exp_f32 v52, v52
    v_exp_f32 v53, v53
    v_exp_f32 v54, v54
    v_exp_f32 v55, v55
    s_waitcnt lgkmcnt(3)
    v_mfma_f32_32x32x16_bf16 v[68:83], v[24:27], v[32:35], v[68:83]
    ds_read_b128 v[24:27], v86 offset:4480
    v_cvt_pk_bf16_f32 v28, v52, v53
    v_cvt_pk_bf16_f32 v29, v54, v55
    v_exp_f32 v56, v56
    v_exp_f32 v57, v57
    s_waitcnt lgkmcnt(3)
    v_mfma_f32_32x32x8_bf16 v[36:51], v[16:17], v[8:9], v[36:51]
    v_exp_f32 v58, v58
    v_exp_f32 v59, v59
    v_cvt_pk_bf16_f32 v30, v56, v57
    v_cvt_pk_bf16_f32 v31, v58, v59
    s_waitcnt vmcnt(16)
    v_mfma_f32_32x32x16_bf16 v[100:115], v[196:199], v[200:203], v[100:115]
    v_exp_f32 v60, v60
    v_exp_f32 v61, v61
    v_exp_f32 v62, v62
    v_exp_f32 v63, v63
    v_mfma_f32_32x32x16_bf16 v[116:131], v[204:207], v[208:211], v[116:131]
    buffer_load_dwordx4 v[196:199], v212, s[8:11], s38 offen offset:128
    buffer_load_dwordx4 v[200:203], v213, s[8:11], s39 offen offset:32
    buffer_load_dwordx4 v[204:207], v214, s[8:11], s38 offen offset:128
    buffer_load_dwordx4 v[208:211], v215, s[8:11], s39 offen offset:32
    v_cvt_pk_bf16_f32 v32, v60, v61
    v_cvt_pk_bf16_f32 v33, v62, v63
    v_exp_f32 v64, v64
    v_exp_f32 v65, v65
    s_waitcnt lgkmcnt(2)
    v_mfma_f32_32x32x16_bf16 v[68:83], v[20:23], v[28:31], v[68:83]
    ds_read_b128 v[20:23], v86 offset:5120
    v_exp_f32 v66, v66
    v_exp_f32 v67, v67
    v_cvt_pk_bf16_f32 v34, v64, v65
    v_cvt_pk_bf16_f32 v35, v66, v67
    s_waitcnt lgkmcnt(2)
    v_mfma_f32_32x32x16_bf16 v[52:67], v[12:15], v[4:7], 0
    ds_read_b128 v[12:15], v84 offset:6144
    v_exp_f32 v36, v36
    v_exp_f32 v37, v37
    v_exp_f32 v38, v38
    v_exp_f32 v39, v39
    s_waitcnt lgkmcnt(2)
    v_mfma_f32_32x32x16_bf16 v[68:83], v[24:27], v[32:35], v[68:83]
    ds_read_b128 v[24:27], v86 offset:5760
    v_cvt_pk_bf16_f32 v28, v36, v37
    v_cvt_pk_bf16_f32 v29, v38, v39
    v_exp_f32 v40, v40
    v_exp_f32 v41, v41
    v_mfma_f32_32x32x8_bf16 v[52:67], v[16:17], v[10:11], v[52:67]
    v_exp_f32 v42, v42
    v_exp_f32 v43, v43
    v_cvt_pk_bf16_f32 v30, v40, v41
    v_cvt_pk_bf16_f32 v31, v42, v43
    s_waitcnt vmcnt(16)
    v_mfma_f32_32x32x16_bf16 v[100:115], v[132:135], v[136:139], v[100:115]
    v_exp_f32 v44, v44
    v_exp_f32 v45, v45
    v_exp_f32 v46, v46
    v_exp_f32 v47, v47
    v_mfma_f32_32x32x16_bf16 v[116:131], v[140:143], v[144:147], v[116:131]
    buffer_load_dwordx4 v[132:135], v212, s[8:11], s38 offen offset:160
    buffer_load_dwordx4 v[136:139], v213, s[8:11], s39 offen offset:3104
    buffer_load_dwordx4 v[140:143], v214, s[8:11], s38 offen offset:160
    buffer_load_dwordx4 v[144:147], v215, s[8:11], s39 offen offset:3104
    v_cvt_pk_bf16_f32 v32, v44, v45
    v_cvt_pk_bf16_f32 v33, v46, v47
    v_exp_f32 v48, v48
    v_exp_f32 v49, v49
    s_waitcnt lgkmcnt(2)
    v_mfma_f32_32x32x16_bf16 v[68:83], v[20:23], v[28:31], v[68:83]
    ds_read_b128 v[20:23], v86 offset:6400
    v_exp_f32 v50, v50
    v_exp_f32 v51, v51
    v_cvt_pk_bf16_f32 v34, v48, v49
    v_cvt_pk_bf16_f32 v35, v50, v51
    s_waitcnt lgkmcnt(2)
    v_mfma_f32_32x32x16_bf16 v[36:51], v[12:15], v[4:7], 0
    ds_read_b128 v[12:15], v84 offset:7168
    v_exp_f32 v52, v52
    v_exp_f32 v53, v53
    v_exp_f32 v54, v54
    v_exp_f32 v55, v55
    s_waitcnt lgkmcnt(2)
    v_mfma_f32_32x32x16_bf16 v[68:83], v[24:27], v[32:35], v[68:83]
    ds_read_b128 v[24:27], v86 offset:7040
    v_cvt_pk_bf16_f32 v28, v52, v53
    v_cvt_pk_bf16_f32 v29, v54, v55
    v_exp_f32 v56, v56
    v_exp_f32 v57, v57
    v_mfma_f32_32x32x8_bf16 v[36:51], v[18:19], v[8:9], v[36:51]
    v_exp_f32 v58, v58
    v_exp_f32 v59, v59
    v_cvt_pk_bf16_f32 v30, v56, v57
    v_cvt_pk_bf16_f32 v31, v58, v59
    s_waitcnt vmcnt(16)
    v_mfma_f32_32x32x16_bf16 v[100:115], v[148:151], v[152:155], v[100:115]
    v_exp_f32 v60, v60
    v_exp_f32 v61, v61
    v_exp_f32 v62, v62
    v_exp_f32 v63, v63
    v_mfma_f32_32x32x16_bf16 v[116:131], v[156:159], v[160:163], v[116:131]
    buffer_load_dwordx4 v[148:151], v212, s[8:11], s38 offen offset:64
    buffer_load_dwordx4 v[152:155], v213, s[8:11], s39 offen offset:16
    buffer_load_dwordx4 v[156:159], v214, s[8:11], s38 offen offset:64
    buffer_load_dwordx4 v[160:163], v215, s[8:11], s39 offen offset:16
    v_cvt_pk_bf16_f32 v32, v60, v61
    v_cvt_pk_bf16_f32 v33, v62, v63
    v_exp_f32 v64, v64
    v_exp_f32 v65, v65
    s_waitcnt lgkmcnt(2)
    v_mfma_f32_32x32x16_bf16 v[68:83], v[20:23], v[28:31], v[68:83]
    ds_read_b128 v[20:23], v86 offset:7680
    v_exp_f32 v66, v66
    v_exp_f32 v67, v67
    v_cvt_pk_bf16_f32 v34, v64, v65
    v_cvt_pk_bf16_f32 v35, v66, v67
    s_waitcnt lgkmcnt(2)
    v_mfma_f32_32x32x16_bf16 v[52:67], v[12:15], v[4:7], 0
    ds_read_b128 v[12:15], v84 offset:19456
    v_exp_f32 v36, v36
    v_exp_f32 v37, v37
    v_exp_f32 v38, v38
    s_waitcnt lgkmcnt(2)
    v_mfma_f32_32x32x16_bf16 v[68:83], v[24:27], v[32:35], v[68:83]
    ds_read_b128 v[24:27], v86 offset:8320
    v_exp_f32 v39, v39
    v_cvt_pk_bf16_f32 v28, v36, v37
    v_cvt_pk_bf16_f32 v29, v38, v39
    s_waitcnt vmcnt(16)
    v_mfma_f32_32x32x16_bf16 v[100:115], v[164:167], v[168:171], v[100:115]
    v_exp_f32 v40, v40
    v_exp_f32 v41, v41
    v_exp_f32 v42, v42
    v_mfma_f32_32x32x16_bf16 v[116:131], v[172:175], v[176:179], v[116:131]
    buffer_load_dwordx4 v[164:167], v212, s[8:11], s38 offen offset:96
    buffer_load_dwordx4 v[168:171], v213, s[8:11], s39 offen offset:3088
    buffer_load_dwordx4 v[172:175], v214, s[8:11], s38 offen offset:96
    buffer_load_dwordx4 v[176:179], v215, s[8:11], s39 offen offset:3088
    v_exp_f32 v43, v43
    v_cvt_pk_bf16_f32 v30, v40, v41
    v_cvt_pk_bf16_f32 v31, v42, v43
    v_mfma_f32_32x32x8_bf16 v[52:67], v[18:19], v[10:11], v[52:67]
    ds_read_b128 v[16:19], v85 offset:19456
    v_exp_f32 v44, v44
    v_exp_f32 v45, v45
    v_exp_f32 v46, v46
    s_waitcnt vmcnt(16)
    v_mfma_f32_32x32x16_bf16 v[100:115], v[180:183], v[184:187], v[100:115]
    v_exp_f32 v47, v47
    v_cvt_pk_bf16_f32 v32, v44, v45
    v_cvt_pk_bf16_f32 v33, v46, v47
    v_mfma_f32_32x32x16_bf16 v[116:131], v[188:191], v[192:195], v[116:131]
    buffer_load_dwordx4 v[180:183], v212, s[8:11], s38 offen offset:0
    buffer_load_dwordx4 v[184:187], v213, s[8:11], s39 offen offset:0
    buffer_load_dwordx4 v[188:191], v214, s[8:11], s38 offen offset:0
    buffer_load_dwordx4 v[192:195], v215, s[8:11], s39 offen offset:0
    v_exp_f32 v48, v48
    v_exp_f32 v49, v49
    v_exp_f32 v50, v50
    s_waitcnt lgkmcnt(3)
    v_mfma_f32_32x32x16_bf16 v[68:83], v[20:23], v[28:31], v[68:83]
    ds_read_b128 v[20:23], v86 offset:8960
    v_exp_f32 v51, v51
    v_cvt_pk_bf16_f32 v34, v48, v49
    v_cvt_pk_bf16_f32 v35, v50, v51
    s_waitcnt lgkmcnt(3)
    v_mfma_f32_32x32x16_bf16 v[36:51], v[12:15], v[4:7], 0
    ds_read_b128 v[12:15], v84 offset:20480
    v_exp_f32 v52, v52
    v_exp_f32 v53, v53
    v_exp_f32 v54, v54
    v_exp_f32 v55, v55
    s_waitcnt lgkmcnt(3)
    v_mfma_f32_32x32x16_bf16 v[68:83], v[24:27], v[32:35], v[68:83]
    ds_read_b128 v[24:27], v86 offset:9600
    v_cvt_pk_bf16_f32 v28, v52, v53
    v_cvt_pk_bf16_f32 v29, v54, v55
    v_exp_f32 v56, v56
    v_exp_f32 v57, v57
    s_waitcnt lgkmcnt(3)
    v_mfma_f32_32x32x8_bf16 v[36:51], v[16:17], v[8:9], v[36:51]
    v_exp_f32 v58, v58
    v_exp_f32 v59, v59
    v_cvt_pk_bf16_f32 v30, v56, v57
    v_cvt_pk_bf16_f32 v31, v58, v59
    s_waitcnt vmcnt(16)
    s_cmp_eq_u32 s41, 7
    s_cbranch_scc1 L_k2_kernel_skipx_14
    v_mfma_f32_32x32x16_bf16 v[100:115], v[196:199], v[200:203], v[100:115]
L_k2_kernel_skipx_14:
    v_exp_f32 v60, v60
    v_exp_f32 v61, v61
    v_exp_f32 v62, v62
    v_exp_f32 v63, v63
    s_cmp_eq_u32 s41, 7
    s_cbranch_scc1 L_k2_kernel_skipx_15
    v_mfma_f32_32x32x16_bf16 v[116:131], v[204:207], v[208:211], v[116:131]
L_k2_kernel_skipx_15:
    buffer_load_dwordx4 v[196:199], v212, s[8:11], s38 offen offset:32
    buffer_load_dwordx4 v[200:203], v213, s[8:11], s39 offen offset:3072
    buffer_load_dwordx4 v[204:207], v214, s[8:11], s38 offen offset:32
    buffer_load_dwordx4 v[208:211], v215, s[8:11], s39 offen offset:3072
    v_cvt_pk_bf16_f32 v32, v60, v61
    v_cvt_pk_bf16_f32 v33, v62, v63
    v_exp_f32 v64, v64
    v_exp_f32 v65, v65
    s_waitcnt lgkmcnt(2)
    v_mfma_f32_32x32x16_bf16 v[68:83], v[20:23], v[28:31], v[68:83]
    ds_read_b128 v[20:23], v86 offset:19456
    v_exp_f32 v66, v66
    v_exp_f32 v67, v67
    v_cvt_pk_bf16_f32 v34, v64, v65
    v_cvt_pk_bf16_f32 v35, v66, v67
    v_add_u32 v84, 19456, v84
    v_add_u32 v85, 19456, v85
    v_add_u32 v86, 19456, v86
    s_sub_u32 s38, s38, 320
    s_sub_u32 s39, s39, 80
    s_add_u32 s41, s41, 1
    s_cmp_eq_u32 s41, 2
    s_cbranch_scc0 L_k2_kernel_nobar_16
    s_barrier
L_k2_kernel_nobar_16:
    s_cmp_lt_u32 s41, 8
    s_cbranch_scc1 L_k2_kernel_loop_13
    s_branch L_k2_kernel_join_6
L_k2_kernel_Pl_8:
    s_mov_b32 s41, 1
L_k2_kernel_loop_17:
    s_waitcnt lgkmcnt(2)
    v_mfma_f32_32x32x16_bf16 v[52:67], v[12:15], v[4:7], 0
    ds_read_b128 v[12:15], v84 offset:2048
    v_exp_f32 v36, v36
    v_exp_f32 v37, v37
    v_exp_f32 v38, v38
    v_exp_f32 v39, v39
    v_cvt_pk_bf16_f32 v28, v36, v37
    v_cvt_pk_bf16_f32 v29, v38, v39
    s_waitcnt lgkmcnt(2)
    v_mfma_f32_32x32x16_bf16 v[68:83], v[24:27], v[32:35], v[68:83]
    ds_read_b128 v[24:27], v86 offset:640
    v_exp_f32 v40, v40
    v_exp_f32 v41, v41
    v_exp_f32 v42, v42
    v_exp_f32 v43, v43
    v_cvt_pk_bf16_f32 v30, v40, v41
    v_cvt_pk_bf16_f32 v31, v42, v43
    v_mfma_f32_32x32x8_bf16 v[52:67], v[16:17], v[10:11], v[52:67]
    v_exp_f32 v44, v44
    v_exp_f32 v45, v45
    v_exp_f32 v46, v46
    v_exp_f32 v47, v47
    v_cvt_pk_bf16_f32 v32, v44, v45
    v_cvt_pk_bf16_f32 v33, v46, v47
    s_waitcnt lgkmcnt(2)
    v_mfma_f32_32x32x16_bf16 v[68:83], v[20:23], v[28:31], v[68:83]
    ds_read_b128 v[20:23], v86 offset:1280
    v_exp_f32 v48, v48
    v_exp_f32 v49, v49
    v_exp_f32 v50, v50
    v_exp_f32 v51, v51
    v_cvt_pk_bf16_f32 v34, v48, v49
    v_cvt_pk_bf16_f32 v35, v50, v51
    s_waitcnt lgkmcnt(2)
    v_mfma_f32_32x32x16_bf16 v[36:51], v[12:15], v[4:7], 0
    ds_read_b128 v[12:15], v84 offset:3072
    v_exp_f32 v52, v52
    v_exp_f32 v53, v53
    v_exp_f32 v54, v54
    v_exp_f32 v55, v55
    v_cvt_pk_bf16_f32 v28, v52, v53
    v_cvt_pk_bf16_f32 v29, v54, v55
    s_waitcnt lgkmcnt(2)
    v_mfma_f32_32x32x16_bf16 v[68:83], v[24:27], v[32:35], v[68:83]
    ds_read_b128 v[24:27], v86 offset:1920
    v_exp_f32 v56, v56
    v_exp_f32 v57, v57
    v_exp_f32 v58, v58
    v_exp_f32 v59, v59
    v_cvt_pk_bf16_f32 v30, v56, v57
    v_cvt_pk_bf16_f32 v31, v58, v59
    v_mfma_f32_32x32x8_bf16 v[36:51], v[18:19], v[8:9], v[36:51]
    v_exp_f32 v60, v60
    v_exp_f32 v61, v61
    v_exp_f32 v62, v62
    v_exp_f32 v63, v63
    v_cvt_pk_bf16_f32 v32, v60, v61
    v_cvt_pk_bf16_f32 v33, v62, v63
    s_waitcnt lgkmcnt(2)
    v_mfma_f32_32x32x16_bf16 v[68:83], v[20:23], v[28:31], v[68:83]
    ds_read_b128 v[20:23], v86 offset:2560
    v_exp_f32 v64, v64
    v_exp_f32 v65, v65
    v_exp_f32 v66, v66
    v_exp_f32 v67, v67
    v_cvt_pk_bf16_f32 v34, v64, v65
    v_cvt_pk_bf16_f32 v35, v66, v67
    s_waitcnt lgkmcnt(2)
    v_mfma_f32_32x32x16_bf16 v[52:67], v[12:15], v[4:7], 0
    ds_read_b128 v[12:15], v84 offset:4096
    v_exp_f32 v36, v36
    v_exp_f32 v37, v37
    v_exp_f32 v38, v38
    v_exp_f32 v39, v39
    v_cvt_pk_bf16_f32 v28, v36, v37
    v_cvt_pk_bf16_f32 v29, v38, v39
    s_waitcnt lgkmcnt(2)
    v_mfma_f32_32x32x16_bf16 v[68:83], v[24:27], v[32:35], v[68:83]
    ds_read_b128 v[24:27], v86 offset:3200
    v_exp_f32 v40, v40
    v_exp_f32 v41, v41
    v_exp_f32 v42, v42
    v_exp_f32 v43, v43
    v_cvt_pk_bf16_f32 v30, v40, v41
    v_cvt_pk_bf16_f32 v31, v42, v43
    v_mfma_f32_32x32x8_bf16 v[52:67], v[18:19], v[10:11], v[52:67]
    ds_read_b128 v[16:19], v85 offset:512
    v_exp_f32 v44, v44
    v_exp_f32 v45, v45
    v_exp_f32 v46, v46
    v_exp_f32 v47, v47
    v_cvt_pk_bf16_f32 v32, v44, v45
    v_cvt_pk_bf16_f32 v33, v46, v47
    s_waitcnt lgkmcnt(3)
    v_mfma_f32_32x32x16_bf16 v[68:83], v[20:23], v[28:31], v[68:83]
    ds_read_b128 v[20:23], v86 offset:3840
    v_exp_f32 v48, v48
    v_exp_f32 v49, v49
    v_exp_f32 v50, v50
    v_exp_f32 v51, v51
    v_cvt_pk_bf16_f32 v34, v48, v49
    v_cvt_pk_bf16_f32 v35, v50, v51
    s_waitcnt lgkmcnt(3)
    v_mfma_f32_32x32x16_bf16 v[36:51], v[12:15], v[4:7], 0
    ds_read_b128 v[12:15], v84 offset:5120
    v_exp_f32 v52, v52
    v_exp_f32 v53, v53
    v_exp_f32 v54, v54
    v_exp_f32 v55, v55
    v_cvt_pk_bf16_f32 v28, v52, v53
    v_cvt_pk_bf16_f32 v29, v54, v55
    s_waitcnt lgkmcnt(3)
    v_mfma_f32_32x32x16_bf16 v[68:83], v[24:27], v[32:35], v[68:83]
    ds_read_b128 v[24:27], v86 offset:4480
    v_exp_f32 v56, v56
    v_exp_f32 v57, v57
    v_exp_f32 v58, v58
    v_exp_f32 v59, v59
    v_cvt_pk_bf16_f32 v30, v56, v57
    v_cvt_pk_bf16_f32 v31, v58, v59
    s_waitcnt lgkmcnt(3)
    v_mfma_f32_32x32x8_bf16 v[36:51], v[16:17], v[8:9], v[36:51]
    v_exp_f32 v60, v60
    v_exp_f32 v61, v61
    v_exp_f32 v62, v62
    v_exp_f32 v63, v63
    v_cvt_pk_bf16_f32 v32, v60, v61
    v_cvt_pk_bf16_f32 v33, v62, v63
    s_waitcnt lgkmcnt(2)
    v_mfma_f32_32x32x16_bf16 v[68:83], v[20:23], v[28:31], v[68:83]
    ds_read_b128 v[20:23], v86 offset:5120
    v_exp_f32 v64, v64
    v_exp_f32 v65, v65
    v_exp_f32 v66, v66
    v_exp_f32 v67, v67
    v_cvt_pk_bf16_f32 v34, v64, v65
    v_cvt_pk_bf16_f32 v35, v66, v67
    s_waitcnt lgkmcnt(2)
    v_mfma_f32_32x32x16_bf16 v[52:67], v[12:15], v[4:7], 0
    ds_read_b128 v[12:15], v84 offset:6144
    v_exp_f32 v36, v36
    v_exp_f32 v37, v37
    v_exp_f32 v38, v38
    v_exp_f32 v39, v39
    v_cvt_pk_bf16_f32 v28, v36, v37
    v_cvt_pk_bf16_f32 v29, v38, v39
    s_waitcnt lgkmcnt(2)
    v_mfma_f32_32x32x16_bf16 v[68:83], v[24:27], v[32:35], v[68:83]
    ds_read_b128 v[24:27], v86 offset:5760
    v_exp_f32 v40, v40
    v_exp_f32 v41, v41
    v_exp_f32 v42, v42
    v_exp_f32 v43, v43
    v_cvt_pk_bf16_f32 v30, v40, v41
    v_cvt_pk_bf16_f32 v31, v42, v43
    v_mfma_f32_32x32x8_bf16 v[52:67], v[16:17], v[10:11], v[52:67]
    v_exp_f32 v44, v44
    v_exp_f32 v45, v45
    v_exp_f32 v46, v46
    v_exp_f32 v47, v47
    v_cvt_pk_bf16_f32 v32, v44, v45
    v_cvt_pk_bf16_f32 v33, v46, v47
    s_waitcnt lgkmcnt(2)
    v_mfma_f32_32x32x16_bf16 v[68:83], v[20:23], v[28:31], v[68:83]
    ds_read_b128 v[20:23], v86 offset:6400
    v_exp_f32 v48, v48
    v_exp_f32 v49, v49
    v_exp_f32 v50, v50
    v_exp_f32 v51, v51
    v_cvt_pk_bf16_f32 v34, v48, v49
    v_cvt_pk_bf16_f32 v35, v50, v51
    s_waitcnt lgkmcnt(2)
    v_mfma_f32_32x32x16_bf16 v[36:51], v[12:15], v[4:7], 0
    ds_read_b128 v[12:15], v84 offset:7168
    v_exp_f32 v52, v52
    v_exp_f32 v53, v53
    v_exp_f32 v54, v54
    v_exp_f32 v55, v55
    v_cvt_pk_bf16_f32 v28, v52, v53
    v_cvt_pk_bf16_f32 v29, v54, v55
    s_waitcnt lgkmcnt(2)
    v_mfma_f32_32x32x16_bf16 v[68:83], v[24:27], v[32:35], v[68:83]
    ds_read_b128 v[24:27], v86 offset:7040
    v_exp_f32 v56, v56
    v_exp_f32 v57, v57
    v_exp_f32 v58, v58
    v_exp_f32 v59, v59
    v_cvt_pk_bf16_f32 v30, v56, v57
    v_cvt_pk_bf16_f32 v31, v58, v59
    v_mfma_f32_32x32x8_bf16 v[36:51], v[18:19], v[8:9], v[36:51]
    v_exp_f32 v60, v60
    v_exp_f32 v61, v61
    v_exp_f32 v62, v62
    v_exp_f32 v63, v63
    v_cvt_pk_bf16_f32 v32, v60, v61
    v_cvt_pk_bf16_f32 v33, v62, v63
    s_waitcnt lgkmcnt(2)
    v_mfma_f32_32x32x16_bf16 v[68:83], v[20:23], v[28:31], v[68:83]
    ds_read_b128 v[20:23], v86 offset:7680
    v_exp_f32 v64, v64
    v_exp_f32 v65, v65
    v_exp_f32 v66, v66
    v_exp_f32 v67, v67
    v_cvt_pk_bf16_f32 v34, v64, v65
    v_cvt_pk_bf16_f32 v35, v66, v67
    s_waitcnt lgkmcnt(2)
    v_mfma_f32_32x32x16_bf16 v[52:67], v[12:15], v[4:7], 0
    ds_read_b128 v[12:15], v84 offset:19456
    v_exp_f32 v36, v36
    v_exp_f32 v37, v37
    v_exp_f32 v38, v38
    v_exp_f32 v39, v39
    v_cvt_pk_bf16_f32 v28, v36, v37
    v_cvt_pk_bf16_f32 v29, v38, v39
    s_waitcnt lgkmcnt(2)
    v_mfma_f32_32x32x16_bf16 v[68:83], v[24:27], v[32:35], v[68:83]
    ds_read_b128 v[24:27], v86 offset:8320
    v_exp_f32 v40, v40
    v_exp_f32 v41, v41
    v_exp_f32 v42, v42
    v_exp_f32 v43, v43
    v_cvt_pk_bf16_f32 v30, v40, v41
    v_cvt_pk_bf16_f32 v31, v42, v43
    v_mfma_f32_32x32x8_bf16 v[52:67], v[18:19], v[10:11], v[52:67]
    ds_read_b128 v[16:19], v85 offset:19456
    v_exp_f32 v44, v44
    v_exp_f32 v45, v45
    v_exp_f32 v46, v46
    v_exp_f32 v47, v47
    v_cvt_pk_bf16_f32 v32, v44, v45
    v_cvt_pk_bf16_f32 v33, v46, v47
    s_waitcnt lgkmcnt(3)
    v_mfma_f32_32x32x16_bf16 v[68:83], v[20:23], v[28:31], v[68:83]
    ds_read_b128 v[20:23], v86 offset:8960
    v_exp_f32 v48, v48
    v_exp_f32 v49, v49
    v_exp_f32 v50, v50
    v_exp_f32 v51, v51
    v_cvt_pk_bf16_f32 v34, v48, v49
    v_cvt_pk_bf16_f32 v35, v50, v51
    s_waitcnt lgkmcnt(3)
    v_mfma_f32_32x32x16_bf16 v[36:51], v[12:15], v[4:7], 0
    ds_read_b128 v[12:15], v84 offset:20480
    v_exp_f32 v52, v52
    v_exp_f32 v53, v53
    v_exp_f32 v54, v54
    v_exp_f32 v55, v55
    v_cvt_pk_bf16_f32 v28, v52, v53
    v_cvt_pk_bf16_f32 v29, v54, v55
    s_waitcnt lgkmcnt(3)
    v_mfma_f32_32x32x16_bf16 v[68:83], v[24:27], v[32:35], v[68:83]
    ds_read_b128 v[24:27], v86 offset:9600
    v_exp_f32 v56, v56
    v_exp_f32 v57, v57
    v_exp_f32 v58, v58
    v_exp_f32 v59, v59
    v_cvt_pk_bf16_f32 v30, v56, v57
    v_cvt_pk_bf16_f32 v31, v58, v59
    s_waitcnt lgkmcnt(3)
    v_mfma_f32_32x32x8_bf16 v[36:51], v[16:17], v[8:9], v[36:51]
    v_exp_f32 v60, v60
    v_exp_f32 v61, v61
    v_exp_f32 v62, v62
    v_exp_f32 v63, v63
    v_cvt_pk_bf16_f32 v32, v60, v61
    v_cvt_pk_bf16_f32 v33, v62, v63
    s_waitcnt lgkmcnt(2)
    v_mfma_f32_32x32x16_bf16 v[68:83], v[20:23], v[28:31], v[68:83]
    ds_read_b128 v[20:23], v86 offset:19456
    v_exp_f32 v64, v64
    v_exp_f32 v65, v65
    v_exp_f32 v66, v66
    v_exp_f32 v67, v67
    v_cvt_pk_bf16_f32 v34, v64, v65
    v_cvt_pk_bf16_f32 v35, v66, v67
    v_add_u32 v84, 19456, v84
    v_add_u32 v85, 19456, v85
    v_add_u32 v86, 19456, v86
    s_add_u32 s41, s41, 1
    s_cmp_eq_u32 s41, 2
    s_cbranch_scc0 L_k2_kernel_nobar_18
    s_waitcnt vmcnt(0)
    s_barrier
L_k2_kernel_nobar_18:
    s_cmp_lt_u32 s41, 8
    s_cbranch_scc1 L_k2_kernel_loop_17
    s_branch L_k2_kernel_join_6
L_k2_kernel_dma_5:
    s_waitcnt lgkmcnt(2)
    v_mfma_f32_32x32x16_bf16 v[52:67], v[12:15], v[4:7], 0
    ds_read_b128 v[12:15], v84 offset:2048
    v_exp_f32 v36, v36
    v_exp_f32 v37, v37
    v_exp_f32 v38, v38
    v_exp_f32 v39, v39
    v_cvt_pk_bf16_f32 v28, v36, v37
    v_cvt_pk_bf16_f32 v29, v38, v39
    s_waitcnt lgkmcnt(2)
    v_mfma_f32_32x32x16_bf16 v[68:83], v[24:27], v[32:35], v[68:83]
    ds_read_b128 v[24:27], v86 offset:640
    v_exp_f32 v40, v40
    v_exp_f32 v41, v41
    v_exp_f32 v42, v42
    v_exp_f32 v43, v43
    v_cvt_pk_bf16_f32 v30, v40, v41
    v_cvt_pk_bf16_f32 v31, v42, v43
    v_mfma_f32_32x32x8_bf16 v[52:67], v[16:17], v[10:11], v[52:67]
    v_exp_f32 v44, v44
    v_exp_f32 v45, v45
    v_exp_f32 v46, v46
    v_exp_f32 v47, v47
    v_cvt_pk_bf16_f32 v32, v44, v45
    v_cvt_pk_bf16_f32 v33, v46, v47
    s_waitcnt lgkmcnt(2)
    v_mfma_f32_32x32x16_bf16 v[68:83], v[20:23], v[28:31], v[68:83]
    ds_read_b128 v[20:23], v86 offset:1280
    v_exp_f32 v48, v48
    v_exp_f32 v49, v49
    v_exp_f32 v50, v50
    v_exp_f32 v51, v51
    v_cvt_pk_bf16_f32 v34, v48, v49
    v_cvt_pk_bf16_f32 v35, v50, v51
    s_waitcnt lgkmcnt(2)
    v_mfma_f32_32x32x16_bf16 v[36:51], v[12:15], v[4:7], 0
    ds_read_b128 v[12:15], v84 offset:3072
    v_exp_f32 v52, v52
    v_exp_f32 v53, v53
    v_exp_f32 v54, v54
    v_exp_f32 v55, v55
    v_cvt_pk_bf16_f32 v28, v52, v53
    v_cvt_pk_bf16_f32 v29, v54, v55
    s_waitcnt lgkmcnt(2)
    v_mfma_f32_32x32x16_bf16 v[68:83], v[24:27], v[32:35], v[68:83]
    ds_read_b128 v[24:27], v86 offset:1920
    v_exp_f32 v56, v56
    v_exp_f32 v57, v57
    v_exp_f32 v58, v58
    v_exp_f32 v59, v59
    v_cvt_pk_bf16_f32 v30, v56, v57
    v_cvt_pk_bf16_f32 v31, v58, v59
    v_mfma_f32_32x32x8_bf16 v[36:51], v[18:19], v[8:9], v[36:51]
    v_exp_f32 v60, v60
    v_exp_f32 v61, v61
    v_exp_f32 v62, v62
    v_exp_f32 v63, v63
    v_cvt_pk_bf16_f32 v32, v60, v61
    v_cvt_pk_bf16_f32 v33, v62, v63
    s_waitcnt lgkmcnt(2)
    v_mfma_f32_32x32x16_bf16 v[68:83], v[20:23], v[28:31], v[68:83]
    ds_read_b128 v[20:23], v86 offset:2560
    v_exp_f32 v64, v64
    v_exp_f32 v65, v65
    v_exp_f32 v66, v66
    v_exp_f32 v67, v67
    v_cvt_pk_bf16_f32 v34, v64, v65
    v_cvt_pk_bf16_f32 v35, v66, v67
    s_waitcnt vmcnt(0)
    s_barrier
    s_waitcnt lgkmcnt(2)
    v_mfma_f32_32x32x16_bf16 v[52:67], v[12:15], v[4:7], 0
    ds_read_b128 v[12:15], v84 offset:4096
    v_exp_f32 v36, v36
    v_exp_f32 v37, v37
    v_exp_f32 v38, v38
    v_exp_f32 v39, v39
    v_cvt_pk_bf16_f32 v28, v36, v37
    v_cvt_pk_bf16_f32 v29, v38, v39
    s_waitcnt lgkmcnt(2)
    v_mfma_f32_32x32x16_bf16 v[68:83], v[24:27], v[32:35], v[68:83]
    ds_read_b128 v[24:27], v86 offset:3200
    v_exp_f32 v40, v40
    v_exp_f32 v41, v41
    v_exp_f32 v42, v42
    v_exp_f32 v43, v43
    v_cvt_pk_bf16_f32 v30, v40, v41
    v_cvt_pk_bf16_f32 v31, v42, v43
    v_mfma_f32_32x32x8_bf16 v[52:67], v[18:19], v[10:11], v[52:67]
    ds_read_b128 v[16:19], v85 offset:512
    v_exp_f32 v44, v44
    v_exp_f32 v45, v45
    v_exp_f32 v46, v46
    v_exp_f32 v47, v47
    v_cvt_pk_bf16_f32 v32, v44, v45
    v_cvt_pk_bf16_f32 v33, v46, v47
    s_waitcnt lgkmcnt(3)
    v_mfma_f32_32x32x16_bf16 v[68:83], v[20:23], v[28:31], v[68:83]
    ds_read_b128 v[20:23], v86 offset:3840
    v_exp_f32 v48, v48
    v_exp_f32 v49, v49
    v_exp_f32 v50, v50
    v_exp_f32 v51, v51
    v_cvt_pk_bf16_f32 v34, v48, v49
    v_cvt_pk_bf16_f32 v35, v50, v51
    s_waitcnt lgkmcnt(3)
    v_mfma_f32_32x32x16_bf16 v[36:51], v[12:15], v[4:7], 0
    ds_read_b128 v[12:15], v84 offset:5120
    v_exp_f32 v52, v52
    v_exp_f32 v53, v53
    v_exp_f32 v54, v54
    v_exp_f32 v55, v55
    v_cvt_pk_bf16_f32 v28, v52, v53
    v_cvt_pk_bf16_f32 v29, v54, v55
    s_waitcnt lgkmcnt(3)
    v_mfma_f32_32x32x16_bf16 v[68:83], v[24:27], v[32:35], v[68:83]
    ds_read_b128 v[24:27], v86 offset:4480
    v_exp_f32 v56, v56
    v_exp_f32 v57, v57
    v_exp_f32 v58, v58
    v_exp_f32 v59, v59
    v_cvt_pk_bf16_f32 v30, v56, v57
    v_cvt_pk_bf16_f32 v31, v58, v59
    s_waitcnt lgkmcnt(3)
    v_mfma_f32_32x32x8_bf16 v[36:51], v[16:17], v[8:9], v[36:51]
    v_exp_f32 v60, v60
    v_exp_f32 v61, v61
    v_exp_f32 v62, v62
    v_exp_f32 v63, v63
    v_cvt_pk_bf16_f32 v32, v60, v61
    v_cvt_pk_bf16_f32 v33, v62, v63
    s_waitcnt lgkmcnt(2)
    v_mfma_f32_32x32x16_bf16 v[68:83], v[20:23], v[28:31], v[68:83]
    ds_read_b128 v[20:23], v86 offset:5120
    v_exp_f32 v64, v64
    v_exp_f32 v65, v65
    v_exp_f32 v66, v66
    v_exp_f32 v67, v67
    v_cvt_pk_bf16_f32 v34, v64, v65
    v_cvt_pk_bf16_f32 v35, v66, v67
    s_waitcnt lgkmcnt(2)
    v_mfma_f32_32x32x16_bf16 v[52:67], v[12:15], v[4:7], 0
    ds_read_b128 v[12:15], v84 offset:6144
    v_exp_f32 v36, v36
    v_exp_f32 v37, v37
    v_exp_f32 v38, v38
    v_exp_f32 v39, v39
    v_cvt_pk_bf16_f32 v28, v36, v37
    v_cvt_pk_bf16_f32 v29, v38, v39
    s_waitcnt lgkmcnt(2)
    v_mfma_f32_32x32x16_bf16 v[68:83], v[24:27], v[32:35], v[68:83]
    ds_read_b128 v[24:27], v86 offset:5760
    v_exp_f32 v40, v40
    v_exp_f32 v41, v41
    v_exp_f32 v42, v42
    v_exp_f32 v43, v43
    v_cvt_pk_bf16_f32 v30, v40, v41
    v_cvt_pk_bf16_f32 v31, v42, v43
    v_mfma_f32_32x32x8_bf16 v[52:67], v[16:17], v[10:11], v[52:67]
    v_exp_f32 v44, v44
    v_exp_f32 v45, v45
    v_exp_f32 v46, v46
    v_exp_f32 v47, v47
    v_cvt_pk_bf16_f32 v32, v44, v45
    v_cvt_pk_bf16_f32 v33, v46, v47
    s_waitcnt lgkmcnt(2)
    v_mfma_f32_32x32x16_bf16 v[68:83], v[20:23], v[28:31], v[68:83]
    ds_read_b128 v[20:23], v86 offset:6400
    v_exp_f32 v48, v48
    v_exp_f32 v49, v49
    v_exp_f32 v50, v50
    v_exp_f32 v51, v51
    v_cvt_pk_bf16_f32 v34, v48, v49
    v_cvt_pk_bf16_f32 v35, v50, v51
    s_waitcnt lgkmcnt(2)
    v_mfma_f32_32x32x16_bf16 v[36:51], v[12:15], v[4:7], 0
    ds_read_b128 v[12:15], v84 offset:7168
    v_exp_f32 v52, v52
    v_exp_f32 v53, v53
    v_exp_f32 v54, v54
    v_exp_f32 v55, v55
    v_cvt_pk_bf16_f32 v28, v52, v53
    v_cvt_pk_bf16_f32 v29, v54, v55
    s_waitcnt lgkmcnt(2)
    v_mfma_f32_32x32x16_bf16 v[68:83], v[24:27], v[32:35], v[68:83]
    ds_read_b128 v[24:27], v86 offset:7040
    v_exp_f32 v56, v56
    v_exp_f32 v57, v57
    v_exp_f32 v58, v58
    v_exp_f32 v59, v59
    v_cvt_pk_bf16_f32 v30, v56, v57
    v_cvt_pk_bf16_f32 v31, v58, v59
    v_mfma_f32_32x32x8_bf16 v[36:51], v[18:19], v[8:9], v[36:51]
    v_exp_f32 v60, v60
    v_exp_f32 v61, v61
    v_exp_f32 v62, v62
    v_exp_f32 v63, v63
    v_cvt_pk_bf16_f32 v32, v60, v61
    v_cvt_pk_bf16_f32 v33, v62, v63
    s_waitcnt lgkmcnt(2)
    v_mfma_f32_32x32x16_bf16 v[68:83], v[20:23], v[28:31], v[68:83]
    ds_read_b128 v[20:23], v86 offset:7680
    v_exp_f32 v64, v64
    v_exp_f32 v65, v65
    v_exp_f32 v66, v66
    v_exp_f32 v67, v67
    v_cvt_pk_bf16_f32 v34, v64, v65
    v_cvt_pk_bf16_f32 v35, v66, v67
    s_waitcnt lgkmcnt(2)
    v_mfma_f32_32x32x16_bf16 v[52:67], v[12:15], v[4:7], 0
    ds_read_b128 v[12:15], v84 offset:19456
    v_exp_f32 v36, v36
    v_exp_f32 v37, v37
    v_exp_f32 v38, v38
    v_exp_f32 v39, v39
    v_cvt_pk_bf16_f32 v28, v36, v37
    v_cvt_pk_bf16_f32 v29, v38, v39
    s_waitcnt lgkmcnt(2)
    v_mfma_f32_32x32x16_bf16 v[68:83], v[24:27], v[32:35], v[68:83]
    ds_read_b128 v[24:27], v86 offset:8320
    v_exp_f32 v40, v40
    v_exp_f32 v41, v41
    v_exp_f32 v42, v42
    v_exp_f32 v43, v43
    v_cvt_pk_bf16_f32 v30, v40, v41
    v_cvt_pk_bf16_f32 v31, v42, v43
    v_mfma_f32_32x32x8_bf16 v[52:67], v[18:19], v[10:11], v[52:67]
    ds_read_b128 v[16:19], v85 offset:19456
    v_exp_f32 v44, v44
    v_exp_f32 v45, v45
    v_exp_f32 v46, v46
    v_exp_f32 v47, v47
    v_cvt_pk_bf16_f32 v32, v44, v45
    v_cvt_pk_bf16_f32 v33, v46, v47
    s_waitcnt lgkmcnt(3)
    v_mfma_f32_32x32x16_bf16 v[68:83], v[20:23], v[28:31], v[68:83]
    ds_read_b128 v[20:23], v86 offset:8960
    v_exp_f32 v48, v48
    v_exp_f32 v49, v49
    v_exp_f32 v50, v50
    v_exp_f32 v51, v51
    v_cvt_pk_bf16_f32 v34, v48, v49
    v_cvt_pk_bf16_f32 v35, v50, v51
    s_waitcnt lgkmcnt(3)
    v_mfma_f32_32x32x16_bf16 v[36:51], v[12:15], v[4:7], 0
    ds_read_b128 v[12:15], v84 offset:20480
    v_exp_f32 v52, v52
    v_exp_f32 v53, v53
    v_exp_f32 v54, v54
    v_exp_f32 v55, v55
    v_cvt_pk_bf16_f32 v28, v52, v53
    v_cvt_pk_bf16_f32 v29, v54, v55
    s_waitcnt lgkmcnt(3)
    v_mfma_f32_32x32x16_bf16 v[68:83], v[24:27], v[32:35], v[68:83]
    ds_read_b128 v[24:27], v86 offset:9600
    v_exp_f32 v56, v56
    v_exp_f32 v57, v57
    v_exp_f32 v58, v58
    v_exp_f32 v59, v59
    v_cvt_pk_bf16_f32 v30, v56, v57
    v_cvt_pk_bf16_f32 v31, v58, v59
    s_waitcnt lgkmcnt(3)
    v_mfma_f32_32x32x8_bf16 v[36:51], v[16:17], v[8:9], v[36:51]
    v_exp_f32 v60, v60
    v_exp_f32 v61, v61
    v_exp_f32 v62, v62
    v_exp_f32 v63, v63
    v_cvt_pk_bf16_f32 v32, v60, v61
    v_cvt_pk_bf16_f32 v33, v62, v63
    s_waitcnt lgkmcnt(2)
    v_mfma_f32_32x32x16_bf16 v[68:83], v[20:23], v[28:31], v[68:83]
    ds_read_b128 v[20:23], v86 offset:19456
    v_exp_f32 v64, v64
    v_exp_f32 v65, v65
    v_exp_f32 v66, v66
    v_exp_f32 v67, v67
    v_cvt_pk_bf16_f32 v34, v64, v65
    v_cvt_pk_bf16_f32 v35, v66, v67
    v_add_u32 v84, 19456, v84
    v_add_u32 v85, 19456, v85
    v_add_u32 v86, 19456, v86
    s_barrier
    s_waitcnt lgkmcnt(2)
    v_mfma_f32_32x32x16_bf16 v[52:67], v[12:15], v[4:7], 0
    ds_read_b128 v[12:15], v84 offset:2048
    v_exp_f32 v36, v36
    v_exp_f32 v37, v37
    v_exp_f32 v38, v38
    v_exp_f32 v39, v39
    v_cvt_pk_bf16_f32 v28, v36, v37
    v_cvt_pk_bf16_f32 v29, v38, v39
    s_waitcnt lgkmcnt(2)
    v_mfma_f32_32x32x16_bf16 v[68:83], v[24:27], v[32:35], v[68:83]
    ds_read_b128 v[24:27], v86 offset:640
    v_exp_f32 v40, v40
    v_exp_f32 v41, v41
    v_exp_f32 v42, v42
    v_exp_f32 v43, v43
    v_cvt_pk_bf16_f32 v30, v40, v41
    v_cvt_pk_bf16_f32 v31, v42, v43
    v_mfma_f32_32x32x8_bf16 v[52:67], v[16:17], v[10:11], v[52:67]
    v_exp_f32 v44, v44
    v_exp_f32 v45, v45
    v_exp_f32 v46, v46
    v_exp_f32 v47, v47
    v_cvt_pk_bf16_f32 v32, v44, v45
    v_cvt_pk_bf16_f32 v33, v46, v47
    s_waitcnt lgkmcnt(2)
    v_mfma_f32_32x32x16_bf16 v[68:83], v[20:23], v[28:31], v[68:83]
    ds_read_b128 v[20:23], v86 offset:1280
    v_exp_f32 v48, v48
    v_exp_f32 v49, v49
    v_exp_f32 v50, v50
    v_exp_f32 v51, v51
    v_cvt_pk_bf16_f32 v34, v48, v49
    v_cvt_pk_bf16_f32 v35, v50, v51
    s_waitcnt lgkmcnt(2)
    v_mfma_f32_32x32x16_bf16 v[36:51], v[12:15], v[4:7], 0
    ds_read_b128 v[12:15], v84 offset:3072
    v_exp_f32 v52, v52
    v_exp_f32 v53, v53
    v_exp_f32 v54, v54
    v_exp_f32 v55, v55
    v_cvt_pk_bf16_f32 v28, v52, v53
    v_cvt_pk_bf16_f32 v29, v54, v55
    s_waitcnt lgkmcnt(2)
    v_mfma_f32_32x32x16_bf16 v[68:83], v[24:27], v[32:35], v[68:83]
    ds_read_b128 v[24:27], v86 offset:1920
    v_exp_f32 v56, v56
    v_exp_f32 v57, v57
    v_exp_f32 v58, v58
    v_exp_f32 v59, v59
    v_cvt_pk_bf16_f32 v30, v56, v57
    v_cvt_pk_bf16_f32 v31, v58, v59
    v_mfma_f32_32x32x8_bf16 v[36:51], v[18:19], v[8:9], v[36:51]
    v_exp_f32 v60, v60
    v_exp_f32 v61, v61
    v_exp_f32 v62, v62
    v_exp_f32 v63, v63
    v_cvt_pk_bf16_f32 v32, v60, v61
    v_cvt_pk_bf16_f32 v33, v62, v63
    s_waitcnt lgkmcnt(2)
    v_mfma_f32_32x32x16_bf16 v[68:83], v[20:23], v[28:31], v[68:83]
    ds_read_b128 v[20:23], v86 offset:2560
    v_exp_f32 v64, v64
    v_exp_f32 v65, v65
    v_exp_f32 v66, v66
    v_exp_f32 v67, v67
    v_cvt_pk_bf16_f32 v34, v64, v65
    v_cvt_pk_bf16_f32 v35, v66, v67
    s_waitcnt lgkmcnt(2)
    v_mfma_f32_32x32x16_bf16 v[52:67], v[12:15], v[4:7], 0
    ds_read_b128 v[12:15], v84 offset:4096
    v_exp_f32 v36, v36
    v_exp_f32 v37, v37
    v_exp_f32 v38, v38
    v_exp_f32 v39, v39
    v_cvt_pk_bf16_f32 v28, v36, v37
    v_cvt_pk_bf16_f32 v29, v38, v39
    s_waitcnt lgkmcnt(2)
    v_mfma_f32_32x32x16_bf16 v[68:83], v[24:27], v[32:35], v[68:83]
    ds_read_b128 v[24:27], v86 offset:3200
    v_exp_f32 v40, v40
    v_exp_f32 v41, v41
    v_exp_f32 v42, v42
    v_exp_f32 v43, v43
    v_cvt_pk_bf16_f32 v30, v40, v41
    v_cvt_pk_bf16_f32 v31, v42, v43
    v_mfma_f32_32x32x8_bf16 v[52:67], v[18:19], v[10:11], v[52:67]
    ds_read_b128 v[16:19], v85 offset:512
    v_exp_f32 v44, v44
    v_exp_f32 v45, v45
    v_exp_f32 v46, v46
    v_exp_f32 v47, v47
    v_cvt_pk_bf16_f32 v32, v44, v45
    v_cvt_pk_bf16_f32 v33, v46, v47
    s_waitcnt lgkmcnt(3)
    v_mfma_f32_32x32x16_bf16 v[68:83], v[20:23], v[28:31], v[68:83]
    ds_read_b128 v[20:23], v86 offset:3840
    v_exp_f32 v48, v48
    v_exp_f32 v49, v49
    v_exp_f32 v50, v50
    v_exp_f32 v51, v51
    v_cvt_pk_bf16_f32 v34, v48, v49
    v_cvt_pk_bf16_f32 v35, v50, v51
    s_waitcnt lgkmcnt(3)
    v_mfma_f32_32x32x16_bf16 v[36:51], v[12:15], v[4:7], 0
    ds_read_b128 v[12:15], v84 offset:5120
    v_exp_f32 v52, v52
    v_exp_f32 v53, v53
    v_exp_f32 v54, v54
    v_exp_f32 v55, v55
    v_cvt_pk_bf16_f32 v28, v52, v53
    v_cvt_pk_bf16_f32 v29, v54, v55
    s_waitcnt lgkmcnt(3)
    v_mfma_f32_32x32x16_bf16 v[68:83], v[24:27], v[32:35], v[68:83]
    ds_read_b128 v[24:27], v86 offset:4480
    v_exp_f32 v56, v56
    v_exp_f32 v57, v57
    v_exp_f32 v58, v58
    v_exp_f32 v59, v59
    v_cvt_pk_bf16_f32 v30, v56, v57
    v_cvt_pk_bf16_f32 v31, v58, v59
    s_waitcnt lgkmcnt(3)
    v_mfma_f32_32x32x8_bf16 v[36:51], v[16:17], v[8:9], v[36:51]
    v_exp_f32 v60, v60
    v_exp_f32 v61, v61
    v_exp_f32 v62, v62
    v_exp_f32 v63, v63
    v_cvt_pk_bf16_f32 v32, v60, v61
    v_cvt_pk_bf16_f32 v33, v62, v63
    s_waitcnt lgkmcnt(2)
    v_mfma_f32_32x32x16_bf16 v[68:83], v[20:23], v[28:31], v[68:83]
    ds_read_b128 v[20:23], v86 offset:5120
    v_exp_f32 v64, v64
    v_exp_f32 v65, v65
    v_exp_f32 v66, v66
    v_exp_f32 v67, v67
    v_cvt_pk_bf16_f32 v34, v64, v65
    v_cvt_pk_bf16_f32 v35, v66, v67
    s_waitcnt lgkmcnt(2)
    v_mfma_f32_32x32x16_bf16 v[52:67], v[12:15], v[4:7], 0
    ds_read_b128 v[12:15], v84 offset:6144
    v_exp_f32 v36, v36
    v_exp_f32 v37, v37
    v_exp_f32 v38, v38
    v_exp_f32 v39, v39
    v_cvt_pk_bf16_f32 v28, v36, v37
    v_cvt_pk_bf16_f32 v29, v38, v39
    s_waitcnt lgkmcnt(2)
    v_mfma_f32_32x32x16_bf16 v[68:83], v[24:27], v[32:35], v[68:83]
    ds_read_b128 v[24:27], v86 offset:5760
    v_exp_f32 v40, v40
    v_exp_f32 v41, v41
    v_exp_f32 v42, v42
    v_exp_f32 v43, v43
    v_cvt_pk_bf16_f32 v30, v40, v41
    v_cvt_pk_bf16_f32 v31, v42, v43
    v_mfma_f32_32x32x8_bf16 v[52:67], v[16:17], v[10:11], v[52:67]
    v_exp_f32 v44, v44
    v_exp_f32 v45, v45
    v_exp_f32 v46, v46
    v_exp_f32 v47, v47
    v_cvt_pk_bf16_f32 v32, v44, v45
    v_cvt_pk_bf16_f32 v33, v46, v47
    s_waitcnt lgkmcnt(2)
    v_mfma_f32_32x32x16_bf16 v[68:83], v[20:23], v[28:31], v[68:83]
    ds_read_b128 v[20:23], v86 offset:6400
    v_exp_f32 v48, v48
    v_exp_f32 v49, v49
    v_exp_f32 v50, v50
    v_exp_f32 v51, v51
    v_cvt_pk_bf16_f32 v34, v48, v49
    v_cvt_pk_bf16_f32 v35, v50, v51
    s_waitcnt lgkmcnt(2)
    v_mfma_f32_32x32x16_bf16 v[36:51], v[12:15], v[4:7], 0
    ds_read_b128 v[12:15], v84 offset:7168
    v_exp_f32 v52, v52
    v_exp_f32 v53, v53
    v_exp_f32 v54, v54
    v_exp_f32 v55, v55
    v_cvt_pk_bf16_f32 v28, v52, v53
    v_cvt_pk_bf16_f32 v29, v54, v55
    s_waitcnt lgkmcnt(2)
    v_mfma_f32_32x32x16_bf16 v[68:83], v[24:27], v[32:35], v[68:83]
    ds_read_b128 v[24:27], v86 offset:7040
    v_exp_f32 v56, v56
    v_exp_f32 v57, v57
    v_exp_f32 v58, v58
    v_exp_f32 v59, v59
    v_cvt_pk_bf16_f32 v30, v56, v57
    v_cvt_pk_bf16_f32 v31, v58, v59
    v_mfma_f32_32x32x8_bf16 v[36:51], v[18:19], v[8:9], v[36:51]
    v_exp_f32 v60, v60
    v_exp_f32 v61, v61
    v_exp_f32 v62, v62
    v_exp_f32 v63, v63
    v_cvt_pk_bf16_f32 v32, v60, v61
    v_cvt_pk_bf16_f32 v33, v62, v63
    s_waitcnt lgkmcnt(2)
    v_mfma_f32_32x32x16_bf16 v[68:83], v[20:23], v[28:31], v[68:83]
    ds_read_b128 v[20:23], v86 offset:7680
    v_exp_f32 v64, v64
    v_exp_f32 v65, v65
    v_exp_f32 v66, v66
    v_exp_f32 v67, v67
    v_cvt_pk_bf16_f32 v34, v64, v65
    v_cvt_pk_bf16_f32 v35, v66, v67
    s_waitcnt lgkmcnt(2)
    v_mfma_f32_32x32x16_bf16 v[52:67], v[12:15], v[4:7], 0
    ds_read_b128 v[12:15], v84 offset:19456
    v_exp_f32 v36, v36
    v_exp_f32 v37, v37
    v_exp_f32 v38, v38
    v_exp_f32 v39, v39
    v_cvt_pk_bf16_f32 v28, v36, v37
    v_cvt_pk_bf16_f32 v29, v38, v39
    s_waitcnt lgkmcnt(2)
    v_mfma_f32_32x32x16_bf16 v[68:83], v[24:27], v[32:35], v[68:83]
    ds_read_b128 v[24:27], v86 offset:8320
    v_exp_f32 v40, v40
    v_exp_f32 v41, v41
    v_exp_f32 v42, v42
    v_exp_f32 v43, v43
    v_cvt_pk_bf16_f32 v30, v40, v41
    v_cvt_pk_bf16_f32 v31, v42, v43
    v_mfma_f32_32x32x8_bf16 v[52:67], v[18:19], v[10:11], v[52:67]
    ds_read_b128 v[16:19], v85 offset:19456
    v_exp_f32 v44, v44
    v_exp_f32 v45, v45
    v_exp_f32 v46, v46
    v_exp_f32 v47, v47
    v_cvt_pk_bf16_f32 v32, v44, v45
    v_cvt_pk_bf16_f32 v33, v46, v47
    s_waitcnt lgkmcnt(3)
    v_mfma_f32_32x32x16_bf16 v[68:83], v[20:23], v[28:31], v[68:83]
    ds_read_b128 v[20:23], v86 offset:8960
    v_exp_f32 v48, v48
    v_exp_f32 v49, v49
    v_exp_f32 v50, v50
    v_exp_f32 v51, v51
    v_cvt_pk_bf16_f32 v34, v48, v49
    v_cvt_pk_bf16_f32 v35, v50, v51
    s_waitcnt lgkmcnt(3)
    v_mfma_f32_32x32x16_bf16 v[36:51], v[12:15], v[4:7], 0
    ds_read_b128 v[12:15], v84 offset:20480
    v_exp_f32 v52, v52
    v_exp_f32 v53, v53
    v_exp_f32 v54, v54
    v_exp_f32 v55, v55
    v_cvt_pk_bf16_f32 v28, v52, v53
    v_cvt_pk_bf16_f32 v29, v54, v55
    s_waitcnt lgkmcnt(3)
    v_mfma_f32_32x32x16_bf16 v[68:83], v[24:27], v[32:35], v[68:83]
    ds_read_b128 v[24:27], v86 offset:9600
    v_exp_f32 v56, v56
    v_exp_f32 v57, v57
    v_exp_f32 v58, v58
    v_exp_f32 v59, v59
    v_cvt_pk_bf16_f32 v30, v56, v57
    v_cvt_pk_bf16_f32 v31, v58, v59
    s_waitcnt lgkmcnt(3)
    v_mfma_f32_32x32x8_bf16 v[36:51], v[16:17], v[8:9], v[36:51]
    v_exp_f32 v60, v60
    v_exp_f32 v61, v61
    v_exp_f32 v62, v62
    v_exp_f32 v63, v63
    v_cvt_pk_bf16_f32 v32, v60, v61
    v_cvt_pk_bf16_f32 v33, v62, v63
    s_waitcnt lgkmcnt(2)
    v_mfma_f32_32x32x16_bf16 v[68:83], v[20:23], v[28:31], v[68:83]
    ds_read_b128 v[20:23], v86 offset:19456
    v_exp_f32 v64, v64
    v_exp_f32 v65, v65
    v_exp_f32 v66, v66
    v_exp_f32 v67, v67
    v_cvt_pk_bf16_f32 v34, v64, v65
    v_cvt_pk_bf16_f32 v35, v66, v67
    v_add_u32 v84, 19456, v84
    v_add_u32 v85, 19456, v85
    v_add_u32 v86, 19456, v86
    s_barrier
    s_load_dwordx2 s[6:7], s[0:1], 72
    s_lshr_b32 s30, s2, 3
    s_lshl_b32 s30, s30, 2
    s_add_u32 s30, s30, s19
    s_sub_u32 s30, s30, 4
    s_mul_i32 s30, s30, 5248
    v_lshlrev_b32 v96, 7, v2
    v_cmp_gt_u32 vcc, 41, v2
    s_and_saveexec_b64 s[44:45], vcc
    s_waitcnt lgkmcnt(0)
    s_mov_b32 s12, s6
    s_and_b32 s13, s7, 0xffff
    s_mov_b32 s14, 663552
    s_mov_b32 s15, 0x00020000
    buffer_load_dword v218, v96, s[12:15], s30 offen
    s_mov_b64 exec, -1
    s_mov_b32 s41, 2
L_k2_kernel_loop_19:
    s_waitcnt lgkmcnt(2)
    v_mfma_f32_32x32x16_bf16 v[52:67], v[12:15], v[4:7], 0
    ds_read_b128 v[12:15], v84 offset:2048
    v_exp_f32 v36, v36
    v_exp_f32 v37, v37
    v_exp_f32 v38, v38
    v_exp_f32 v39, v39
    v_cvt_pk_bf16_f32 v28, v36, v37
    v_cvt_pk_bf16_f32 v29, v38, v39
    s_waitcnt lgkmcnt(2)
    v_mfma_f32_32x32x16_bf16 v[68:83], v[24:27], v[32:35], v[68:83]
    ds_read_b128 v[24:27], v86 offset:640
    v_exp_f32 v40, v40
    v_exp_f32 v41, v41
    v_exp_f32 v42, v42
    v_exp_f32 v43, v43
    v_cvt_pk_bf16_f32 v30, v40, v41
    v_cvt_pk_bf16_f32 v31, v42, v43
    v_mfma_f32_32x32x8_bf16 v[52:67], v[16:17], v[10:11], v[52:67]
    v_exp_f32 v44, v44
    v_exp_f32 v45, v45
    v_exp_f32 v46, v46
    v_exp_f32 v47, v47
    v_cvt_pk_bf16_f32 v32, v44, v45
    v_cvt_pk_bf16_f32 v33, v46, v47
    s_waitcnt lgkmcnt(2)
    v_mfma_f32_32x32x16_bf16 v[68:83], v[20:23], v[28:31], v[68:83]
    ds_read_b128 v[20:23], v86 offset:1280
    v_exp_f32 v48, v48
    v_exp_f32 v49, v49
    v_exp_f32 v50, v50
    v_exp_f32 v51, v51
    v_cvt_pk_bf16_f32 v34, v48, v49
    v_cvt_pk_bf16_f32 v35, v50, v51
    s_waitcnt lgkmcnt(2)
    v_mfma_f32_32x32x16_bf16 v[36:51], v[12:15], v[4:7], 0
    ds_read_b128 v[12:15], v84 offset:3072
    v_exp_f32 v52, v52
    v_exp_f32 v53, v53
    v_exp_f32 v54, v54
    v_exp_f32 v55, v55
    v_cvt_pk_bf16_f32 v28, v52, v53
    v_cvt_pk_bf16_f32 v29, v54, v55
    s_waitcnt lgkmcnt(2)
    v_mfma_f32_32x32x16_bf16 v[68:83], v[24:27], v[32:35], v[68:83]
    ds_read_b128 v[24:27], v86 offset:1920
    v_exp_f32 v56, v56
    v_exp_f32 v57, v57
    v_exp_f32 v58, v58
    v_exp_f32 v59, v59
    v_cvt_pk_bf16_f32 v30, v56, v57
    v_cvt_pk_bf16_f32 v31, v58, v59
    v_mfma_f32_32x32x8_bf16 v[36:51], v[18:19], v[8:9], v[36:51]
    v_exp_f32 v60, v60
    v_exp_f32 v61, v61
    v_exp_f32 v62, v62
    v_exp_f32 v63, v63
    v_cvt_pk_bf16_f32 v32, v60, v61
    v_cvt_pk_bf16_f32 v33, v62, v63
    s_waitcnt lgkmcnt(2)
    v_mfma_f32_32x32x16_bf16 v[68:83], v[20:23], v[28:31], v[68:83]
    ds_read_b128 v[20:23], v86 offset:2560
    v_exp_f32 v64, v64
    v_exp_f32 v65, v65
    v_exp_f32 v66, v66
    v_exp_f32 v67, v67
    v_cvt_pk_bf16_f32 v34, v64, v65
    v_cvt_pk_bf16_f32 v35, v66, v67
    s_waitcnt lgkmcnt(2)
    v_mfma_f32_32x32x16_bf16 v[52:67], v[12:15], v[4:7], 0
    ds_read_b128 v[12:15], v84 offset:4096
    v_exp_f32 v36, v36
    v_exp_f32 v37, v37
    v_exp_f32 v38, v38
    v_exp_f32 v39, v39
    v_cvt_pk_bf16_f32 v28, v36, v37
    v_cvt_pk_bf16_f32 v29, v38, v39
    s_waitcnt lgkmcnt(2)
    v_mfma_f32_32x32x16_bf16 v[68:83], v[24:27], v[32:35], v[68:83]
    ds_read_b128 v[24:27], v86 offset:3200
    v_exp_f32 v40, v40
    v_exp_f32 v41, v41
    v_exp_f32 v42, v42
    v_exp_f32 v43, v43
    v_cvt_pk_bf16_f32 v30, v40, v41
    v_cvt_pk_bf16_f32 v31, v42, v43
    v_mfma_f32_32x32x8_bf16 v[52:67], v[18:19], v[10:11], v[52:67]
    ds_read_b128 v[16:19], v85 offset:512
    v_exp_f32 v44, v44
    v_exp_f32 v45, v45
    v_exp_f32 v46, v46
    v_exp_f32 v47, v47
    v_cvt_pk_bf16_f32 v32, v44, v45
    v_cvt_pk_bf16_f32 v33, v46, v47
    s_waitcnt lgkmcnt(3)
    v_mfma_f32_32x32x16_bf16 v[68:83], v[20:23], v[28:31], v[68:83]
    ds_read_b128 v[20:23], v86 offset:3840
    v_exp_f32 v48, v48
    v_exp_f32 v49, v49
    v_exp_f32 v50, v50
    v_exp_f32 v51, v51
    v_cvt_pk_bf16_f32 v34, v48, v49
    v_cvt_pk_bf16_f32 v35, v50, v51
    s_waitcnt lgkmcnt(3)
    v_mfma_f32_32x32x16_bf16 v[36:51], v[12:15], v[4:7], 0
    ds_read_b128 v[12:15], v84 offset:5120
    v_exp_f32 v52, v52
    v_exp_f32 v53, v53
    v_exp_f32 v54, v54
    v_exp_f32 v55, v55
    v_cvt_pk_bf16_f32 v28, v52, v53
    v_cvt_pk_bf16_f32 v29, v54, v55
    s_waitcnt lgkmcnt(3)
    v_mfma_f32_32x32x16_bf16 v[68:83], v[24:27], v[32:35], v[68:83]
    ds_read_b128 v[24:27], v86 offset:4480
    v_exp_f32 v56, v56
    v_exp_f32 v57, v57
    v_exp_f32 v58, v58
    v_exp_f32 v59, v59
    v_cvt_pk_bf16_f32 v30, v56, v57
    v_cvt_pk_bf16_f32 v31, v58, v59
    s_waitcnt lgkmcnt(3)
    v_mfma_f32_32x32x8_bf16 v[36:51], v[16:17], v[8:9], v[36:51]
    v_exp_f32 v60, v60
    v_exp_f32 v61, v61
    v_exp_f32 v62, v62
    v_exp_f32 v63, v63
    v_cvt_pk_bf16_f32 v32, v60, v61
    v_cvt_pk_bf16_f32 v33, v62, v63
    s_waitcnt lgkmcnt(2)
    v_mfma_f32_32x32x16_bf16 v[68:83], v[20:23], v[28:31], v[68:83]
    ds_read_b128 v[20:23], v86 offset:5120
    v_exp_f32 v64, v64
    v_exp_f32 v65, v65
    v_exp_f32 v66, v66
    v_exp_f32 v67, v67
    v_cvt_pk_bf16_f32 v34, v64, v65
    v_cvt_pk_bf16_f32 v35, v66, v67
    s_waitcnt lgkmcnt(2)
    v_mfma_f32_32x32x16_bf16 v[52:67], v[12:15], v[4:7], 0
    ds_read_b128 v[12:15], v84 offset:6144
    v_exp_f32 v36, v36
    v_exp_f32 v37, v37
    v_exp_f32 v38, v38
    v_exp_f32 v39, v39
    v_cvt_pk_bf16_f32 v28, v36, v37
    v_cvt_pk_bf16_f32 v29, v38, v39
    s_waitcnt lgkmcnt(2)
    v_mfma_f32_32x32x16_bf16 v[68:83], v[24:27], v[32:35], v[68:83]
    ds_read_b128 v[24:27], v86 offset:5760
    v_exp_f32 v40, v40
    v_exp_f32 v41, v41
    v_exp_f32 v42, v42
    v_exp_f32 v43, v43
    v_cvt_pk_bf16_f32 v30, v40, v41
    v_cvt_pk_bf16_f32 v31, v42, v43
    v_mfma_f32_32x32x8_bf16 v[52:67], v[16:17], v[10:11], v[52:67]
    v_exp_f32 v44, v44
    v_exp_f32 v45, v45
    v_exp_f32 v46, v46
    v_exp_f32 v47, v47
    v_cvt_pk_bf16_f32 v32, v44, v45
    v_cvt_pk_bf16_f32 v33, v46, v47
    s_waitcnt lgkmcnt(2)
    v_mfma_f32_32x32x16_bf16 v[68:83], v[20:23], v[28:31], v[68:83]
    ds_read_b128 v[20:23], v86 offset:6400
    v_exp_f32 v48, v48
    v_exp_f32 v49, v49
    v_exp_f32 v50, v50
    v_exp_f32 v51, v51
    v_cvt_pk_bf16_f32 v34, v48, v49
    v_cvt_pk_bf16_f32 v35, v50, v51
    s_waitcnt lgkmcnt(2)
    v_mfma_f32_32x32x16_bf16 v[36:51], v[12:15], v[4:7], 0
    ds_read_b128 v[12:15], v84 offset:7168
    v_exp_f32 v52, v52
    v_exp_f32 v53, v53
    v_exp_f32 v54, v54
    v_exp_f32 v55, v55
    v_cvt_pk_bf16_f32 v28, v52, v53
    v_cvt_pk_bf16_f32 v29, v54, v55
    s_waitcnt lgkmcnt(2)
    v_mfma_f32_32x32x16_bf16 v[68:83], v[24:27], v[32:35], v[68:83]
    ds_read_b128 v[24:27], v86 offset:7040
    v_exp_f32 v56, v56
    v_exp_f32 v57, v57
    v_exp_f32 v58, v58
    v_exp_f32 v59, v59
    v_cvt_pk_bf16_f32 v30, v56, v57
    v_cvt_pk_bf16_f32 v31, v58, v59
    v_mfma_f32_32x32x8_bf16 v[36:51], v[18:19], v[8:9], v[36:51]
    v_exp_f32 v60, v60
    v_exp_f32 v61, v61
    v_exp_f32 v62, v62
    v_exp_f32 v63, v63
    v_cvt_pk_bf16_f32 v32, v60, v61
    v_cvt_pk_bf16_f32 v33, v62, v63
    s_waitcnt lgkmcnt(2)
    v_mfma_f32_32x32x16_bf16 v[68:83], v[20:23], v[28:31], v[68:83]
    ds_read_b128 v[20:23], v86 offset:7680
    v_exp_f32 v64, v64
    v_exp_f32 v65, v65
    v_exp_f32 v66, v66
    v_exp_f32 v67, v67
    v_cvt_pk_bf16_f32 v34, v64, v65
    v_cvt_pk_bf16_f32 v35, v66, v67
    s_waitcnt lgkmcnt(2)
    v_mfma_f32_32x32x16_bf16 v[52:67], v[12:15], v[4:7], 0
    ds_read_b128 v[12:15], v84 offset:19456
    v_exp_f32 v36, v36
    v_exp_f32 v37, v37
    v_exp_f32 v38, v38
    v_exp_f32 v39, v39
    v_cvt_pk_bf16_f32 v28, v36, v37
    v_cvt_pk_bf16_f32 v29, v38, v39
    s_waitcnt lgkmcnt(2)
    v_mfma_f32_32x32x16_bf16 v[68:83], v[24:27], v[32:35], v[68:83]
    ds_read_b128 v[24:27], v86 offset:8320
    v_exp_f32 v40, v40
    v_exp_f32 v41, v41
    v_exp_f32 v42, v42
    v_exp_f32 v43, v43
    v_cvt_pk_bf16_f32 v30, v40, v41
    v_cvt_pk_bf16_f32 v31, v42, v43
    v_mfma_f32_32x32x8_bf16 v[52:67], v[18:19], v[10:11], v[52:67]
    ds_read_b128 v[16:19], v85 offset:19456
    v_exp_f32 v44, v44
    v_exp_f32 v45, v45
    v_exp_f32 v46, v46
    v_exp_f32 v47, v47
    v_cvt_pk_bf16_f32 v32, v44, v45
    v_cvt_pk_bf16_f32 v33, v46, v47
    s_waitcnt lgkmcnt(3)
    v_mfma_f32_32x32x16_bf16 v[68:83], v[20:23], v[28:31], v[68:83]
    ds_read_b128 v[20:23], v86 offset:8960
    v_exp_f32 v48, v48
    v_exp_f32 v49, v49
    v_exp_f32 v50, v50
    v_exp_f32 v51, v51
    v_cvt_pk_bf16_f32 v34, v48, v49
    v_cvt_pk_bf16_f32 v35, v50, v51
    s_waitcnt lgkmcnt(3)
    v_mfma_f32_32x32x16_bf16 v[36:51], v[12:15], v[4:7], 0
    ds_read_b128 v[12:15], v84 offset:20480
    v_exp_f32 v52, v52
    v_exp_f32 v53, v53
    v_exp_f32 v54, v54
    v_exp_f32 v55, v55
    v_cvt_pk_bf16_f32 v28, v52, v53
    v_cvt_pk_bf16_f32 v29, v54, v55
    s_waitcnt lgkmcnt(3)
    v_mfma_f32_32x32x16_bf16 v[68:83], v[24:27], v[32:35], v[68:83]
    ds_read_b128 v[24:27], v86 offset:9600
    v_exp_f32 v56, v56
    v_exp_f32 v57, v57
    v_exp_f32 v58, v58
    v_exp_f32 v59, v59
    v_cvt_pk_bf16_f32 v30, v56, v57
    v_cvt_pk_bf16_f32 v31, v58, v59
    s_waitcnt lgkmcnt(3)
    v_mfma_f32_32x32x8_bf16 v[36:51], v[16:17], v[8:9], v[36:51]
    v_exp_f32 v60, v60
    v_exp_f32 v61, v61
    v_exp_f32 v62, v62
    v_exp_f32 v63, v63
    v_cvt_pk_bf16_f32 v32, v60, v61
    v_cvt_pk_bf16_f32 v33, v62, v63
    s_waitcnt lgkmcnt(2)
    v_mfma_f32_32x32x16_bf16 v[68:83], v[20:23], v[28:31], v[68:83]
    ds_read_b128 v[20:23], v86 offset:19456
    v_exp_f32 v64, v64
    v_exp_f32 v65, v65
    v_exp_f32 v66, v66
    v_exp_f32 v67, v67
    v_cvt_pk_bf16_f32 v34, v64, v65
    v_cvt_pk_bf16_f32 v35, v66, v67
    v_add_u32 v84, 19456, v84
    v_add_u32 v85, 19456, v85
    v_add_u32 v86, 19456, v86
    s_add_u32 s41, s41, 1
    s_cmp_lt_u32 s41, 8
    s_cbranch_scc1 L_k2_kernel_loop_19
L_k2_kernel_join_6:
    s_waitcnt lgkmcnt(0)
    v_mfma_f32_32x32x16_bf16 v[68:83], v[24:27], v[32:35], v[68:83]
    s_nop 11
    v_mov_b32 v88, v78
    v_mov_b32 v89, v78
    s_mov_b32 s42, 528482304
    s_mov_b32 s43, 1400897536
    v_permlane32_swap_b32 v88, v89
    s_nop 1
    v_cmp_le_f32 vcc, s42, v88
    v_cmp_ge_f32 s[44:45], s43, v88
    s_and_b64 s[44:45], s[44:45], vcc
    s_cmp_eq_u64 s[44:45], exec
    s_cbranch_scc0 L_k2_kernel_fb_21
L_k2_kernel_fin_20:
    v_rcp_f32 v88, v88
    v_and_b32 v90, 31, v2
    v_lshrrev_b32 v91, 5, v2
    s_lshl_b32 s26, s21, 5
    v_add_u32 v90, s26, v90
    v_mul_u32_u24 v90, 1152, v90
    v_lshl_add_u32 v90, v91, 3, v90
    s_mul_i32 s27, s20, 36
    s_add_u32 s27, s27, 8388608
    v_mul_f32 v68, v68, v88
    v_mul_f32 v69, v69, v88
    v_mul_f32 v70, v70, v88
    v_mul_f32 v71, v71, v88
    v_mul_f32 v72, v72, v88
    v_mul_f32 v73, v73, v88
    v_mul_f32 v74, v74, v88
    v_mul_f32 v75, v75, v88
    v_mul_f32 v76, v76, v88
    v_mul_f32 v77, v77, v88
    v_cvt_pk_bf16_f32 v28, v68, v69
    v_cvt_pk_bf16_f32 v29, v70, v71
    v_cvt_pk_bf16_f32 v30, v72, v73
    v_cvt_pk_bf16_f32 v31, v74, v75
    v_cvt_pk_bf16_f32 v32, v76, v77
    buffer_store_dwordx2 v[28:29], v90, s[8:11], s27 offen
    buffer_store_dwordx2 v[30:31], v90, s[8:11], s27 offen offset:16
    s_mov_b32 exec_hi, 0
    buffer_store_dword v32, v90, s[8:11], s27 offen offset:32
    s_mov_b64 exec, -1
    s_cmp_eq_u32 s35, 3
    s_cbranch_scc1 L_k2_kernel_help_23
    s_waitcnt vmcnt(3)
    v_permlane32_swap_b32 v100, v104
    v_permlane32_swap_b32 v101, v105
    v_permlane32_swap_b32 v102, v106
    v_permlane32_swap_b32 v103, v107
    v_permlane32_swap_b32 v108, v112
    v_permlane32_swap_b32 v109, v113
    v_permlane32_swap_b32 v110, v114
    v_permlane32_swap_b32 v111, v115
    s_nop 1
    v_cvt_pk_bf16_f32 v132, v100, v104
    v_cvt_pk_bf16_f32 v133, v101, v105
    v_cvt_pk_bf16_f32 v134, v102, v106
    v_cvt_pk_bf16_f32 v135, v103, v107
    v_cvt_pk_bf16_f32 v136, v108, v112
    v_cvt_pk_bf16_f32 v137, v109, v113
    v_cvt_pk_bf16_f32 v138, v110, v114
    v_cvt_pk_bf16_f32 v139, v111, v115
    buffer_store_dwordx4 v[132:135], v216, s[8:11], s33 offen offset:0
    buffer_store_dwordx4 v[136:139], v216, s[8:11], s33 offen offset:32
    v_permlane32_swap_b32 v116, v120
    v_permlane32_swap_b32 v117, v121
    v_permlane32_swap_b32 v118, v122
    v_permlane32_swap_b32 v119, v123
    v_permlane32_swap_b32 v124, v128
    v_permlane32_swap_b32 v125, v129
    v_permlane32_swap_b32 v126, v130
    v_permlane32_swap_b32 v127, v131
    s_nop 1
    v_cvt_pk_bf16_f32 v140, v116, v120
    v_cvt_pk_bf16_f32 v141, v117, v121
    v_cvt_pk_bf16_f32 v142, v118, v122
    v_cvt_pk_bf16_f32 v143, v119, v123
    v_cvt_pk_bf16_f32 v144, v124, v128
    v_cvt_pk_bf16_f32 v145, v125, v129
    v_cvt_pk_bf16_f32 v146, v126, v130
    v_cvt_pk_bf16_f32 v147, v127, v131
    buffer_store_dwordx4 v[140:143], v216, s[8:11], s34 offen offset:0
    buffer_store_dwordx4 v[144:147], v216, s[8:11], s34 offen offset:32
L_k2_kernel_help_23:
    s_branch L_k2_kernel_end_22
L_k2_kernel_fb_21:
    v_mov_b32 v94, 0xff800000
    s_mov_b32 s46, 0
    s_nop 7
L_k2_kernel_pass_24:
    v_mov_b32 v68, 0
    v_mov_b32 v69, 0
    v_mov_b32 v70, 0
    v_mov_b32 v71, 0
    v_mov_b32 v72, 0
    v_mov_b32 v73, 0
    v_mov_b32 v74, 0
    v_mov_b32 v75, 0
    v_mov_b32 v76, 0
    v_mov_b32 v77, 0
    v_mov_b32 v78, 0
    v_mov_b32 v79, 0
    v_mov_b32 v80, 0
    v_mov_b32 v81, 0
    v_mov_b32 v82, 0
    v_mov_b32 v83, 0
    s_mov_b32 s41, 0
L_k2_kernel_sl_25:
    s_lshr_b32 s47, s41, 3
    s_mul_i32 s47, s47, 19456
    s_and_b32 s48, s41, 7
    s_mul_i32 s52, s20, 155648
    s_add_u32 s47, s47, s52
    s_lshl_b32 s49, s48, 10
    s_add_u32 s49, s49, s47
    v_lshlrev_b32 v95, 4, v2
    buffer_load_dwordx4 v[12:15], v95, s[8:11], s49 offen
    s_lshr_b32 s49, s48, 2
    s_lshl_b32 s49, s49, 9
    s_and_b32 s50, s48, 3
    s_lshl_b32 s50, s50, 2
    s_add_u32 s49, s49, s50
    s_add_u32 s49, s49, s47
    s_add_u32 s49, s49, 8192
    v_and_b32 v96, 31, v2
    v_lshlrev_b32 v96, 4, v96
    buffer_load_dword v16, v96, s[8:11], s49 offen
    s_mul_i32 s49, s48, 1280
    s_add_u32 s49, s49, s47
    s_add_u32 s49, s49, 9216
    v_mov_b32 v17, 0
    buffer_load_dwordx4 v[20:23], v93, s[8:11], s49 offen
    buffer_load_dwordx4 v[24:27], v93, s[8:11], s49 offen offset:640
    s_waitcnt vmcnt(0)
    v_mfma_f32_32x32x16_bf16 v[36:51], v[12:15], v[4:7], 0
    v_mfma_f32_32x32x8_bf16 v[36:51], v[16:17], v[8:9], v[36:51]
    s_nop 11
    s_cmp_eq_u32 s46, 1
    s_cbranch_scc1 L_k2_kernel_p2_26
    v_max3_f32 v94, v36, v37, v94
    v_max3_f32 v94, v38, v39, v94
    v_max3_f32 v94, v40, v41, v94
    v_max3_f32 v94, v42, v43, v94
    v_max3_f32 v94, v44, v45, v94
    v_max3_f32 v94, v46, v47, v94
    v_max3_f32 v94, v48, v49, v94
    v_max3_f32 v94, v50, v51, v94
    s_branch L_k2_kernel_nx_27
L_k2_kernel_p2_26:
    v_sub_f32 v36, v36, v94
    v_sub_f32 v37, v37, v94
    v_sub_f32 v38, v38, v94
    v_sub_f32 v39, v39, v94
    v_sub_f32 v40, v40, v94
    v_sub_f32 v41, v41, v94
    v_sub_f32 v42, v42, v94
    v_sub_f32 v43, v43, v94
    v_sub_f32 v44, v44, v94
    v_sub_f32 v45, v45, v94
    v_sub_f32 v46, v46, v94
    v_sub_f32 v47, v47, v94
    v_sub_f32 v48, v48, v94
    v_sub_f32 v49, v49, v94
    v_sub_f32 v50, v50, v94
    v_sub_f32 v51, v51, v94
    v_exp_f32 v36, v36
    v_exp_f32 v37, v37
    v_exp_f32 v38, v38
    v_exp_f32 v39, v39
    v_exp_f32 v40, v40
    v_exp_f32 v41, v41
    v_exp_f32 v42, v42
    v_exp_f32 v43, v43
    v_exp_f32 v44, v44
    v_exp_f32 v45, v45
    v_exp_f32 v46, v46
    v_exp_f32 v47, v47
    v_exp_f32 v48, v48
    v_exp_f32 v49, v49
    v_exp_f32 v50, v50
    v_exp_f32 v51, v51
    s_nop 0
    v_cvt_pk_bf16_f32 v28, v36, v37
    v_cvt_pk_bf16_f32 v29, v38, v39
    v_cvt_pk_bf16_f32 v30, v40, v41
    v_cvt_pk_bf16_f32 v31, v42, v43
    v_cvt_pk_bf16_f32 v32, v44, v45
    v_cvt_pk_bf16_f32 v33, v46, v47
    v_cvt_pk_bf16_f32 v34, v48, v49
    v_cvt_pk_bf16_f32 v35, v50, v51
    s_nop 1
    v_mfma_f32_32x32x16_bf16 v[68:83], v[20:23], v[28:31], v[68:83]
    v_mfma_f32_32x32x16_bf16 v[68:83], v[24:27], v[32:35], v[68:83]
L_k2_kernel_nx_27:
    s_add_u32 s41, s41, 1
    s_cmp_lt_u32 s41, 64
    s_cbranch_scc1 L_k2_kernel_sl_25
    s_cmp_eq_u32 s46, 1
    s_cbranch_scc1 L_k2_kernel_fbdone_28
    v_mov_b32 v95, v94
    s_nop 1
    v_permlane32_swap_b32 v94, v95
    s_nop 1
    v_max_f32 v94, v94, v95
    s_mov_b32 s46, 1
    s_branch L_k2_kernel_pass_24
L_k2_kernel_fbdone_28:
    s_nop 11
    v_mov_b32 v88, v78
    v_mov_b32 v89, v78
    s_nop 1
    v_permlane32_swap_b32 v88, v89
    s_nop 1
    s_branch L_k2_kernel_fin_20
L_k2_kernel_end_22:
L_k2_kernel_exit:
    s_endpgm

.text
.globl k3_kernel
.p2align 8
.type k3_kernel,@function
k3_kernel:
    s_cmp_ge_u32 s2, 216
    s_cbranch_scc1 L_k3_kernel_exit
    s_cmp_ge_u32 s2, 144
    s_cbranch_scc1 L_k3_kernel_fin_1
    s_load_dwordx4 s[4:7], s[0:1], 72
    s_load_dwordx2 s[28:29], s[0:1], 96
    v_lshrrev_b32 v1, 6, v0
    v_and_b32 v2, 63, v0
    s_and_b32 s30, s2, 7
    v_readfirstlane_b32 s19, v1
    s_lshr_b32 s31, s2, 3
    s_lshl_b32 s21, s30, 1
    s_and_b32 s32, s31, 1
    s_add_u32 s21, s21, s32
    s_lshr_b32 s22, s31, 1
    s_and_b32 s20, s19, 3
    s_lshr_b32 s43, s19, 2
    s_lshl_b32 s24, s21, 7
    s_lshl_b32 s33, s20, 5
    s_add_u32 s24, s24, s33
    s_lshl_b32 s33, s43, 4
    s_add_u32 s24, s24, s33
    s_mul_i32 s24, s24, 1152
    s_add_u32 s24, s24, 8388608
    s_lshl_b32 s25, s22, 7
    s_mul_i32 s33, s19, 9216
    s_add_u32 s25, s25, s33
    s_lshl_b32 s26, s20, 12
    s_lshl_b32 s33, s43, 11
    s_add_u32 s48, s26, s33
    s_lshl_b32 s27, s19, 10
    s_add_u32 s27, s27, 65536
    v_lshrrev_b32 v48, 3, v2
    v_mul_u32_u24 v48, 1152, v48
    v_and_b32 v49, 7, v2
    v_lshrrev_b32 v50, 4, v2
    v_xor_b32 v51, v49, v50
    v_lshl_add_u32 v4, v51, 4, v48
    v_xor_b32 v51, 4, v51
    v_lshl_add_u32 v5, v51, 4, v48
    v_bfe_u32 v51, v2, 4, 1
    v_lshlrev_b32 v51, 2, v51
    v_xor_b32 v51, v49, v51
    v_lshl_add_u32 v6, v51, 4, v48
    s_waitcnt lgkmcnt(0)
    s_mov_b32 s8, s28
    s_and_b32 s9, s29, 0xffff
    s_mov_b32 s10, 26214400
    s_mov_b32 s11, 0x00020000
    s_mov_b32 s12, s4
    s_and_b32 s13, s5, 0xffff
    s_mov_b32 s14, 663552
    s_mov_b32 s15, 0x00020000
    s_mov_b32 s16, s6
    s_and_b32 s17, s7, 0xffff
    s_mov_b32 s18, 4718592
    s_mov_b32 s19, 0x00020000
    s_add_u32 m0, s48, 0
    s_add_u32 s28, s24, 0
    buffer_load_dwordx4 v4, s[8:11], s28 offen lds
    s_add_u32 m0, s48, 1024
    s_add_u32 s28, s24, 9216
    buffer_load_dwordx4 v5, s[8:11], s28 offen lds
    s_add_u32 m0, s27, 0
    s_add_u32 s28, s25, 0
    buffer_load_dwordx4 v6, s[12:15], s28 offen lds
    s_barrier
    s_add_u32 m0, s48, 16384
    s_add_u32 s28, s24, 128
    buffer_load_dwordx4 v4, s[8:11], s28 offen lds
    s_add_u32 m0, s48, 17408
    s_add_u32 s28, s24, 9344
    buffer_load_dwordx4 v5, s[8:11], s28 offen lds
    s_add_u32 m0, s27, 8192
    s_add_u32 s28, s25, 73728
    buffer_load_dwordx4 v6, s[12:15], s28 offen lds
    s_add_u32 m0, s48, 32768
    s_add_u32 s28, s24, 256
    buffer_load_dwordx4 v4, s[8:11], s28 offen lds
    s_add_u32 m0, s48, 33792
    s_add_u32 s28, s24, 9472
    buffer_load_dwordx4 v5, s[8:11], s28 offen lds
    s_add_u32 m0, s27, 16384
    s_add_u32 s28, s25, 147456
    buffer_load_dwordx4 v6, s[12:15], s28 offen lds
    v_and_b32 v48, 31, v2
    v_lshrrev_b32 v49, 5, v2
    v_bfe_u32 v50, v48, 1, 3
    v_lshlrev_b32 v48, 7, v48
    v_add_u32 v48, s26, v48
    v_add_u32 v51, 0, v49
    v_xor_b32 v51, v51, v50
    v_lshl_add_u32 v8, v51, 4, v48
    v_add_u32 v51, 2, v49
    v_xor_b32 v51, v51, v50
    v_lshl_add_u32 v9, v51, 4, v48
    v_add_u32 v51, 4, v49
    v_xor_b32 v51, v51, v50
    v_lshl_add_u32 v10, v51, 4, v48
    v_add_u32 v51, 6, v49
    v_xor_b32 v51, v51, v50
    v_lshl_add_u32 v11, v51, 4, v48
    v_add_u32 v56, 65536, v8
    v_add_u32 v57, 65536, v9
    v_add_u32 v58, 65536, v10
    v_add_u32 v59, 65536, v11
    v_bfe_u32 v48, v2, 2, 2
    v_lshrrev_b32 v49, 5, v2
    v_lshl_add_u32 v48, v49, 3, v48
    v_lshlrev_b32 v48, 7, v48
    v_add_u32 v48, 65536, v48
    v_bfe_u32 v49, v2, 4, 1
    v_and_b32 v50, 3, v2
    v_bfe_u32 v51, v2, 3, 1
    v_and_b32 v52, 1, v50
    v_lshl_add_u32 v52, v49, 1, v52
    v_xor_b32 v51, s43, v51
    v_lshl_add_u32 v52, v51, 2, v52
    v_lshlrev_b32 v52, 4, v52
    v_lshrrev_b32 v53, 1, v50
    v_lshl_add_u32 v52, v53, 3, v52
    v_add_u32 v12, v48, v52
    s_waitcnt vmcnt(6)
    s_waitcnt lgkmcnt(0)
    s_barrier
    ds_read_b128 v[32:35], v8 offset:0
    ds_read_b64_tr_b16 v[40:41], v12 offset:0
    ds_read_b64_tr_b16 v[42:43], v12 offset:512
    ds_read_b128 v[36:39], v9 offset:0
    ds_read_b64_tr_b16 v[44:45], v12 offset:2048
    ds_read_b64_tr_b16 v[46:47], v12 offset:2560
    s_add_u32 m0, s48, 49152
    s_add_u32 s28, s24, 384
    buffer_load_dwordx4 v4, s[8:11], s28 offen lds
    s_waitcnt lgkmcnt(3)
    v_mfma_f32_32x32x16_bf16 v[16:31], v[40:43], v[32:35], 0
    ds_read_b128 v[32:35], v10 offset:0
    ds_read_b64_tr_b16 v[40:41], v12 offset:4096
    ds_read_b64_tr_b16 v[42:43], v12 offset:4608
    s_add_u32 m0, s48, 50176
    s_add_u32 s28, s24, 9600
    buffer_load_dwordx4 v5, s[8:11], s28 offen lds
    s_waitcnt lgkmcnt(3)
    v_mfma_f32_32x32x16_bf16 v[16:31], v[44:47], v[36:39], v[16:31]
    ds_read_b128 v[36:39], v11 offset:0
    ds_read_b64_tr_b16 v[44:45], v12 offset:6144
    ds_read_b64_tr_b16 v[46:47], v12 offset:6656
    s_add_u32 m0, s27, 24576
    s_add_u32 s28, s25, 221184
    buffer_load_dwordx4 v6, s[12:15], s28 offen lds
    s_waitcnt lgkmcnt(3)
    v_mfma_f32_32x32x16_bf16 v[16:31], v[40:43], v[32:35], v[16:31]
    s_waitcnt vmcnt(6)
    s_waitcnt lgkmcnt(0)
    s_barrier
    ds_read_b128 v[32:35], v8 offset:16384
    ds_read_b64_tr_b16 v[40:41], v12 offset:8192
    ds_read_b64_tr_b16 v[42:43], v12 offset:8704
    v_mfma_f32_32x32x16_bf16 v[16:31], v[44:47], v[36:39], v[16:31]
    ds_read_b128 v[36:39], v9 offset:16384
    ds_read_b64_tr_b16 v[44:45], v12 offset:10240
    ds_read_b64_tr_b16 v[46:47], v12 offset:10752
    s_add_u32 m0, s48, 0
    s_add_u32 s28, s24, 512
    buffer_load_dwordx4 v4, s[8:11], s28 offen lds
    s_waitcnt lgkmcnt(3)
    v_mfma_f32_32x32x16_bf16 v[16:31], v[40:43], v[32:35], v[16:31]
    ds_read_b128 v[32:35], v10 offset:16384
    ds_read_b64_tr_b16 v[40:41], v12 offset:12288
    ds_read_b64_tr_b16 v[42:43], v12 offset:12800
    s_add_u32 m0, s48, 1024
    s_add_u32 s28, s24, 9728
    buffer_load_dwordx4 v5, s[8:11], s28 offen lds
    s_waitcnt lgkmcnt(3)
    v_mfma_f32_32x32x16_bf16 v[16:31], v[44:47], v[36:39], v[16:31]
    ds_read_b128 v[36:39], v11 offset:16384
    ds_read_b64_tr_b16 v[44:45], v12 offset:14336
    ds_read_b64_tr_b16 v[46:47], v12 offset:14848
    s_add_u32 m0, s27, 0
    s_add_u32 s28, s25, 294912
    buffer_load_dwordx4 v6, s[12:15], s28 offen lds
    s_waitcnt lgkmcnt(3)
    v_mfma_f32_32x32x16_bf16 v[16:31], v[40:43], v[32:35], v[16:31]
    s_waitcnt vmcnt(6)
    s_waitcnt lgkmcnt(0)
    s_barrier
    ds_read_b128 v[32:35], v8 offset:32768
    ds_read_b64_tr_b16 v[40:41], v12 offset:16384
    ds_read_b64_tr_b16 v[42:43], v12 offset:16896
    v_mfma_f32_32x32x16_bf16 v[16:31], v[44:47], v[36:39], v[16:31]
    ds_read_b128 v[36:39], v9 offset:32768
    ds_read_b64_tr_b16 v[44:45], v12 offset:18432
    ds_read_b64_tr_b16 v[46:47], v12 offset:18944
    s_add_u32 m0, s48, 16384
    s_add_u32 s28, s24, 640
    buffer_load_dwordx4 v4, s[8:11], s28 offen lds
    s_waitcnt lgkmcnt(3)
    v_mfma_f32_32x32x16_bf16 v[16:31], v[40:43], v[32:35], v[16:31]
    ds_read_b128 v[32:35], v10 offset:32768
    ds_read_b64_tr_b16 v[40:41], v12 offset:20480
    ds_read_b64_tr_b16 v[42:43], v12 offset:20992
    s_add_u32 m0, s48, 17408
    s_add_u32 s28, s24, 9856
    buffer_load_dwordx4 v5, s[8:11], s28 offen lds
    s_waitcnt lgkmcnt(3)
    v_mfma_f32_32x32x16_bf16 v[16:31], v[44:47], v[36:39], v[16:31]
    ds_read_b128 v[36:39], v11 offset:32768
    ds_read_b64_tr_b16 v[44:45], v12 offset:22528
    ds_read_b64_tr_b16 v[46:47], v12 offset:23040
    s_add_u32 m0, s27, 8192
    s_add_u32 s28, s25, 368640
    buffer_load_dwordx4 v6, s[12:15], s28 offen lds
    s_waitcnt lgkmcnt(3)
    v_mfma_f32_32x32x16_bf16 v[16:31], v[40:43], v[32:35], v[16:31]
    s_waitcnt vmcnt(6)
    s_waitcnt lgkmcnt(0)
    s_barrier
    ds_read_b128 v[32:35], v8 offset:49152
    ds_read_b64_tr_b16 v[40:41], v12 offset:24576
    ds_read_b64_tr_b16 v[42:43], v12 offset:25088
    v_mfma_f32_32x32x16_bf16 v[16:31], v[44:47], v[36:39], v[16:31]
    ds_read_b128 v[36:39], v9 offset:49152
    ds_read_b64_tr_b16 v[44:45], v12 offset:26624
    ds_read_b64_tr_b16 v[46:47], v12 offset:27136
    s_add_u32 m0, s48, 32768
    s_add_u32 s28, s24, 768
    buffer_load_dwordx4 v4, s[8:11], s28 offen lds
    s_waitcnt lgkmcnt(3)
    v_mfma_f32_32x32x16_bf16 v[16:31], v[40:43], v[32:35], v[16:31]
    ds_read_b128 v[32:35], v10 offset:49152
    ds_read_b64_tr_b16 v[40:41], v12 offset:28672
    ds_read_b64_tr_b16 v[42:43], v12 offset:29184
    s_add_u32 m0, s48, 33792
    s_add_u32 s28, s24, 9984
    buffer_load_dwordx4 v5, s[8:11], s28 offen lds
    s_waitcnt lgkmcnt(3)
    v_mfma_f32_32x32x16_bf16 v[16:31], v[44:47], v[36:39], v[16:31]
    ds_read_b128 v[36:39], v11 offset:49152
    ds_read_b64_tr_b16 v[44:45], v12 offset:30720
    ds_read_b64_tr_b16 v[46:47], v12 offset:31232
    s_add_u32 m0, s27, 16384
    s_add_u32 s28, s25, 442368
    buffer_load_dwordx4 v6, s[12:15], s28 offen lds
    s_waitcnt lgkmcnt(3)
    v_mfma_f32_32x32x16_bf16 v[16:31], v[40:43], v[32:35], v[16:31]
    s_waitcnt vmcnt(6)
    s_waitcnt lgkmcnt(0)
    s_barrier
    ds_read_b128 v[32:35], v8 offset:0
    ds_read_b64_tr_b16 v[40:41], v12 offset:0
    ds_read_b64_tr_b16 v[42:43], v12 offset:512
    v_mfma_f32_32x32x16_bf16 v[16:31], v[44:47], v[36:39], v[16:31]
    ds_read_b128 v[36:39], v9 offset:0
    ds_read_b64_tr_b16 v[44:45], v12 offset:2048
    ds_read_b64_tr_b16 v[46:47], v12 offset:2560
    s_add_u32 m0, s48, 49152
    s_add_u32 s28, s24, 896
    buffer_load_dwordx4 v4, s[8:11], s28 offen lds
    s_waitcnt lgkmcnt(3)
    v_mfma_f32_32x32x16_bf16 v[16:31], v[40:43], v[32:35], v[16:31]
    ds_read_b128 v[32:35], v10 offset:0
    ds_read_b64_tr_b16 v[40:41], v12 offset:4096
    ds_read_b64_tr_b16 v[42:43], v12 offset:4608
    s_add_u32 m0, s48, 50176
    s_add_u32 s28, s24, 10112
    buffer_load_dwordx4 v5, s[8:11], s28 offen lds
    s_waitcnt lgkmcnt(3)
    v_mfma_f32_32x32x16_bf16 v[16:31], v[44:47], v[36:39], v[16:31]
    ds_read_b128 v[36:39], v11 offset:0
    ds_read_b64_tr_b16 v[44:45], v12 offset:6144
    ds_read_b64_tr_b16 v[46:47], v12 offset:6656
    s_add_u32 m0, s27, 24576
    s_add_u32 s28, s25, 516096
    buffer_load_dwordx4 v6, s[12:15], s28 offen lds
    s_waitcnt lgkmcnt(3)
    v_mfma_f32_32x32x16_bf16 v[16:31], v[40:43], v[32:35], v[16:31]
    s_waitcnt vmcnt(6)
    s_waitcnt lgkmcnt(0)
    s_barrier
    ds_read_b128 v[32:35], v8 offset:16384
    ds_read_b64_tr_b16 v[40:41], v12 offset:8192
    ds_read_b64_tr_b16 v[42:43], v12 offset:8704
    v_mfma_f32_32x32x16_bf16 v[16:31], v[44:47], v[36:39], v[16:31]
    ds_read_b128 v[36:39], v9 offset:16384
    ds_read_b64_tr_b16 v[44:45], v12 offset:10240
    ds_read_b64_tr_b16 v[46:47], v12 offset:10752
    s_add_u32 m0, s48, 0
    s_add_u32 s28, s24, 1024
    buffer_load_dwordx4 v4, s[8:11], s28 offen lds
    s_waitcnt lgkmcnt(3)
    v_mfma_f32_32x32x16_bf16 v[16:31], v[40:43], v[32:35], v[16:31]
    ds_read_b128 v[32:35], v10 offset:16384
    ds_read_b64_tr_b16 v[40:41], v12 offset:12288
    ds_read_b64_tr_b16 v[42:43], v12 offset:12800
    s_add_u32 m0, s48, 1024
    s_add_u32 s28, s24, 10240
    buffer_load_dwordx4 v5, s[8:11], s28 offen lds
    s_waitcnt lgkmcnt(3)
    v_mfma_f32_32x32x16_bf16 v[16:31], v[44:47], v[36:39], v[16:31]
    ds_read_b128 v[36:39], v11 offset:16384
    ds_read_b64_tr_b16 v[44:45], v12 offset:14336
    ds_read_b64_tr_b16 v[46:47], v12 offset:14848
    s_add_u32 m0, s27, 0
    s_add_u32 s28, s25, 589824
    buffer_load_dwordx4 v6, s[12:15], s28 offen lds
    s_waitcnt lgkmcnt(3)
    v_mfma_f32_32x32x16_bf16 v[16:31], v[40:43], v[32:35], v[16:31]
    s_waitcnt vmcnt(6)
    s_waitcnt lgkmcnt(0)
    s_barrier
    ds_read_b128 v[32:35], v8 offset:32768
    ds_read_b64_tr_b16 v[40:41], v12 offset:16384
    ds_read_b64_tr_b16 v[42:43], v12 offset:16896
    v_mfma_f32_32x32x16_bf16 v[16:31], v[44:47], v[36:39], v[16:31]
    ds_read_b128 v[36:39], v9 offset:32768
    ds_read_b64_tr_b16 v[44:45], v12 offset:18432
    ds_read_b64_tr_b16 v[46:47], v12 offset:18944
    s_waitcnt lgkmcnt(3)
    v_mfma_f32_32x32x16_bf16 v[16:31], v[40:43], v[32:35], v[16:31]
    ds_read_b128 v[32:35], v10 offset:32768
    ds_read_b64_tr_b16 v[40:41], v12 offset:20480
    ds_read_b64_tr_b16 v[42:43], v12 offset:20992
    s_waitcnt lgkmcnt(3)
    v_mfma_f32_32x32x16_bf16 v[16:31], v[44:47], v[36:39], v[16:31]
    ds_read_b128 v[36:39], v11 offset:32768
    ds_read_b64_tr_b16 v[44:45], v12 offset:22528
    ds_read_b64_tr_b16 v[46:47], v12 offset:23040
    s_waitcnt lgkmcnt(3)
    v_mfma_f32_32x32x16_bf16 v[16:31], v[40:43], v[32:35], v[16:31]
    s_waitcnt vmcnt(3)
    s_waitcnt lgkmcnt(0)
    s_barrier
    ds_read_b128 v[32:35], v8 offset:49152
    ds_read_b64_tr_b16 v[40:41], v12 offset:24576
    ds_read_b64_tr_b16 v[42:43], v12 offset:25088
    v_mfma_f32_32x32x16_bf16 v[16:31], v[44:47], v[36:39], v[16:31]
    ds_read_b128 v[36:39], v9 offset:49152
    ds_read_b64_tr_b16 v[44:45], v12 offset:26624
    ds_read_b64_tr_b16 v[46:47], v12 offset:27136
    s_waitcnt lgkmcnt(3)
    v_mfma_f32_32x32x16_bf16 v[16:31], v[40:43], v[32:35], v[16:31]
    ds_read_b128 v[32:35], v10 offset:49152
    ds_read_b64_tr_b16 v[40:41], v12 offset:28672
    ds_read_b64_tr_b16 v[42:43], v12 offset:29184
    s_waitcnt lgkmcnt(3)
    v_mfma_f32_32x32x16_bf16 v[16:31], v[44:47], v[36:39], v[16:31]
    ds_read_b128 v[36:39], v11 offset:49152
    ds_read_b64_tr_b16 v[44:45], v12 offset:30720
    ds_read_b64_tr_b16 v[46:47], v12 offset:31232
    s_waitcnt lgkmcnt(3)
    v_mfma_f32_32x32x16_bf16 v[16:31], v[40:43], v[32:35], v[16:31]
    s_waitcnt vmcnt(0)
    s_waitcnt lgkmcnt(0)
    s_barrier
    ds_read_b128 v[32:35], v8 offset:0
    ds_read_b64_tr_b16 v[40:41], v12 offset:0
    ds_read_b64_tr_b16 v[42:43], v12 offset:512
    v_mfma_f32_32x32x16_bf16 v[16:31], v[44:47], v[36:39], v[16:31]
    ds_read_b128 v[36:39], v9 offset:0
    ds_read_b64_tr_b16 v[44:45], v12 offset:2048
    ds_read_b64_tr_b16 v[46:47], v12 offset:2560
    s_waitcnt lgkmcnt(3)
    v_mfma_f32_32x32x16_bf16 v[16:31], v[40:43], v[32:35], v[16:31]
    ds_read_b128 v[32:35], v10 offset:0
    ds_read_b64_tr_b16 v[40:41], v12 offset:4096
    ds_read_b64_tr_b16 v[42:43], v12 offset:4608
    s_waitcnt lgkmcnt(3)
    v_mfma_f32_32x32x16_bf16 v[16:31], v[44:47], v[36:39], v[16:31]
    ds_read_b128 v[36:39], v11 offset:0
    ds_read_b64_tr_b16 v[44:45], v12 offset:6144
    ds_read_b64_tr_b16 v[46:47], v12 offset:6656
    s_waitcnt lgkmcnt(3)
    v_mfma_f32_32x32x16_bf16 v[16:31], v[40:43], v[32:35], v[16:31]
    s_waitcnt lgkmcnt(0)
    v_mfma_f32_32x32x16_bf16 v[16:31], v[44:47], v[36:39], v[16:31]
    s_lshl_b32 s30, s21, 7
    s_lshl_b32 s31, s20, 5
    s_add_u32 s30, s30, s31
    s_mul_i32 s30, s30, 2304
    s_lshl_b32 s31, s22, 7
    s_add_u32 s30, s30, s31
    s_lshl_b32 s31, s43, 6
    s_add_u32 s30, s30, s31
    s_add_u32 s30, s30, 1152
    v_and_b32 v48, 31, v2
    v_mul_u32_u24 v48, 2304, v48
    v_lshrrev_b32 v49, 5, v2
    v_lshl_add_u32 v48, v49, 4, v48
    s_nop 3
    v_cvt_pk_bf16_f32 v32, v16, v17
    v_cvt_pk_bf16_f32 v33, v18, v19
    v_cvt_pk_bf16_f32 v34, v20, v21
    v_cvt_pk_bf16_f32 v35, v22, v23
    buffer_store_dwordx4 v[32:35], v48, s[16:19], s30 offen offset:0
    v_cvt_pk_bf16_f32 v36, v24, v25
    v_cvt_pk_bf16_f32 v37, v26, v27
    v_cvt_pk_bf16_f32 v38, v28, v29
    v_cvt_pk_bf16_f32 v39, v30, v31
    buffer_store_dwordx4 v[36:39], v48, s[16:19], s30 offen offset:32
    s_branch L_k3_kernel_k3end_2
L_k3_kernel_fin_1:
    s_sub_u32 s50, s2, 144
    s_load_dwordx2 s[26:27], s[0:1], 80
    s_load_dwordx2 s[28:29], s[0:1], 96
    v_lshrrev_b32 v1, 6, v0
    v_and_b32 v2, 63, v0
    s_and_b32 s22, s50, 7
    v_readfirstlane_b32 s38, v1
    s_lshr_b32 s21, s50, 3
    s_cmp_lt_u32 s50, 64
    s_cbranch_scc1 L_k3_kernel_gd_4
    s_mov_b32 s22, 8
    s_sub_u32 s21, s50, 64
L_k3_kernel_gd_4:
    s_mul_i32 s24, s22, 262144
    s_lshl_b32 s25, s21, 9
    s_add_u32 s24, s24, s25
    s_mul_i32 s25, s38, 32768
    s_add_u32 s24, s24, s25
    s_add_u32 s24, s24, 20971520
    s_mul_i32 s39, s22, 131072
    s_lshl_b32 s25, s21, 9
    s_add_u32 s39, s39, s25
    s_mul_i32 s25, s38, 16384
    s_add_u32 s39, s39, s25
    s_add_u32 s39, s39, 24115200
    s_cmp_ge_u32 s21, 4
    s_cselect_b32 s39, s39, 0x40000000
    s_lshl_b32 s30, s38, 12
    s_and_b32 s31, s38, 1
    s_lshl_b32 s31, s31, 3
    v_lshrrev_b32 v32, 5, v2
    v_and_b32 v33, 31, v2
    v_lshlrev_b32 v34, 1, v32
    v_add_u32 v34, s31, v34
    v_xor_b32 v35, v33, v34
    v_xor_b32 v36, 4, v35
    v_lshlrev_b32 v35, 4, v35
    v_lshlrev_b32 v36, 4, v36
    v_lshlrev_b32 v37, 12, v32
    v_lshlrev_b32 v38, 11, v32
    v_add_u32 v39, v35, v37
    v_add_u32 v40, v36, v37
    v_add_u32 v41, v35, v38
    v_add_u32 v42, v36, v38
    s_waitcnt lgkmcnt(0)
    s_mov_b32 s8, s28
    s_and_b32 s9, s29, 0xffff
    s_mov_b32 s10, 26214400
    s_mov_b32 s11, 0x00020000
    s_mov_b32 s16, s26
    s_and_b32 s17, s27, 0xffff
    s_mov_b32 s18, 4718592
    s_mov_b32 s19, 0x00020000
    s_add_u32 m0, s30, 0
    s_add_u32 s31, s24, 0
    buffer_load_dwordx4 v39, s[8:11], s31 offen lds
    s_add_u32 m0, s30, 1024
    s_add_u32 s31, s24, 8192
    buffer_load_dwordx4 v40, s[8:11], s31 offen lds
    s_add_u32 m0, s30, 2048
    s_add_u32 s31, s24, 16384
    buffer_load_dwordx4 v39, s[8:11], s31 offen lds
    s_add_u32 m0, s30, 3072
    s_add_u32 s31, s24, 24576
    buffer_load_dwordx4 v40, s[8:11], s31 offen lds
    s_add_u32 m0, s30, 32768
    s_add_u32 s31, s39, 0
    buffer_load_dwordx4 v41, s[8:11], s31 offen lds
    s_add_u32 m0, s30, 33792
    s_add_u32 s31, s39, 4096
    buffer_load_dwordx4 v42, s[8:11], s31 offen lds
    s_add_u32 m0, s30, 34816
    s_add_u32 s31, s39, 8192
    buffer_load_dwordx4 v41, s[8:11], s31 offen lds
    s_add_u32 m0, s30, 35840
    s_add_u32 s31, s39, 12288
    buffer_load_dwordx4 v42, s[8:11], s31 offen lds
    v_lshrrev_b32 v32, 4, v2
    v_bfe_u32 v33, v2, 2, 2
    v_lshl_add_u32 v34, v32, 3, v33
    v_lshlrev_b32 v34, 9, v34
    v_and_b32 v35, 1, v32
    v_lshlrev_b32 v35, 3, v35
    v_lshl_add_u32 v35, v33, 1, v35
    v_bfe_u32 v36, v2, 1, 1
    s_lshl_b32 s31, s38, 2
    v_add_u32 v36, s31, v36
    v_xor_b32 v37, v36, v35
    v_add_u32 v36, 2, v36
    v_xor_b32 v38, v36, v35
    v_and_b32 v36, 1, v2
    v_lshl_add_u32 v34, v36, 3, v34
    v_lshl_add_u32 v37, v37, 4, v34
    v_lshl_add_u32 v38, v38, 4, v34
    v_and_b32 v36, 15, v2
    s_lshl_b32 s31, s21, 8
    s_lshl_b32 s36, s38, 5
    s_add_u32 s31, s31, s36
    v_add_u32 v36, s31, v36
    v_mul_u32_u24 v36, 2304, v36
    v_lshl_add_u32 v36, v32, 4, v36
    s_lshl_b32 s36, s22, 7
    s_mov_b32 s37, 0xffff0000
    s_waitcnt vmcnt(0)
    s_barrier
    ds_read_b64_tr_b16 v[8:9], v37 offset:0
    ds_read_b64_tr_b16 v[10:11], v37 offset:2048
    ds_read_b64_tr_b16 v[12:13], v37 offset:32768
    ds_read_b64_tr_b16 v[14:15], v37 offset:34816
    s_waitcnt lgkmcnt(0)
    v_lshlrev_b32 v48, 16, v8
    v_and_b32 v49, s37, v8
    v_lshlrev_b32 v50, 16, v12
    v_and_b32 v51, s37, v12
    v_add_f32 v48, v48, v50
    v_add_f32 v49, v49, v51
    v_cvt_pk_bf16_f32 v24, v48, v49
    v_lshlrev_b32 v48, 16, v9
    v_and_b32 v49, s37, v9
    v_lshlrev_b32 v50, 16, v13
    v_and_b32 v51, s37, v13
    v_add_f32 v48, v48, v50
    v_add_f32 v49, v49, v51
    v_cvt_pk_bf16_f32 v25, v48, v49
    v_lshlrev_b32 v48, 16, v10
    v_and_b32 v49, s37, v10
    v_lshlrev_b32 v50, 16, v14
    v_and_b32 v51, s37, v14
    v_add_f32 v48, v48, v50
    v_add_f32 v49, v49, v51
    v_cvt_pk_bf16_f32 v26, v48, v49
    v_lshlrev_b32 v48, 16, v11
    v_and_b32 v49, s37, v11
    v_lshlrev_b32 v50, 16, v15
    v_and_b32 v51, s37, v15
    v_add_f32 v48, v48, v50
    v_add_f32 v49, v49, v51
    v_cvt_pk_bf16_f32 v27, v48, v49
    s_add_u32 s31, s36, 0
    buffer_store_dwordx4 v[24:27], v36, s[16:19], s31 offen offset:0
    ds_read_b64_tr_b16 v[16:17], v37 offset:16384
    ds_read_b64_tr_b16 v[18:19], v37 offset:18432
    ds_read_b64_tr_b16 v[20:21], v37 offset:49152
    ds_read_b64_tr_b16 v[22:23], v37 offset:51200
    s_waitcnt lgkmcnt(0)
    v_lshlrev_b32 v48, 16, v16
    v_and_b32 v49, s37, v16
    v_lshlrev_b32 v50, 16, v20
    v_and_b32 v51, s37, v20
    v_add_f32 v48, v48, v50
    v_add_f32 v49, v49, v51
    v_cvt_pk_bf16_f32 v28, v48, v49
    v_lshlrev_b32 v48, 16, v17
    v_and_b32 v49, s37, v17
    v_lshlrev_b32 v50, 16, v21
    v_and_b32 v51, s37, v21
    v_add_f32 v48, v48, v50
    v_add_f32 v49, v49, v51
    v_cvt_pk_bf16_f32 v29, v48, v49
    v_lshlrev_b32 v48, 16, v18
    v_and_b32 v49, s37, v18
    v_lshlrev_b32 v50, 16, v22
    v_and_b32 v51, s37, v22
    v_add_f32 v48, v48, v50
    v_add_f32 v49, v49, v51
    v_cvt_pk_bf16_f32 v30, v48, v49
    v_lshlrev_b32 v48, 16, v19
    v_and_b32 v49, s37, v19
    v_lshlrev_b32 v50, 16, v23
    v_and_b32 v51, s37, v23
    v_add_f32 v48, v48, v50
    v_add_f32 v49, v49, v51
    v_cvt_pk_bf16_f32 v31, v48, v49
    s_add_u32 s31, s36, 0
    buffer_store_dwordx4 v[28:31], v36, s[16:19], s31 offen offset:64
    ds_read_b64_tr_b16 v[8:9], v38 offset:0
    ds_read_b64_tr_b16 v[10:11], v38 offset:2048
    ds_read_b64_tr_b16 v[12:13], v38 offset:32768
    ds_read_b64_tr_b16 v[14:15], v38 offset:34816
    s_waitcnt lgkmcnt(0)
    v_lshlrev_b32 v48, 16, v8
    v_and_b32 v49, s37, v8
    v_lshlrev_b32 v50, 16, v12
    v_and_b32 v51, s37, v12
    v_add_f32 v48, v48, v50
    v_add_f32 v49, v49, v51
    v_cvt_pk_bf16_f32 v24, v48, v49
    v_lshlrev_b32 v48, 16, v9
    v_and_b32 v49, s37, v9
    v_lshlrev_b32 v50, 16, v13
    v_and_b32 v51, s37, v13
    v_add_f32 v48, v48, v50
    v_add_f32 v49, v49, v51
    v_cvt_pk_bf16_f32 v25, v48, v49
    v_lshlrev_b32 v48, 16, v10
    v_and_b32 v49, s37, v10
    v_lshlrev_b32 v50, 16, v14
    v_and_b32 v51, s37, v14
    v_add_f32 v48, v48, v50
    v_add_f32 v49, v49, v51
    v_cvt_pk_bf16_f32 v26, v48, v49
    v_lshlrev_b32 v48, 16, v11
    v_and_b32 v49, s37, v11
    v_lshlrev_b32 v50, 16, v15
    v_and_b32 v51, s37, v15
    v_add_f32 v48, v48, v50
    v_add_f32 v49, v49, v51
    v_cvt_pk_bf16_f32 v27, v48, v49
    s_add_u32 s31, s36, 36864
    buffer_store_dwordx4 v[24:27], v36, s[16:19], s31 offen offset:0
    ds_read_b64_tr_b16 v[16:17], v38 offset:16384
    ds_read_b64_tr_b16 v[18:19], v38 offset:18432
    ds_read_b64_tr_b16 v[20:21], v38 offset:49152
    ds_read_b64_tr_b16 v[22:23], v38 offset:51200
    s_waitcnt lgkmcnt(0)
    v_lshlrev_b32 v48, 16, v16
    v_and_b32 v49, s37, v16
    v_lshlrev_b32 v50, 16, v20
    v_and_b32 v51, s37, v20
    v_add_f32 v48, v48, v50
    v_add_f32 v49, v49, v51
    v_cvt_pk_bf16_f32 v28, v48, v49
    v_lshlrev_b32 v48, 16, v17
    v_and_b32 v49, s37, v17
    v_lshlrev_b32 v50, 16, v21
    v_and_b32 v51, s37, v21
    v_add_f32 v48, v48, v50
    v_add_f32 v49, v49, v51
    v_cvt_pk_bf16_f32 v29, v48, v49
    v_lshlrev_b32 v48, 16, v18
    v_and_b32 v49, s37, v18
    v_lshlrev_b32 v50, 16, v22
    v_and_b32 v51, s37, v22
    v_add_f32 v48, v48, v50
    v_add_f32 v49, v49, v51
    v_cvt_pk_bf16_f32 v30, v48, v49
    v_lshlrev_b32 v48, 16, v19
    v_and_b32 v49, s37, v19
    v_lshlrev_b32 v50, 16, v23
    v_and_b32 v51, s37, v23
    v_add_f32 v48, v48, v50
    v_add_f32 v49, v49, v51
    v_cvt_pk_bf16_f32 v31, v48, v49
    s_add_u32 s31, s36, 36864
    buffer_store_dwordx4 v[28:31], v36, s[16:19], s31 offen offset:64
L_k3_kernel_k3end_2:
L_k3_kernel_exit:
    s_endpgm

L_text_end:
.section .rodata,"a"

.p2align 6
.amdhsa_kernel k1_kernel
  .amdhsa_next_free_vgpr 128
  .amdhsa_next_free_sgpr 96
  .amdhsa_accum_offset 128
  .amdhsa_group_segment_fixed_size 0
  .amdhsa_kernarg_size 104
  .amdhsa_user_sgpr_count 2
  .amdhsa_user_sgpr_kernarg_segment_ptr 1
  .amdhsa_system_sgpr_workgroup_id_x 1
  .amdhsa_float_denorm_mode_32 3
.end_amdhsa_kernel

.p2align 6
.amdhsa_kernel k2_kernel
  .amdhsa_next_free_vgpr 228
  .amdhsa_next_free_sgpr 96
  .amdhsa_accum_offset 228
  .amdhsa_group_segment_fixed_size 0
  .amdhsa_kernarg_size 104
  .amdhsa_user_sgpr_count 2
  .amdhsa_user_sgpr_kernarg_segment_ptr 1
  .amdhsa_system_sgpr_workgroup_id_x 1
  .amdhsa_float_denorm_mode_32 3
.end_amdhsa_kernel

.p2align 6
.amdhsa_kernel k3_kernel
  .amdhsa_next_free_vgpr 100
  .amdhsa_next_free_sgpr 96
  .amdhsa_accum_offset 100
  .amdhsa_group_segment_fixed_size 0
  .amdhsa_kernarg_size 104
  .amdhsa_user_sgpr_count 2
  .amdhsa_user_sgpr_kernarg_segment_ptr 1
  .amdhsa_system_sgpr_workgroup_id_x 1
  .amdhsa_float_denorm_mode_32 3
.end_amdhsa_kernel
```
